```python
import torch

def _softmax(x, axis=-1):
    return torch.softmax(x, dim=axis)

def _gelu(x):
    return torch.nn.functional.gelu(x, approximate='tanh')

def _silu(x):
    return torch.nn.functional.silu(x)

def _sigmoid(x):
    return torch.sigmoid(x)

def _layernorm(x, axis=-1, eps=1e-05):
    m = x.mean(dim=axis, keepdim=True)
    v = x.var(dim=axis, keepdim=True, unbiased=False)
    return (x - m) / torch.sqrt(v + eps)

def _scatter_add(tgt, idx, src, axis=0):
    return tgt.clone().index_add_(axis, idx, src)

def _segment_sum(src, seg, n):
    out = torch.zeros((n,) + src.shape[1:], dtype=src.dtype)
    return out.index_add_(0, seg, src)

def _pad(x, pw):
    flat = tuple((v for pair in reversed(pw) for v in pair))
    return torch.nn.functional.pad(x, flat)
kernel_name = 'recurrent_scan__memory_aug_recurrent_mem_tr__dense_activation_mish__prompt'

def setup_inputs():

    _w = lambda a: (lambda t: t.to(torch.bfloat16) if t.is_floating_point() else t)(torch.as_tensor(a))

    def _A_setup():
        B, S, Dm = (1, 2048, 640)
        H, Dh = (32, 128)
        M, seg = (8, 32)
        seg = min(seg, S)
        S = S // seg * seg
        return {'x': _w((lambda *s: torch.randn(*s, dtype=torch.bfloat16) * 0.05)(B, S, Dm)), 'mem0': _w((lambda *s: torch.randn(*s, dtype=torch.bfloat16) * 0.8)(B, M, Dm)), 'Wq': _w((lambda *s: torch.randn(*s, dtype=torch.bfloat16) * 0.8)(Dm, H, Dh) * Dm ** (-0.5)), 'Wk': _w((lambda *s: torch.randn(*s, dtype=torch.bfloat16) * 0.8)(Dm, H, Dh) * Dm ** (-0.5)), 'Wv': _w((lambda *s: torch.randn(*s, dtype=torch.bfloat16) * 0.8)(Dm, H, Dh) * Dm ** (-0.5)), 'Wo': _w((lambda *s: torch.randn(*s, dtype=torch.bfloat16) * 0.8)(H, Dh, Dm) * (H * Dh) ** (-0.5)), 'seg_len': seg}
    _A_in = _A_setup()

    def _B_setup():
        B, S, D, F = (1, 2048, 640, 1728)
        return {'x': _w((lambda *s: torch.randn(*s, dtype=torch.bfloat16) * 0.05)(B, S, D)), 'w1': _w((lambda *s: torch.randn(*s, dtype=torch.bfloat16) * 0.8)(D, F) * D ** (-0.5)), 'b1': _w((lambda *s: torch.randn(*s, dtype=torch.bfloat16) * 0.4)(F)), 'w2': _w((lambda *s: torch.randn(*s, dtype=torch.bfloat16) * 0.2)(F, D) * F ** (-0.5))}
    _B_in = _B_setup()
    return {'A_x': _A_in['x'], 'A_mem0': _A_in['mem0'], 'A_Wq': _A_in['Wq'], 'A_Wk': _A_in['Wk'], 'A_Wv': _A_in['Wv'], 'A_Wo': _A_in['Wo'], 'A_seg_len': _A_in['seg_len'], 'B_x': _B_in['x'], 'B_w1': _B_in['w1'], 'B_b1': _B_in['b1'], 'B_w2': _B_in['w2']}

def reference(A_x, A_mem0, A_Wq, A_Wk, A_Wv, A_Wo, A_seg_len, B_x, B_w1, B_b1, B_w2):

    def _A_ref(x, mem0, Wq, Wk, Wv, Wo, seg_len):
        B, S, Dm = x.shape
        H, Dh = (Wq.shape[1], Wq.shape[2])
        M = mem0.shape[1]
        scale = Dh ** (-0.5)
        n_seg = S // seg_len
        L = M + seg_len
        idx = torch.arange(L)
        mask = (idx[:, None] < M) | (idx[:, None] >= idx[None, :])
        mem = mem0
        outs = []
        for s in range(n_seg):
            xs = x[:, s * seg_len:(s + 1) * seg_len, :].clone()
            h = torch.concatenate([mem, xs], axis=1)
            q = torch.einsum('btd,dhe->bhte', h, Wq)
            k = torch.einsum('btd,dhe->bhte', h, Wk)
            v = torch.einsum('btd,dhe->bhte', h, Wv)
            scores = torch.einsum('bhqe,bhke->bhqk', q, k) * scale
            scores = torch.where(mask[None, None], scores, -1000000000.0)
            p = _softmax(scores, axis=-1)
            o = torch.einsum('bhqk,bhke->bhqe', p, v)
            o = torch.einsum('bhte,hed->btd', o, Wo)
            mem = o[:, :M, :].clone()
            outs.append(o[:, M:, :])
        return torch.concatenate(outs, axis=1)

    def _B_ref(x, w1, b1, w2):
        h = torch.einsum('bsd,df->bsf', x, w1) + b1
        sp = torch.log1p(torch.exp(-torch.abs(h))) + torch.where(h > 0, h, torch.zeros_like(h))
        act = h * torch.tanh(sp)
        return torch.einsum('bsf,fd->bsd', act, w2)
    x = A_x
    xn = _layernorm(x, axis=-1)
    s = _A_ref(xn, A_mem0, A_Wq, A_Wk, A_Wv, A_Wo, A_seg_len)
    g = _silu(_B_ref(xn, B_w1, B_b1, B_w2))
    return x + s * g
```

```asm
; @launch grid=(256,1,1) block=(256,1,1) lds=163840
.amdgcn_target "amdgcn-amd-amdhsa--gfx950"
.text
.globl recurrent_scan__memory_aug_recurrent_mem_tr__dense_activation_mish__prompt_kernel
.p2align 8
.type recurrent_scan__memory_aug_recurrent_mem_tr__dense_activation_mish__prompt_kernel,@function
recurrent_scan__memory_aug_recurrent_mem_tr__dense_activation_mish__prompt_kernel:
    s_load_dwordx16 s[64:79], s[0:1], 0
    s_load_dwordx8 s[80:87], s[0:1], 64
    s_load_dwordx4 s[88:91], s[0:1], 96
    v_lshrrev_b32 v1, 6, v0
    v_and_b32 v0, 63, v0
    v_readfirstlane_b32 s3, v1
    s_getreg_b32 s6, hwreg(HW_REG_XCC_ID)
    s_and_b32 s6, s6, 7
    s_lshl_b32 s7, s6, 3
    s_lshl_b64 s[28:29], 1, s7
    v_mov_b32 v4, 0
    s_waitcnt lgkmcnt(0)
    s_mov_b32 s8, s90
    s_and_b32 s9, s91, 0xffff
    s_mov_b32 s10, 268435456
    s_mov_b32 s11, 0x20000
    s_mov_b32 s24, s88
    s_and_b32 s25, s89, 0xffff
    s_mov_b32 s26, 256
    s_mov_b32 s27, 0x20000
    s_cmp_lg_u32 s3, 0
    s_cbranch_scc1 notick_recurrent_scan__memory_aug_recurrent_mem_tr__dense_activation_mish__prompt_kernel_1
    v_mov_b32 v2, s28
    v_mov_b32 v3, s29
    s_mov_b64 exec, 1
    buffer_atomic_add_x2 v[2:3], off, s[24:27], 0 offset:0 sc0 sc1
    s_mov_b64 exec, -1
notick_recurrent_scan__memory_aug_recurrent_mem_tr__dense_activation_mish__prompt_kernel_1:
    s_bfe_u32 s30, s2, 0x50003
    s_cmp_ge_u32 s6, 2
    s_cbranch_scc1 pfw_recurrent_scan__memory_aug_recurrent_mem_tr__dense_activation_mish__prompt_kernel_2
    s_mov_b32 s12, s68
    s_and_b32 s13, s69, 0xffff
    s_mov_b32 s14, 5242880
    s_mov_b32 s15, 0x20000
    v_lshrrev_b32 v5, 1, v0
    v_lshlrev_b32 v5, 13, v5
    v_and_b32 v6, 1, v0
    v_lshl_add_u32 v5, v6, 7, v5
    s_lshl_b32 s30, s30, 8
    s_lshl_b32 s31, s3, 18
    s_add_u32 s30, s30, s31
    s_mul_i32 s31, s6, 2621440
    s_add_u32 s32, s30, s31
    s_sub_u32 s31, 2621440, s31
    s_add_u32 s33, s30, s31
    s_waitcnt vmcnt(0)
    s_branch pfe_recurrent_scan__memory_aug_recurrent_mem_tr__dense_activation_mish__prompt_kernel_3
pfw_recurrent_scan__memory_aug_recurrent_mem_tr__dense_activation_mish__prompt_kernel_2:
    s_mul_i32 s30, s30, 6
    s_add_u32 s30, s30, s6
    s_sub_u32 s30, s30, 2
    s_lshl_b32 s30, s30, 2
    s_add_u32 s30, s30, s3
    s_lshl_b32 s30, s30, 13
    v_lshlrev_b32 v5, 7, v0
    s_waitcnt vmcnt(0)
pfe_recurrent_scan__memory_aug_recurrent_mem_tr__dense_activation_mish__prompt_kernel_3:
    s_cmp_eq_u32 s3, 0
    s_cselect_b32 exec_lo, 1, 0
    s_mov_b32 exec_hi, 0
    ds_write_b64 v4, v[2:3]
    s_mov_b64 exec, -1
    s_waitcnt lgkmcnt(0)
    s_barrier
    ds_read_b64 v[2:3], v4
    s_waitcnt lgkmcnt(0)
    s_barrier
    v_sad_u8 v5, v2, 0, 0
    v_sad_u8 v5, v3, 0, v5
    v_readfirstlane_b32 s30, v2
    v_readfirstlane_b32 s31, v3
    v_readfirstlane_b32 s32, v5
    s_cmp_ge_u32 s32, 256
    s_cbranch_scc1 recurrent_scan__memory_aug_recurrent_mem_tr__dense_activation_mish__prompt_kernel_exit
    s_lshr_b64 s[34:35], s[30:31], s7
    s_and_b32 s5, s34, 255
    s_mov_b32 s4, s6
    s_cmp_lg_u32 s3, 0
    s_cbranch_scc1 nz_recurrent_scan__memory_aug_recurrent_mem_tr__dense_activation_mish__prompt_kernel_4
    s_cmp_lg_u32 s32, 255
    s_cbranch_scc1 nz_recurrent_scan__memory_aug_recurrent_mem_tr__dense_activation_mish__prompt_kernel_4
    s_add_u32 s34, s30, s28
    s_addc_u32 s35, s31, s29
    v_mov_b32 v2, s34
    v_mov_b32 v3, s35
    buffer_store_dwordx2 v[2:3], off, s[24:27], 0 offset:72 sc1
nz_recurrent_scan__memory_aug_recurrent_mem_tr__dense_activation_mish__prompt_kernel_4:
    s_cmp_lt_u32 s5, 32
    s_cbranch_scc1 roleok_recurrent_scan__memory_aug_recurrent_mem_tr__dense_activation_mish__prompt_kernel_6
    s_mov_b32 s36, 0
snsp_recurrent_scan__memory_aug_recurrent_mem_tr__dense_activation_mish__prompt_kernel_7:
    buffer_load_dwordx2 v[2:3], off, s[24:27], 0 offset:72 sc1
    s_waitcnt vmcnt(0)
    v_readfirstlane_b32 s34, v2
    v_readfirstlane_b32 s35, v3
    s_cmp_lg_u64 s[34:35], 0
    s_cbranch_scc1 sngot_recurrent_scan__memory_aug_recurrent_mem_tr__dense_activation_mish__prompt_kernel_8
    s_add_u32 s36, s36, 1
    s_cmp_gt_u32 s36, 100000
    s_cbranch_scc1 recurrent_scan__memory_aug_recurrent_mem_tr__dense_activation_mish__prompt_kernel_exit
    s_sleep 2
    s_branch snsp_recurrent_scan__memory_aug_recurrent_mem_tr__dense_activation_mish__prompt_kernel_7
sngot_recurrent_scan__memory_aug_recurrent_mem_tr__dense_activation_mish__prompt_kernel_8:
    s_sub_u32 s37, s5, 32
    s_bfe_u32 s38, s34, 524288
    s_max_u32 s38, s38, 32
    s_sub_u32 s38, s38, 32
    s_cmp_gt_u32 s6, 0
    s_cselect_b32 s38, s38, 0
    s_add_u32 s37, s37, s38
    s_bfe_u32 s38, s34, 524296
    s_max_u32 s38, s38, 32
    s_sub_u32 s38, s38, 32
    s_cmp_gt_u32 s6, 1
    s_cselect_b32 s38, s38, 0
    s_add_u32 s37, s37, s38
    s_bfe_u32 s38, s34, 524304
    s_max_u32 s38, s38, 32
    s_sub_u32 s38, s38, 32
    s_cmp_gt_u32 s6, 2
    s_cselect_b32 s38, s38, 0
    s_add_u32 s37, s37, s38
    s_bfe_u32 s38, s34, 524312
    s_max_u32 s38, s38, 32
    s_sub_u32 s38, s38, 32
    s_cmp_gt_u32 s6, 3
    s_cselect_b32 s38, s38, 0
    s_add_u32 s37, s37, s38
    s_bfe_u32 s38, s35, 524288
    s_max_u32 s38, s38, 32
    s_sub_u32 s38, s38, 32
    s_cmp_gt_u32 s6, 4
    s_cselect_b32 s38, s38, 0
    s_add_u32 s37, s37, s38
    s_bfe_u32 s38, s35, 524296
    s_max_u32 s38, s38, 32
    s_sub_u32 s38, s38, 32
    s_cmp_gt_u32 s6, 5
    s_cselect_b32 s38, s38, 0
    s_add_u32 s37, s37, s38
    s_bfe_u32 s38, s35, 524304
    s_max_u32 s38, s38, 32
    s_sub_u32 s38, s38, 32
    s_cmp_gt_u32 s6, 6
    s_cselect_b32 s38, s38, 0
    s_add_u32 s37, s37, s38
    s_mov_b32 s4, 7
    s_mov_b32 s5, 31
    s_mov_b32 s40, 0
    s_bfe_u32 s38, s34, 524288
    s_min_u32 s38, s38, 32
    s_add_u32 s39, s38, s37
    s_cmp_lt_u32 s39, 32
    s_cselect_b32 s41, 1, 0
    s_andn2_b32 s41, s41, s40
    s_or_b32 s40, s40, s41
    s_cmp_lg_u32 s41, 0
    s_cselect_b32 s4, 0, s4
    s_cselect_b32 s5, s39, s5
    s_sub_u32 s37, s39, 32
    s_bfe_u32 s38, s34, 524296
    s_min_u32 s38, s38, 32
    s_add_u32 s39, s38, s37
    s_cmp_lt_u32 s39, 32
    s_cselect_b32 s41, 1, 0
    s_andn2_b32 s41, s41, s40
    s_or_b32 s40, s40, s41
    s_cmp_lg_u32 s41, 0
    s_cselect_b32 s4, 1, s4
    s_cselect_b32 s5, s39, s5
    s_sub_u32 s37, s39, 32
    s_bfe_u32 s38, s34, 524304
    s_min_u32 s38, s38, 32
    s_add_u32 s39, s38, s37
    s_cmp_lt_u32 s39, 32
    s_cselect_b32 s41, 1, 0
    s_andn2_b32 s41, s41, s40
    s_or_b32 s40, s40, s41
    s_cmp_lg_u32 s41, 0
    s_cselect_b32 s4, 2, s4
    s_cselect_b32 s5, s39, s5
    s_sub_u32 s37, s39, 32
    s_bfe_u32 s38, s34, 524312
    s_min_u32 s38, s38, 32
    s_add_u32 s39, s38, s37
    s_cmp_lt_u32 s39, 32
    s_cselect_b32 s41, 1, 0
    s_andn2_b32 s41, s41, s40
    s_or_b32 s40, s40, s41
    s_cmp_lg_u32 s41, 0
    s_cselect_b32 s4, 3, s4
    s_cselect_b32 s5, s39, s5
    s_sub_u32 s37, s39, 32
    s_bfe_u32 s38, s35, 524288
    s_min_u32 s38, s38, 32
    s_add_u32 s39, s38, s37
    s_cmp_lt_u32 s39, 32
    s_cselect_b32 s41, 1, 0
    s_andn2_b32 s41, s41, s40
    s_or_b32 s40, s40, s41
    s_cmp_lg_u32 s41, 0
    s_cselect_b32 s4, 4, s4
    s_cselect_b32 s5, s39, s5
    s_sub_u32 s37, s39, 32
    s_bfe_u32 s38, s35, 524296
    s_min_u32 s38, s38, 32
    s_add_u32 s39, s38, s37
    s_cmp_lt_u32 s39, 32
    s_cselect_b32 s41, 1, 0
    s_andn2_b32 s41, s41, s40
    s_or_b32 s40, s40, s41
    s_cmp_lg_u32 s41, 0
    s_cselect_b32 s4, 5, s4
    s_cselect_b32 s5, s39, s5
    s_sub_u32 s37, s39, 32
    s_bfe_u32 s38, s35, 524304
    s_min_u32 s38, s38, 32
    s_add_u32 s39, s38, s37
    s_cmp_lt_u32 s39, 32
    s_cselect_b32 s41, 1, 0
    s_andn2_b32 s41, s41, s40
    s_or_b32 s40, s40, s41
    s_cmp_lg_u32 s41, 0
    s_cselect_b32 s4, 6, s4
    s_cselect_b32 s5, s39, s5
    s_sub_u32 s37, s39, 32
    s_bfe_u32 s38, s35, 524312
    s_min_u32 s38, s38, 32
    s_add_u32 s39, s38, s37
    s_cmp_lt_u32 s39, 32
    s_cselect_b32 s41, 1, 0
    s_andn2_b32 s41, s41, s40
    s_or_b32 s40, s40, s41
    s_cmp_lg_u32 s41, 0
    s_cselect_b32 s4, 7, s4
    s_cselect_b32 s5, s39, s5
    s_sub_u32 s37, s39, 32
roleok_recurrent_scan__memory_aug_recurrent_mem_tr__dense_activation_mish__prompt_kernel_6:
    s_lshl_b32 s2, s5, 3
    s_add_u32 s2, s2, s4
    s_cmp_ge_u32 s4, 2
    s_cbranch_scc1 worker_recurrent_scan__memory_aug_recurrent_mem_tr__dense_activation_mish__prompt_kernel_9
    s_mov_b32 s12, s68
    s_and_b32 s13, s69, 0xffff
    s_mov_b32 s14, 5242880
    s_mov_b32 s15, 0x20000
    s_mov_b32 s16, s70
    s_and_b32 s17, s71, 0xffff
    s_mov_b32 s18, 5242880
    s_mov_b32 s19, 0x20000
    s_mov_b32 s20, s72
    s_and_b32 s21, s73, 0xffff
    s_mov_b32 s22, 5242880
    s_mov_b32 s23, 0x20000
    s_mov_b32 s96, s74
    s_and_b32 s97, s75, 0xffff
    s_mov_b32 s98, 5242880
    s_mov_b32 s99, 0x20000
    v_lshrrev_b32 v16, 3, v0
    v_and_b32 v17, 7, v0
    v_and_b32 v18, 1, v16
    v_lshlrev_b32 v20, 2, v18
    v_and_b32 v19, 2, v16
    v_add_u32 v20, v20, v19
    v_lshrrev_b32 v21, 2, v16
    v_add_u32 v20, v20, v21
    v_lshlrev_b32 v20, 13, v20
    v_lshlrev_b32 v22, 1, v19
    v_xor_b32 v22, v22, v17
    v_lshl_add_u32 v20, v22, 4, v20
    v_lshl_add_u32 v21, v21, 2, v18
    v_lshl_add_u32 v21, v19, 2, v21
    v_mul_u32_u24 v21, 1280, v21
    v_lshl_add_u32 v21, v17, 4, v21
    s_mul_i32 s37, s3, 36864
    s_add_u32 s37, s37, 16384
    s_lshl_b32 s38, s5, 8
    s_lshr_b32 s39, s3, 1
    s_lshl_b32 s39, s39, 7
    s_add_u32 s38, s38, s39
    s_mul_i32 s39, s4, 2621440
    s_add_u32 s50, s38, s39
    s_sub_u32 s39, 2621440, s39
    s_add_u32 s51, s38, s39
    s_lshl_b32 s39, s3, 19
    s_add_u32 s40, s50, s39
    s_add_u32 s42, s51, s39
    s_xor_b32 s39, s39, 1048576
    s_add_u32 s41, s50, s39
    s_add_u32 s43, s51, s39
    s_bitcmp1_b32 s3, 0
    s_cselect_b32 s44, s51, s50
    s_add_u32 s44, s44, 2097152
    s_mul_i32 s45, s5, 163840
    s_mul_i32 s39, s4, 640
    s_add_u32 s45, s45, s39
    s_mul_i32 s46, s3, 40960
    s_add_u32 s46, s46, s45
    s_add_u32 s46, s46, 512
    s_lshl_b32 s39, s3, 7
    s_add_u32 s45, s45, s39
    s_add_u32 s39, s46, 0
    s_add_u32 m0, s37, 32768
    s_nop 0
    buffer_load_dwordx4 v21, s[96:99], s39 offen lds
    s_add_u32 s39, s46, 2560
    s_add_u32 m0, s37, 33792
    s_nop 0
    buffer_load_dwordx4 v21, s[96:99], s39 offen lds
    s_add_u32 s39, s46, 20480
    s_add_u32 m0, s37, 34816
    s_nop 0
    buffer_load_dwordx4 v21, s[96:99], s39 offen lds
    s_add_u32 s39, s46, 23040
    s_add_u32 m0, s37, 35840
    s_nop 0
    buffer_load_dwordx4 v21, s[96:99], s39 offen lds
    s_add_u32 s39, s40, 0
    s_add_u32 m0, s37, 0
    s_nop 0
    buffer_load_dwordx4 v20, s[12:15], s39 offen lds
    s_add_u32 s39, s40, 65536
    s_add_u32 m0, s37, 1024
    s_nop 0
    buffer_load_dwordx4 v20, s[12:15], s39 offen lds
    s_add_u32 s39, s40, 131072
    s_add_u32 m0, s37, 2048
    s_nop 0
    buffer_load_dwordx4 v20, s[12:15], s39 offen lds
    s_add_u32 s39, s40, 196608
    s_add_u32 m0, s37, 3072
    s_nop 0
    buffer_load_dwordx4 v20, s[12:15], s39 offen lds
    s_add_u32 s39, s40, 262144
    s_add_u32 m0, s37, 4096
    s_nop 0
    buffer_load_dwordx4 v20, s[12:15], s39 offen lds
    s_add_u32 s39, s40, 327680
    s_add_u32 m0, s37, 5120
    s_nop 0
    buffer_load_dwordx4 v20, s[12:15], s39 offen lds
    s_add_u32 s39, s40, 393216
    s_add_u32 m0, s37, 6144
    s_nop 0
    buffer_load_dwordx4 v20, s[12:15], s39 offen lds
    s_add_u32 s39, s40, 458752
    s_add_u32 m0, s37, 7168
    s_nop 0
    buffer_load_dwordx4 v20, s[12:15], s39 offen lds
    s_add_u32 s39, s41, 0
    s_add_u32 m0, s37, 8192
    s_nop 0
    buffer_load_dwordx4 v20, s[12:15], s39 offen lds
    s_add_u32 s39, s41, 65536
    s_add_u32 m0, s37, 9216
    s_nop 0
    buffer_load_dwordx4 v20, s[12:15], s39 offen lds
    s_add_u32 s39, s41, 131072
    s_add_u32 m0, s37, 10240
    s_nop 0
    buffer_load_dwordx4 v20, s[12:15], s39 offen lds
    s_add_u32 s39, s41, 196608
    s_add_u32 m0, s37, 11264
    s_nop 0
    buffer_load_dwordx4 v20, s[12:15], s39 offen lds
    s_add_u32 s39, s41, 262144
    s_add_u32 m0, s37, 12288
    s_nop 0
    buffer_load_dwordx4 v20, s[12:15], s39 offen lds
    s_add_u32 s39, s41, 327680
    s_add_u32 m0, s37, 13312
    s_nop 0
    buffer_load_dwordx4 v20, s[12:15], s39 offen lds
    s_add_u32 s39, s41, 393216
    s_add_u32 m0, s37, 14336
    s_nop 0
    buffer_load_dwordx4 v20, s[12:15], s39 offen lds
    s_add_u32 s39, s41, 458752
    s_add_u32 m0, s37, 15360
    s_nop 0
    buffer_load_dwordx4 v20, s[12:15], s39 offen lds
    s_add_u32 s39, s42, 0
    s_add_u32 m0, s37, 16384
    s_nop 0
    buffer_load_dwordx4 v20, s[12:15], s39 offen lds
    s_add_u32 s39, s42, 65536
    s_add_u32 m0, s37, 17408
    s_nop 0
    buffer_load_dwordx4 v20, s[12:15], s39 offen lds
    s_add_u32 s39, s42, 131072
    s_add_u32 m0, s37, 18432
    s_nop 0
    buffer_load_dwordx4 v20, s[12:15], s39 offen lds
    s_add_u32 s39, s42, 196608
    s_add_u32 m0, s37, 19456
    s_nop 0
    buffer_load_dwordx4 v20, s[12:15], s39 offen lds
    s_add_u32 s39, s42, 262144
    s_add_u32 m0, s37, 20480
    s_nop 0
    buffer_load_dwordx4 v20, s[12:15], s39 offen lds
    s_add_u32 s39, s42, 327680
    s_add_u32 m0, s37, 21504
    s_nop 0
    buffer_load_dwordx4 v20, s[12:15], s39 offen lds
    s_add_u32 s39, s42, 393216
    s_add_u32 m0, s37, 22528
    s_nop 0
    buffer_load_dwordx4 v20, s[12:15], s39 offen lds
    s_add_u32 s39, s42, 458752
    s_add_u32 m0, s37, 23552
    s_nop 0
    buffer_load_dwordx4 v20, s[12:15], s39 offen lds
    s_add_u32 s39, s43, 0
    s_add_u32 m0, s37, 24576
    s_nop 0
    buffer_load_dwordx4 v20, s[12:15], s39 offen lds
    s_add_u32 s39, s43, 65536
    s_add_u32 m0, s37, 25600
    s_nop 0
    buffer_load_dwordx4 v20, s[12:15], s39 offen lds
    s_add_u32 s39, s43, 131072
    s_add_u32 m0, s37, 26624
    s_nop 0
    buffer_load_dwordx4 v20, s[12:15], s39 offen lds
    s_add_u32 s39, s43, 196608
    s_add_u32 m0, s37, 27648
    s_nop 0
    buffer_load_dwordx4 v20, s[12:15], s39 offen lds
    s_add_u32 s39, s43, 262144
    s_add_u32 m0, s37, 28672
    s_nop 0
    buffer_load_dwordx4 v20, s[12:15], s39 offen lds
    s_add_u32 s39, s43, 327680
    s_add_u32 m0, s37, 29696
    s_nop 0
    buffer_load_dwordx4 v20, s[12:15], s39 offen lds
    s_add_u32 s39, s43, 393216
    s_add_u32 m0, s37, 30720
    s_nop 0
    buffer_load_dwordx4 v20, s[12:15], s39 offen lds
    s_add_u32 s39, s43, 458752
    s_add_u32 m0, s37, 31744
    s_nop 0
    buffer_load_dwordx4 v20, s[12:15], s39 offen lds
    v_lshrrev_b32 v16, 4, v0
    v_and_b32 v17, 15, v0
    v_bfe_u32 v18, v0, 1, 1
    v_mov_b32 v1, 0x4444
    v_mul_u32_u24 v18, 0xaaaa, v18
    v_add_u32 v1, v1, v18
    s_lshl_b32 s35, s3, 10
    v_lshlrev_b32 v2, 5, v17
    v_lshl_add_u32 v2, v16, 3, v2
    v_add_u32 v2, s35, v2
    v_lshlrev_b32 v3, 3, v0
    v_lshrrev_b32 v18, 1, v16
    v_lshlrev_b32 v4, 8, v18
    v_and_b32 v18, 1, v16
    v_lshl_add_u32 v4, v18, 5, v4
    v_lshrrev_b32 v18, 2, v17
    v_lshl_add_u32 v4, v18, 6, v4
    v_and_b32 v18, 1, v17
    v_lshl_add_u32 v4, v18, 4, v4
    v_bfe_u32 v18, v17, 1, 1
    v_xor_b32 v18, 1, v18
    v_lshl_add_u32 v4, v18, 11, v4
    s_lshl_b32 s36, s3, 9
    v_add_u32 v4, s36, v4
    v_and_b32 v18, 12, v17
    v_add_u32 v18, v18, v16
    v_lshlrev_b32 v5, 11, v18
    v_and_b32 v18, 3, v17
    v_lshl_add_u32 v5, v18, 4, v5
    v_bfe_u32 v19, v17, 1, 1
    v_lshlrev_b32 v7, 5, v19
    v_and_b32 v19, 1, v17
    v_lshl_add_u32 v7, v19, 3, v7
    v_lshrrev_b32 v19, 1, v16
    v_lshl_add_u32 v7, v19, 4, v7
    v_mul_u32_u24 v22, 1280, v19
    v_and_b32 v19, 1, v16
    v_lshl_add_u32 v7, v19, 2, v7
    v_lshl_add_u32 v18, v19, 3, v18
    v_lshl_add_u32 v22, v18, 1, v22
    v_bfe_u32 v18, v17, 3, 1
    v_lshlrev_b32 v18, 4, v18
    v_mov_b32 v19, 0x3c00
    v_lshlrev_b32 v6, v18, v19
    v_lshrrev_b32 v18, 1, v16
    v_lshlrev_b32 v19, 11, v18
    v_bfe_u32 v18, v0, 2, 3
    v_lshl_add_u32 v19, v18, 7, v19
    v_and_b32 v18, 3, v0
    v_lshl_add_u32 v27, v18, 5, v19
    v_add_u32 v27, s37, v27
    v_lshl_add_u32 v28, v18, 3, v19
    s_lshl_b32 s38, s3, 5
    s_add_u32 s38, s38, 49152
    v_add_u32 v28, s38, v28
    v_add_u32 v29, 73728, v28
    v_lshl_add_u32 v19, v18, 4, v19
    v_bfe_u32 v18, v0, 3, 1
    s_and_b32 s38, s3, 1
    v_xor_b32 v18, s38, v18
    v_lshl_add_u32 v19, v18, 6, v19
    v_add_u32 v23, s37, v19
    s_xor_b32 s38, s3, 1
    s_mul_i32 s38, s38, 36864
    s_add_u32 s38, s38, 16384
    v_add_u32 v24, s38, v19
    v_min_u32 v25, v23, v24
    v_max_u32 v26, v23, v24
    v_lshlrev_b32 v0, 4, v0
    v_add_u32 v8, s37, v0
    v_add_u32 v9, s35, v0
    v_lshrrev_b32 v13, 2, v9
    v_xor_b32 v10, 0x400, v9
    v_xor_b32 v11, 0x800, v9
    v_xor_b32 v12, 0xc00, v9
    s_mul_i32 s39, s4, 327680
    s_add_u32 s39, s39, 96468992
    s_lshl_b32 s100, s5, 6
    s_lshl_b32 s101, s3, 15
    s_add_u32 s100, s100, s101
    s_add_u32 s100, s100, s39
    s_lshl_b32 s28, s3, 5
    s_add_u32 s28, s28, s5
    s_lshl_b32 s101, s28, 11
    s_add_u32 s101, s101, s39
    s_lshl_b32 s39, s4, 16
    s_add_u32 s29, s39, 97779712
    s_lshl_b32 s39, s4, 20
    s_add_u32 s30, s39, 98566144
    s_xor_b32 s39, s39, 0x100000
    s_add_u32 s31, s39, 98566144
    s_lshl_b32 s32, s28, 6
    s_mov_b32 s6, 0xf000f000
    s_mov_b32 s7, 0xf000f000
    s_cmp_lt_u32 s28, 80
    s_cselect_b32 s56, -1, 0
    s_mov_b32 s57, s56
    s_mov_b32 s92, s66
    s_and_b32 s93, s67, 0xffff
    s_mov_b32 s94, 10240
    s_mov_b32 s95, 0x20000
    s_and_b32 s39, s28, 3
    s_mul_i32 s39, s39, 2560
    s_lshr_b32 s38, s28, 2
    s_lshl_b32 s38, s38, 5
    s_add_u32 s39, s39, s38
    s_mul_i32 s38, s4, 640
    s_add_u32 s39, s39, s38
    s_and_b64 exec, s[6:7], s[56:57]
    buffer_load_ushort v16, v22, s[92:95], s39 offen
    buffer_load_ushort v17, v22, s[92:95], s39 offen offset:8
    s_mov_b64 exec, -1
    s_add_u32 s38, s32, s29
    s_add_u32 s39, s32, s30
    v_mov_b32 v92, -1
    v_mov_b32 v93, -1
    v_mov_b32 v94, -1
    v_mov_b32 v95, -1
    v_lshrrev_b32 v18, 6, v0
    v_and_b32 v19, 48, v0
    v_lshl_add_u32 v18, v18, 13, v19
    s_add_u32 s34, s101, 163840
    s_mov_b64 exec, s[56:57]
    buffer_store_dwordx4 v[92:95], v0, s[8:11], s101 offen sc1
    buffer_store_dwordx4 v[92:95], v0, s[8:11], s101 offen offset:1024 sc1
    buffer_store_dwordx4 v[92:95], v0, s[8:11], s34 offen sc1
    buffer_store_dwordx4 v[92:95], v0, s[8:11], s34 offen offset:1024 sc1
    s_and_b32 exec_lo, s56, 0xfff0
    s_mov_b32 exec_hi, 0
    buffer_store_dwordx4 v[92:95], v18, s[8:11], s38 offen sc1
    s_mov_b64 exec, -1
    s_sub_u32 s52, s5, s3
    s_lshl_b32 s52, s52, 8
    s_add_u32 s52, s52, 97910784
    s_mul_i32 s39, s5, 2097152
    s_lshl_b32 s54, s3, 11
    s_add_u32 s51, s54, 0
    s_add_u32 s54, s54, s39
    s_add_u32 s53, s54, 4202496
    s_add_u32 s54, s54, 4210688
    s_waitcnt vmcnt(31)
    s_barrier
    ds_read_b64_tr_b16 a[240:241], v28 offset:0
    ds_read_b64_tr_b16 a[242:243], v28 offset:1024
    ds_read_b64_tr_b16 a[244:245], v28 offset:36864
    ds_read_b64_tr_b16 a[246:247], v28 offset:37888
    ds_read_b64_tr_b16 a[248:249], v29 offset:0
    ds_read_b64_tr_b16 a[250:251], v29 offset:1024
    ds_read_b64_tr_b16 a[252:253], v29 offset:36864
    ds_read_b64_tr_b16 a[254:255], v29 offset:37888
    ds_read_b64_tr_b16 v[96:97], v23 offset:0
    ds_read_b64_tr_b16 v[98:99], v23 offset:1024
    ds_read_b64_tr_b16 v[100:101], v23 offset:4096
    ds_read_b64_tr_b16 v[102:103], v23 offset:5120
    ds_read_b64_tr_b16 v[104:105], v23 offset:8
    ds_read_b64_tr_b16 v[106:107], v23 offset:1032
    ds_read_b64_tr_b16 v[108:109], v23 offset:4104
    ds_read_b64_tr_b16 v[110:111], v23 offset:5128
    ds_read_b64_tr_b16 v[144:145], v24 offset:0
    ds_read_b64_tr_b16 v[146:147], v24 offset:1024
    ds_read_b64_tr_b16 v[148:149], v24 offset:4096
    ds_read_b64_tr_b16 v[150:151], v24 offset:5120
    ds_read_b64_tr_b16 v[152:153], v24 offset:8
    ds_read_b64_tr_b16 v[154:155], v24 offset:1032
    ds_read_b64_tr_b16 v[156:157], v24 offset:4104
    ds_read_b64_tr_b16 v[158:159], v24 offset:5128
    s_waitcnt lgkmcnt(0)
    s_waitcnt vmcnt(23)
    s_barrier
    s_add_u32 s39, s44, 0
    s_add_u32 m0, s37, 0
    s_nop 0
    buffer_load_dwordx4 v20, s[12:15], s39 offen lds
    s_add_u32 s39, s44, 65536
    s_add_u32 m0, s37, 1024
    s_nop 0
    buffer_load_dwordx4 v20, s[12:15], s39 offen lds
    s_add_u32 s39, s44, 131072
    s_add_u32 m0, s37, 2048
    s_nop 0
    buffer_load_dwordx4 v20, s[12:15], s39 offen lds
    s_add_u32 s39, s44, 196608
    s_add_u32 m0, s37, 3072
    s_nop 0
    buffer_load_dwordx4 v20, s[12:15], s39 offen lds
    s_add_u32 s39, s44, 262144
    s_add_u32 m0, s37, 4096
    s_nop 0
    buffer_load_dwordx4 v20, s[12:15], s39 offen lds
    s_add_u32 s39, s44, 327680
    s_add_u32 m0, s37, 5120
    s_nop 0
    buffer_load_dwordx4 v20, s[12:15], s39 offen lds
    s_add_u32 s39, s44, 393216
    s_add_u32 m0, s37, 6144
    s_nop 0
    buffer_load_dwordx4 v20, s[12:15], s39 offen lds
    s_add_u32 s39, s44, 458752
    s_add_u32 m0, s37, 7168
    s_nop 0
    buffer_load_dwordx4 v20, s[12:15], s39 offen lds
    ds_read_b64_tr_b16 v[176:177], v23 offset:8192
    ds_read_b64_tr_b16 v[178:179], v23 offset:9216
    ds_read_b64_tr_b16 v[180:181], v23 offset:12288
    ds_read_b64_tr_b16 v[182:183], v23 offset:13312
    ds_read_b64_tr_b16 v[184:185], v23 offset:8200
    ds_read_b64_tr_b16 v[186:187], v23 offset:9224
    ds_read_b64_tr_b16 v[188:189], v23 offset:12296
    ds_read_b64_tr_b16 v[190:191], v23 offset:13320
    ds_read_b64_tr_b16 v[208:209], v24 offset:8192
    ds_read_b64_tr_b16 v[210:211], v24 offset:9216
    ds_read_b64_tr_b16 v[212:213], v24 offset:12288
    ds_read_b64_tr_b16 v[214:215], v24 offset:13312
    ds_read_b64_tr_b16 v[216:217], v24 offset:8200
    ds_read_b64_tr_b16 v[218:219], v24 offset:9224
    ds_read_b64_tr_b16 v[220:221], v24 offset:12296
    ds_read_b64_tr_b16 v[222:223], v24 offset:13320
    s_waitcnt lgkmcnt(0)
    s_waitcnt vmcnt(23)
    s_barrier
    s_add_u32 s39, s41, 0
    s_add_u32 m0, s37, 8192
    s_nop 0
    buffer_load_dwordx4 v20, s[16:19], s39 offen lds
    s_add_u32 s39, s41, 65536
    s_add_u32 m0, s37, 9216
    s_nop 0
    buffer_load_dwordx4 v20, s[16:19], s39 offen lds
    s_add_u32 s39, s41, 131072
    s_add_u32 m0, s37, 10240
    s_nop 0
    buffer_load_dwordx4 v20, s[16:19], s39 offen lds
    s_add_u32 s39, s41, 196608
    s_add_u32 m0, s37, 11264
    s_nop 0
    buffer_load_dwordx4 v20, s[16:19], s39 offen lds
    s_add_u32 s39, s41, 262144
    s_add_u32 m0, s37, 12288
    s_nop 0
    buffer_load_dwordx4 v20, s[16:19], s39 offen lds
    s_add_u32 s39, s41, 327680
    s_add_u32 m0, s37, 13312
    s_nop 0
    buffer_load_dwordx4 v20, s[16:19], s39 offen lds
    s_add_u32 s39, s41, 393216
    s_add_u32 m0, s37, 14336
    s_nop 0
    buffer_load_dwordx4 v20, s[16:19], s39 offen lds
    s_add_u32 s39, s41, 458752
    s_add_u32 m0, s37, 15360
    s_nop 0
    buffer_load_dwordx4 v20, s[16:19], s39 offen lds
    ds_read_b64_tr_b16 v[240:241], v23 offset:16384
    ds_read_b64_tr_b16 v[242:243], v23 offset:17408
    ds_read_b64_tr_b16 v[244:245], v23 offset:20480
    ds_read_b64_tr_b16 v[246:247], v23 offset:21504
    ds_read_b64_tr_b16 v[248:249], v23 offset:16392
    ds_read_b64_tr_b16 v[250:251], v23 offset:17416
    ds_read_b64_tr_b16 v[252:253], v23 offset:20488
    ds_read_b64_tr_b16 v[254:255], v23 offset:21512
    ds_read_b64_tr_b16 a[64:65], v24 offset:16384
    ds_read_b64_tr_b16 a[66:67], v24 offset:17408
    ds_read_b64_tr_b16 a[68:69], v24 offset:20480
    ds_read_b64_tr_b16 a[70:71], v24 offset:21504
    ds_read_b64_tr_b16 a[72:73], v24 offset:16392
    ds_read_b64_tr_b16 a[74:75], v24 offset:17416
    ds_read_b64_tr_b16 a[76:77], v24 offset:20488
    ds_read_b64_tr_b16 a[78:79], v24 offset:21512
    s_waitcnt lgkmcnt(0)
    s_waitcnt vmcnt(23)
    s_barrier
    s_waitcnt vmcnt(21)
    s_add_u32 s38, s32, s29
    s_add_u32 s39, s32, s30
    s_xor_b32 s34, s39, 8192
    v_lshl_or_b32 v16, v17, 16, v16
    s_and_b64 exec, s[6:7], s[56:57]
    v_min_u32 v16, 0xfffffffe, v16
    buffer_store_dword v16, v7, s[8:11], s39 offen sc1
    buffer_store_dword v16, v7, s[8:11], s34 offen sc1
    buffer_store_dword v16, v7, s[8:11], s38 offen sc1
    s_mov_b64 exec, -1
    s_add_u32 s39, s42, 0
    s_add_u32 m0, s37, 16384
    s_nop 0
    buffer_load_dwordx4 v20, s[16:19], s39 offen lds
    s_add_u32 s39, s42, 65536
    s_add_u32 m0, s37, 17408
    s_nop 0
    buffer_load_dwordx4 v20, s[16:19], s39 offen lds
    s_add_u32 s39, s42, 131072
    s_add_u32 m0, s37, 18432
    s_nop 0
    buffer_load_dwordx4 v20, s[16:19], s39 offen lds
    s_add_u32 s39, s42, 196608
    s_add_u32 m0, s37, 19456
    s_nop 0
    buffer_load_dwordx4 v20, s[16:19], s39 offen lds
    s_add_u32 s39, s42, 262144
    s_add_u32 m0, s37, 20480
    s_nop 0
    buffer_load_dwordx4 v20, s[16:19], s39 offen lds
    s_add_u32 s39, s42, 327680
    s_add_u32 m0, s37, 21504
    s_nop 0
    buffer_load_dwordx4 v20, s[16:19], s39 offen lds
    s_add_u32 s39, s42, 393216
    s_add_u32 m0, s37, 22528
    s_nop 0
    buffer_load_dwordx4 v20, s[16:19], s39 offen lds
    s_add_u32 s39, s42, 458752
    s_add_u32 m0, s37, 23552
    s_nop 0
    buffer_load_dwordx4 v20, s[16:19], s39 offen lds
    ds_read_b64_tr_b16 a[112:113], v23 offset:24576
    ds_read_b64_tr_b16 a[114:115], v23 offset:25600
    ds_read_b64_tr_b16 a[116:117], v23 offset:28672
    ds_read_b64_tr_b16 a[118:119], v23 offset:29696
    ds_read_b64_tr_b16 a[120:121], v23 offset:24584
    ds_read_b64_tr_b16 a[122:123], v23 offset:25608
    ds_read_b64_tr_b16 a[124:125], v23 offset:28680
    ds_read_b64_tr_b16 a[126:127], v23 offset:29704
    ds_read_b64_tr_b16 a[144:145], v24 offset:24576
    ds_read_b64_tr_b16 a[146:147], v24 offset:25600
    ds_read_b64_tr_b16 a[148:149], v24 offset:28672
    ds_read_b64_tr_b16 a[150:151], v24 offset:29696
    ds_read_b64_tr_b16 a[152:153], v24 offset:24584
    ds_read_b64_tr_b16 a[154:155], v24 offset:25608
    ds_read_b64_tr_b16 a[156:157], v24 offset:28680
    ds_read_b64_tr_b16 a[158:159], v24 offset:29704
    s_waitcnt lgkmcnt(0)
    s_waitcnt vmcnt(19)
    s_barrier
    s_add_u32 s39, s43, 0
    s_add_u32 m0, s37, 24576
    s_nop 0
    buffer_load_dwordx4 v20, s[20:23], s39 offen lds
    s_add_u32 s39, s43, 65536
    s_add_u32 m0, s37, 25600
    s_nop 0
    buffer_load_dwordx4 v20, s[20:23], s39 offen lds
    s_add_u32 s39, s43, 131072
    s_add_u32 m0, s37, 26624
    s_nop 0
    buffer_load_dwordx4 v20, s[20:23], s39 offen lds
    s_add_u32 s39, s43, 196608
    s_add_u32 m0, s37, 27648
    s_nop 0
    buffer_load_dwordx4 v20, s[20:23], s39 offen lds
    s_add_u32 s39, s43, 262144
    s_add_u32 m0, s37, 28672
    s_nop 0
    buffer_load_dwordx4 v20, s[20:23], s39 offen lds
    s_add_u32 s39, s43, 327680
    s_add_u32 m0, s37, 29696
    s_nop 0
    buffer_load_dwordx4 v20, s[20:23], s39 offen lds
    s_add_u32 s39, s43, 393216
    s_add_u32 m0, s37, 30720
    s_nop 0
    buffer_load_dwordx4 v20, s[20:23], s39 offen lds
    s_add_u32 s39, s43, 458752
    s_add_u32 m0, s37, 31744
    s_nop 0
    buffer_load_dwordx4 v20, s[20:23], s39 offen lds
    ds_read_b64_tr_b16 v[120:121], v25 offset:0
    ds_read_b64_tr_b16 v[122:123], v25 offset:1024
    ds_read_b64_tr_b16 v[124:125], v25 offset:4096
    ds_read_b64_tr_b16 v[126:127], v25 offset:5120
    ds_read_b64_tr_b16 v[128:129], v25 offset:8
    ds_read_b64_tr_b16 v[130:131], v25 offset:1032
    ds_read_b64_tr_b16 v[132:133], v25 offset:4104
    ds_read_b64_tr_b16 v[134:135], v25 offset:5128
    ds_read_b64_tr_b16 a[16:17], v26 offset:0
    ds_read_b64_tr_b16 a[18:19], v26 offset:1024
    ds_read_b64_tr_b16 a[20:21], v26 offset:4096
    ds_read_b64_tr_b16 a[22:23], v26 offset:5120
    ds_read_b64_tr_b16 a[24:25], v26 offset:8
    ds_read_b64_tr_b16 a[26:27], v26 offset:1032
    ds_read_b64_tr_b16 a[28:29], v26 offset:4104
    ds_read_b64_tr_b16 a[30:31], v26 offset:5128
    s_waitcnt lgkmcnt(0)
    s_waitcnt vmcnt(19)
    s_barrier
    s_add_u32 s39, s45, 0
    s_add_u32 m0, s37, 0
    s_nop 0
    buffer_load_dwordx4 v21, s[96:99], s39 offen lds
    s_add_u32 s39, s45, 2560
    s_add_u32 m0, s37, 1024
    s_nop 0
    buffer_load_dwordx4 v21, s[96:99], s39 offen lds
    s_add_u32 s39, s45, 20480
    s_add_u32 m0, s37, 2048
    s_nop 0
    buffer_load_dwordx4 v21, s[96:99], s39 offen lds
    s_add_u32 s39, s45, 23040
    s_add_u32 m0, s37, 3072
    s_nop 0
    buffer_load_dwordx4 v21, s[96:99], s39 offen lds
    s_add_u32 s39, s45, 40960
    s_add_u32 m0, s37, 4096
    s_nop 0
    buffer_load_dwordx4 v21, s[96:99], s39 offen lds
    s_add_u32 s39, s45, 43520
    s_add_u32 m0, s37, 5120
    s_nop 0
    buffer_load_dwordx4 v21, s[96:99], s39 offen lds
    s_add_u32 s39, s45, 61440
    s_add_u32 m0, s37, 6144
    s_nop 0
    buffer_load_dwordx4 v21, s[96:99], s39 offen lds
    s_add_u32 s39, s45, 64000
    s_add_u32 m0, s37, 7168
    s_nop 0
    buffer_load_dwordx4 v21, s[96:99], s39 offen lds
    ds_read_b64_tr_b16 v[192:193], v23 offset:8192
    ds_read_b64_tr_b16 v[194:195], v23 offset:9216
    ds_read_b64_tr_b16 v[196:197], v23 offset:12288
    ds_read_b64_tr_b16 v[198:199], v23 offset:13312
    ds_read_b64_tr_b16 v[200:201], v23 offset:8200
    ds_read_b64_tr_b16 v[202:203], v23 offset:9224
    ds_read_b64_tr_b16 v[204:205], v23 offset:12296
    ds_read_b64_tr_b16 v[206:207], v23 offset:13320
    ds_read_b64_tr_b16 v[224:225], v24 offset:8192
    ds_read_b64_tr_b16 v[226:227], v24 offset:9216
    ds_read_b64_tr_b16 v[228:229], v24 offset:12288
    ds_read_b64_tr_b16 v[230:231], v24 offset:13312
    ds_read_b64_tr_b16 v[232:233], v24 offset:8200
    ds_read_b64_tr_b16 v[234:235], v24 offset:9224
    ds_read_b64_tr_b16 v[236:237], v24 offset:12296
    ds_read_b64_tr_b16 v[238:239], v24 offset:13320
    s_waitcnt lgkmcnt(0)
    s_waitcnt vmcnt(16)
    s_barrier
    s_add_u32 s39, s45, 81920
    s_add_u32 m0, s37, 8192
    s_nop 0
    buffer_load_dwordx4 v21, s[96:99], s39 offen lds
    s_add_u32 s39, s45, 84480
    s_add_u32 m0, s37, 9216
    s_nop 0
    buffer_load_dwordx4 v21, s[96:99], s39 offen lds
    s_add_u32 s39, s45, 102400
    s_add_u32 m0, s37, 10240
    s_nop 0
    buffer_load_dwordx4 v21, s[96:99], s39 offen lds
    s_add_u32 s39, s45, 104960
    s_add_u32 m0, s37, 11264
    s_nop 0
    buffer_load_dwordx4 v21, s[96:99], s39 offen lds
    s_add_u32 s39, s45, 122880
    s_add_u32 m0, s37, 12288
    s_nop 0
    buffer_load_dwordx4 v21, s[96:99], s39 offen lds
    s_add_u32 s39, s45, 125440
    s_add_u32 m0, s37, 13312
    s_nop 0
    buffer_load_dwordx4 v21, s[96:99], s39 offen lds
    s_add_u32 s39, s45, 143360
    s_add_u32 m0, s37, 14336
    s_nop 0
    buffer_load_dwordx4 v21, s[96:99], s39 offen lds
    s_add_u32 s39, s45, 145920
    s_add_u32 m0, s37, 15360
    s_nop 0
    buffer_load_dwordx4 v21, s[96:99], s39 offen lds
    ds_read_b64_tr_b16 a[0:1], v23 offset:16384
    ds_read_b64_tr_b16 a[2:3], v23 offset:17408
    ds_read_b64_tr_b16 a[4:5], v23 offset:20480
    ds_read_b64_tr_b16 a[6:7], v23 offset:21504
    ds_read_b64_tr_b16 a[8:9], v23 offset:16392
    ds_read_b64_tr_b16 a[10:11], v23 offset:17416
    ds_read_b64_tr_b16 a[12:13], v23 offset:20488
    ds_read_b64_tr_b16 a[14:15], v23 offset:21512
    ds_read_b64_tr_b16 a[80:81], v24 offset:16384
    ds_read_b64_tr_b16 a[82:83], v24 offset:17408
    ds_read_b64_tr_b16 a[84:85], v24 offset:20480
    ds_read_b64_tr_b16 a[86:87], v24 offset:21504
    ds_read_b64_tr_b16 a[88:89], v24 offset:16392
    ds_read_b64_tr_b16 a[90:91], v24 offset:17416
    ds_read_b64_tr_b16 a[92:93], v24 offset:20488
    ds_read_b64_tr_b16 a[94:95], v24 offset:21512
    s_waitcnt lgkmcnt(0)
    s_waitcnt vmcnt(16)
    s_barrier
    s_add_u32 s39, s44, 0
    s_add_u32 m0, s37, 16384
    s_nop 0
    buffer_load_dwordx4 v20, s[16:19], s39 offen lds
    s_add_u32 s39, s44, 65536
    s_add_u32 m0, s37, 17408
    s_nop 0
    buffer_load_dwordx4 v20, s[16:19], s39 offen lds
    s_add_u32 s39, s44, 131072
    s_add_u32 m0, s37, 18432
    s_nop 0
    buffer_load_dwordx4 v20, s[16:19], s39 offen lds
    s_add_u32 s39, s44, 196608
    s_add_u32 m0, s37, 19456
    s_nop 0
    buffer_load_dwordx4 v20, s[16:19], s39 offen lds
    s_add_u32 s39, s44, 262144
    s_add_u32 m0, s37, 20480
    s_nop 0
    buffer_load_dwordx4 v20, s[16:19], s39 offen lds
    s_add_u32 s39, s44, 327680
    s_add_u32 m0, s37, 21504
    s_nop 0
    buffer_load_dwordx4 v20, s[16:19], s39 offen lds
    s_add_u32 s39, s44, 393216
    s_add_u32 m0, s37, 22528
    s_nop 0
    buffer_load_dwordx4 v20, s[16:19], s39 offen lds
    s_add_u32 s39, s44, 458752
    s_add_u32 m0, s37, 23552
    s_nop 0
    buffer_load_dwordx4 v20, s[16:19], s39 offen lds
    ds_read_b64_tr_b16 a[128:129], v23 offset:24576
    ds_read_b64_tr_b16 a[130:131], v23 offset:25600
    ds_read_b64_tr_b16 a[132:133], v23 offset:28672
    ds_read_b64_tr_b16 a[134:135], v23 offset:29696
    ds_read_b64_tr_b16 a[136:137], v23 offset:24584
    ds_read_b64_tr_b16 a[138:139], v23 offset:25608
    ds_read_b64_tr_b16 a[140:141], v23 offset:28680
    ds_read_b64_tr_b16 a[142:143], v23 offset:29704
    ds_read_b64_tr_b16 a[160:161], v24 offset:24576
    ds_read_b64_tr_b16 a[162:163], v24 offset:25600
    ds_read_b64_tr_b16 a[164:165], v24 offset:28672
    ds_read_b64_tr_b16 a[166:167], v24 offset:29696
    ds_read_b64_tr_b16 a[168:169], v24 offset:24584
    ds_read_b64_tr_b16 a[170:171], v24 offset:25608
    ds_read_b64_tr_b16 a[172:173], v24 offset:28680
    ds_read_b64_tr_b16 a[174:175], v24 offset:29704
    s_waitcnt lgkmcnt(0)
    s_waitcnt vmcnt(16)
    s_barrier
    s_add_u32 s39, s40, 0
    s_add_u32 m0, s37, 24576
    s_nop 0
    buffer_load_dwordx4 v20, s[16:19], s39 offen lds
    s_add_u32 s39, s40, 65536
    s_add_u32 m0, s37, 25600
    s_nop 0
    buffer_load_dwordx4 v20, s[16:19], s39 offen lds
    s_add_u32 s39, s40, 131072
    s_add_u32 m0, s37, 26624
    s_nop 0
    buffer_load_dwordx4 v20, s[16:19], s39 offen lds
    s_add_u32 s39, s40, 196608
    s_add_u32 m0, s37, 27648
    s_nop 0
    buffer_load_dwordx4 v20, s[16:19], s39 offen lds
    s_add_u32 s39, s40, 262144
    s_add_u32 m0, s37, 28672
    s_nop 0
    buffer_load_dwordx4 v20, s[16:19], s39 offen lds
    s_add_u32 s39, s40, 327680
    s_add_u32 m0, s37, 29696
    s_nop 0
    buffer_load_dwordx4 v20, s[16:19], s39 offen lds
    s_add_u32 s39, s40, 393216
    s_add_u32 m0, s37, 30720
    s_nop 0
    buffer_load_dwordx4 v20, s[16:19], s39 offen lds
    s_add_u32 s39, s40, 458752
    s_add_u32 m0, s37, 31744
    s_nop 0
    buffer_load_dwordx4 v20, s[16:19], s39 offen lds
    ds_read_b64_tr_b16 a[176:177], v27 offset:0
    ds_read_b64_tr_b16 a[178:179], v27 offset:1024
    ds_read_b64_tr_b16 a[180:181], v27 offset:4096
    ds_read_b64_tr_b16 a[182:183], v27 offset:5120
    ds_read_b64_tr_b16 a[192:193], v27 offset:8
    ds_read_b64_tr_b16 a[194:195], v27 offset:1032
    ds_read_b64_tr_b16 a[196:197], v27 offset:4104
    ds_read_b64_tr_b16 a[198:199], v27 offset:5128
    ds_read_b64_tr_b16 a[208:209], v27 offset:16
    ds_read_b64_tr_b16 a[210:211], v27 offset:1040
    ds_read_b64_tr_b16 a[212:213], v27 offset:4112
    ds_read_b64_tr_b16 a[214:215], v27 offset:5136
    ds_read_b64_tr_b16 a[224:225], v27 offset:24
    ds_read_b64_tr_b16 a[226:227], v27 offset:1048
    ds_read_b64_tr_b16 a[228:229], v27 offset:4120
    ds_read_b64_tr_b16 a[230:231], v27 offset:5144
    s_waitcnt lgkmcnt(0)
    s_waitcnt vmcnt(16)
    s_barrier
    s_add_u32 s39, s42, 0
    s_add_u32 m0, s37, 0
    s_nop 0
    buffer_load_dwordx4 v20, s[20:23], s39 offen lds
    s_add_u32 s39, s42, 65536
    s_add_u32 m0, s37, 1024
    s_nop 0
    buffer_load_dwordx4 v20, s[20:23], s39 offen lds
    s_add_u32 s39, s42, 131072
    s_add_u32 m0, s37, 2048
    s_nop 0
    buffer_load_dwordx4 v20, s[20:23], s39 offen lds
    s_add_u32 s39, s42, 196608
    s_add_u32 m0, s37, 3072
    s_nop 0
    buffer_load_dwordx4 v20, s[20:23], s39 offen lds
    s_add_u32 s39, s42, 262144
    s_add_u32 m0, s37, 4096
    s_nop 0
    buffer_load_dwordx4 v20, s[20:23], s39 offen lds
    s_add_u32 s39, s42, 327680
    s_add_u32 m0, s37, 5120
    s_nop 0
    buffer_load_dwordx4 v20, s[20:23], s39 offen lds
    s_add_u32 s39, s42, 393216
    s_add_u32 m0, s37, 6144
    s_nop 0
    buffer_load_dwordx4 v20, s[20:23], s39 offen lds
    s_add_u32 s39, s42, 458752
    s_add_u32 m0, s37, 7168
    s_nop 0
    buffer_load_dwordx4 v20, s[20:23], s39 offen lds
    ds_read_b64_tr_b16 a[184:185], v27 offset:8192
    ds_read_b64_tr_b16 a[186:187], v27 offset:9216
    ds_read_b64_tr_b16 a[188:189], v27 offset:12288
    ds_read_b64_tr_b16 a[190:191], v27 offset:13312
    ds_read_b64_tr_b16 a[200:201], v27 offset:8200
    ds_read_b64_tr_b16 a[202:203], v27 offset:9224
    ds_read_b64_tr_b16 a[204:205], v27 offset:12296
    ds_read_b64_tr_b16 a[206:207], v27 offset:13320
    ds_read_b64_tr_b16 a[216:217], v27 offset:8208
    ds_read_b64_tr_b16 a[218:219], v27 offset:9232
    ds_read_b64_tr_b16 a[220:221], v27 offset:12304
    ds_read_b64_tr_b16 a[222:223], v27 offset:13328
    ds_read_b64_tr_b16 a[232:233], v27 offset:8216
    ds_read_b64_tr_b16 a[234:235], v27 offset:9240
    ds_read_b64_tr_b16 a[236:237], v27 offset:12312
    ds_read_b64_tr_b16 a[238:239], v27 offset:13336
    s_waitcnt lgkmcnt(0)
    s_waitcnt vmcnt(16)
    s_barrier
    s_add_u32 s39, s44, 0
    s_add_u32 m0, s37, 8192
    s_nop 0
    buffer_load_dwordx4 v20, s[20:23], s39 offen lds
    s_add_u32 s39, s44, 65536
    s_add_u32 m0, s37, 9216
    s_nop 0
    buffer_load_dwordx4 v20, s[20:23], s39 offen lds
    s_add_u32 s39, s44, 131072
    s_add_u32 m0, s37, 10240
    s_nop 0
    buffer_load_dwordx4 v20, s[20:23], s39 offen lds
    s_add_u32 s39, s44, 196608
    s_add_u32 m0, s37, 11264
    s_nop 0
    buffer_load_dwordx4 v20, s[20:23], s39 offen lds
    s_add_u32 s39, s44, 262144
    s_add_u32 m0, s37, 12288
    s_nop 0
    buffer_load_dwordx4 v20, s[20:23], s39 offen lds
    s_add_u32 s39, s44, 327680
    s_add_u32 m0, s37, 13312
    s_nop 0
    buffer_load_dwordx4 v20, s[20:23], s39 offen lds
    s_add_u32 s39, s44, 393216
    s_add_u32 m0, s37, 14336
    s_nop 0
    buffer_load_dwordx4 v20, s[20:23], s39 offen lds
    s_add_u32 s39, s44, 458752
    s_add_u32 m0, s37, 15360
    s_nop 0
    buffer_load_dwordx4 v20, s[20:23], s39 offen lds
    ds_read_b64_tr_b16 v[136:137], v25 offset:16384
    ds_read_b64_tr_b16 v[138:139], v25 offset:17408
    ds_read_b64_tr_b16 v[140:141], v25 offset:20480
    ds_read_b64_tr_b16 v[142:143], v25 offset:21504
    ds_read_b64_tr_b16 v[32:33], v25 offset:16392
    ds_read_b64_tr_b16 v[34:35], v25 offset:17416
    ds_read_b64_tr_b16 v[36:37], v25 offset:20488
    ds_read_b64_tr_b16 v[38:39], v25 offset:21512
    ds_read_b64_tr_b16 a[32:33], v26 offset:16384
    ds_read_b64_tr_b16 a[34:35], v26 offset:17408
    ds_read_b64_tr_b16 a[36:37], v26 offset:20480
    ds_read_b64_tr_b16 a[38:39], v26 offset:21504
    ds_read_b64_tr_b16 a[40:41], v26 offset:16392
    ds_read_b64_tr_b16 a[42:43], v26 offset:17416
    ds_read_b64_tr_b16 a[44:45], v26 offset:20488
    ds_read_b64_tr_b16 a[46:47], v26 offset:21512
    s_waitcnt lgkmcnt(0)
    s_waitcnt vmcnt(16)
    s_barrier
    s_add_u32 s39, s40, 0
    s_add_u32 m0, s37, 16384
    s_nop 0
    buffer_load_dwordx4 v20, s[20:23], s39 offen lds
    s_add_u32 s39, s40, 65536
    s_add_u32 m0, s37, 17408
    s_nop 0
    buffer_load_dwordx4 v20, s[20:23], s39 offen lds
    s_add_u32 s39, s40, 131072
    s_add_u32 m0, s37, 18432
    s_nop 0
    buffer_load_dwordx4 v20, s[20:23], s39 offen lds
    s_add_u32 s39, s40, 196608
    s_add_u32 m0, s37, 19456
    s_nop 0
    buffer_load_dwordx4 v20, s[20:23], s39 offen lds
    s_add_u32 s39, s40, 262144
    s_add_u32 m0, s37, 20480
    s_nop 0
    buffer_load_dwordx4 v20, s[20:23], s39 offen lds
    s_add_u32 s39, s40, 327680
    s_add_u32 m0, s37, 21504
    s_nop 0
    buffer_load_dwordx4 v20, s[20:23], s39 offen lds
    s_add_u32 s39, s40, 393216
    s_add_u32 m0, s37, 22528
    s_nop 0
    buffer_load_dwordx4 v20, s[20:23], s39 offen lds
    s_add_u32 s39, s40, 458752
    s_add_u32 m0, s37, 23552
    s_nop 0
    buffer_load_dwordx4 v20, s[20:23], s39 offen lds
    ds_write_b128 v8, v[32:35] offset:32768
    ds_write_b128 v8, v[36:39] offset:33792
    ds_read_b64_tr_b16 v[40:41], v23 offset:24576
    ds_read_b64_tr_b16 v[42:43], v23 offset:25600
    ds_read_b64_tr_b16 v[44:45], v23 offset:28672
    ds_read_b64_tr_b16 v[46:47], v23 offset:29696
    ds_read_b64_tr_b16 v[48:49], v23 offset:24584
    ds_read_b64_tr_b16 v[50:51], v23 offset:25608
    ds_read_b64_tr_b16 v[52:53], v23 offset:28680
    ds_read_b64_tr_b16 v[54:55], v23 offset:29704
    ds_read_b64_tr_b16 v[160:161], v24 offset:24576
    ds_read_b64_tr_b16 v[162:163], v24 offset:25600
    ds_read_b64_tr_b16 v[164:165], v24 offset:28672
    ds_read_b64_tr_b16 v[166:167], v24 offset:29696
    ds_read_b64_tr_b16 v[168:169], v24 offset:24584
    ds_read_b64_tr_b16 v[170:171], v24 offset:25608
    ds_read_b64_tr_b16 v[172:173], v24 offset:28680
    ds_read_b64_tr_b16 v[174:175], v24 offset:29704
    s_waitcnt lgkmcnt(0)
    s_waitcnt vmcnt(16)
    s_barrier
    s_add_u32 s39, s43, 0
    s_add_u32 m0, s37, 24576
    s_nop 0
    buffer_load_dwordx4 v20, s[16:19], s39 offen lds
    s_add_u32 s39, s43, 65536
    s_add_u32 m0, s37, 25600
    s_nop 0
    buffer_load_dwordx4 v20, s[16:19], s39 offen lds
    s_add_u32 s39, s43, 131072
    s_add_u32 m0, s37, 26624
    s_nop 0
    buffer_load_dwordx4 v20, s[16:19], s39 offen lds
    s_add_u32 s39, s43, 196608
    s_add_u32 m0, s37, 27648
    s_nop 0
    buffer_load_dwordx4 v20, s[16:19], s39 offen lds
    s_add_u32 s39, s43, 262144
    s_add_u32 m0, s37, 28672
    s_nop 0
    buffer_load_dwordx4 v20, s[16:19], s39 offen lds
    s_add_u32 s39, s43, 327680
    s_add_u32 m0, s37, 29696
    s_nop 0
    buffer_load_dwordx4 v20, s[16:19], s39 offen lds
    s_add_u32 s39, s43, 393216
    s_add_u32 m0, s37, 30720
    s_nop 0
    buffer_load_dwordx4 v20, s[16:19], s39 offen lds
    s_add_u32 s39, s43, 458752
    s_add_u32 m0, s37, 31744
    s_nop 0
    buffer_load_dwordx4 v20, s[16:19], s39 offen lds
    ds_write_b128 v8, v[40:43] offset:34816
    ds_write_b128 v8, v[44:47] offset:35840
    ds_read_b64_tr_b16 v[56:57], v23 offset:0
    ds_read_b64_tr_b16 v[58:59], v23 offset:1024
    ds_read_b64_tr_b16 v[60:61], v23 offset:4096
    ds_read_b64_tr_b16 v[62:63], v23 offset:5120
    ds_read_b64_tr_b16 v[64:65], v23 offset:8
    ds_read_b64_tr_b16 v[66:67], v23 offset:1032
    ds_read_b64_tr_b16 v[68:69], v23 offset:4104
    ds_read_b64_tr_b16 v[70:71], v23 offset:5128
    ds_read_b64_tr_b16 a[96:97], v24 offset:0
    ds_read_b64_tr_b16 a[98:99], v24 offset:1024
    ds_read_b64_tr_b16 a[100:101], v24 offset:4096
    ds_read_b64_tr_b16 a[102:103], v24 offset:5120
    ds_read_b64_tr_b16 a[104:105], v24 offset:8
    ds_read_b64_tr_b16 a[106:107], v24 offset:1032
    ds_read_b64_tr_b16 a[108:109], v24 offset:4104
    ds_read_b64_tr_b16 a[110:111], v24 offset:5128
    s_waitcnt lgkmcnt(0)
    s_waitcnt vmcnt(16)
    s_barrier
    s_add_u32 s39, s41, 0
    s_add_u32 m0, s37, 0
    s_nop 0
    buffer_load_dwordx4 v20, s[20:23], s39 offen lds
    s_add_u32 s39, s41, 65536
    s_add_u32 m0, s37, 1024
    s_nop 0
    buffer_load_dwordx4 v20, s[20:23], s39 offen lds
    s_add_u32 s39, s41, 131072
    s_add_u32 m0, s37, 2048
    s_nop 0
    buffer_load_dwordx4 v20, s[20:23], s39 offen lds
    s_add_u32 s39, s41, 196608
    s_add_u32 m0, s37, 3072
    s_nop 0
    buffer_load_dwordx4 v20, s[20:23], s39 offen lds
    s_add_u32 s39, s41, 262144
    s_add_u32 m0, s37, 4096
    s_nop 0
    buffer_load_dwordx4 v20, s[20:23], s39 offen lds
    s_add_u32 s39, s41, 327680
    s_add_u32 m0, s37, 5120
    s_nop 0
    buffer_load_dwordx4 v20, s[20:23], s39 offen lds
    s_add_u32 s39, s41, 393216
    s_add_u32 m0, s37, 6144
    s_nop 0
    buffer_load_dwordx4 v20, s[20:23], s39 offen lds
    s_add_u32 s39, s41, 458752
    s_add_u32 m0, s37, 7168
    s_nop 0
    buffer_load_dwordx4 v20, s[20:23], s39 offen lds
    s_load_dwordx4 s[92:95], s[88:89], 64
    s_load_dword s91, s[88:89], 80
    ds_read_b64_tr_b16 v[72:73], v25 offset:8192
    ds_read_b64_tr_b16 v[74:75], v25 offset:9216
    ds_read_b64_tr_b16 v[76:77], v25 offset:12288
    ds_read_b64_tr_b16 v[78:79], v25 offset:13312
    ds_read_b64_tr_b16 v[80:81], v25 offset:8200
    ds_read_b64_tr_b16 v[82:83], v25 offset:9224
    ds_read_b64_tr_b16 v[84:85], v25 offset:12296
    ds_read_b64_tr_b16 v[86:87], v25 offset:13320
    ds_read_b64_tr_b16 a[48:49], v26 offset:8192
    ds_read_b64_tr_b16 a[50:51], v26 offset:9216
    ds_read_b64_tr_b16 a[52:53], v26 offset:12288
    ds_read_b64_tr_b16 a[54:55], v26 offset:13312
    ds_read_b64_tr_b16 a[56:57], v26 offset:8200
    ds_read_b64_tr_b16 a[58:59], v26 offset:9224
    ds_read_b64_tr_b16 a[60:61], v26 offset:12296
    ds_read_b64_tr_b16 a[62:63], v26 offset:13320
    s_waitcnt lgkmcnt(0)
    s_waitcnt vmcnt(16)
    s_barrier
    v_lshlrev_b32 v17, 1, v0
    s_add_u32 s34, s101, 163840
    s_mov_b64 exec, s[56:57]
    buffer_load_dword v16, v17, s[8:11], s101 offen
    buffer_load_dword v16, v17, s[8:11], s34 offen
    s_lshl_b32 s34, s3, 6
    s_add_u32 s34, s34, s5
    s_lshl_b32 s34, s34, 7
    s_add_u32 s34, s34, s29
    s_mov_b64 exec, 3
    v_lshlrev_b32 v18, 8, v0
    buffer_load_dword v16, v18, s[8:11], s34 offen
    s_mov_b64 exec, -1
    s_cmp_eq_u32 s92, 1
    s_cselect_b32 s47, s93, 0
    s_cmp_lg_u64 s[94:95], 0
    s_cselect_b32 s47, s47, 0
    s_cmp_eq_u32 s91, 32
    s_cselect_b32 s47, s47, 0
    s_and_b32 s90, s94, 0xffff
    buffer_load_dword v31, v13, s[8:11], s52 offen sc1
    ds_write_b128 v8, v[48:51] offset:8192
    ds_write_b128 v8, v[52:55] offset:9216
    ds_write_b128 v8, v[56:59] offset:10240
    ds_write_b128 v8, v[60:63] offset:11264
    ds_write_b128 v8, v[64:67] offset:12288
    ds_write_b128 v8, v[68:71] offset:13312
    ds_write_b128 v8, v[72:75] offset:14336
    ds_write_b128 v8, v[76:79] offset:15360
    ds_read_b64_tr_b16 v[88:89], v23 offset:16384
    ds_read_b64_tr_b16 v[90:91], v23 offset:17408
    ds_read_b64_tr_b16 v[92:93], v23 offset:20480
    ds_read_b64_tr_b16 v[94:95], v23 offset:21504
    ds_read_b64_tr_b16 v[112:113], v23 offset:16392
    ds_read_b64_tr_b16 v[114:115], v23 offset:17416
    ds_read_b64_tr_b16 v[116:117], v23 offset:20488
    ds_read_b64_tr_b16 v[118:119], v23 offset:21512
    ds_read_b64_tr_b16 v[32:33], v24 offset:16384
    ds_read_b64_tr_b16 v[34:35], v24 offset:17408
    ds_read_b64_tr_b16 v[36:37], v24 offset:20480
    ds_read_b64_tr_b16 v[38:39], v24 offset:21504
    ds_read_b64_tr_b16 v[40:41], v24 offset:16392
    ds_read_b64_tr_b16 v[42:43], v24 offset:17416
    ds_read_b64_tr_b16 v[44:45], v24 offset:20488
    ds_read_b64_tr_b16 v[46:47], v24 offset:21512
    s_waitcnt lgkmcnt(0)
    s_memtime s[38:39]
    s_memrealtime s[64:65]
    s_nop 0
    s_memrealtime s[66:67]
    s_nop 0
    s_memrealtime s[68:69]
    s_nop 0
    s_memrealtime s[70:71]
    s_nop 0
    s_memrealtime s[72:73]
    s_nop 0
    s_memrealtime s[74:75]
    s_nop 0
    s_memrealtime s[76:77]
    s_nop 0
    s_memrealtime s[78:79]
    s_nop 0
    s_memrealtime s[80:81]
    s_nop 0
    s_memrealtime s[82:83]
    s_nop 0
    s_memrealtime s[84:85]
    s_nop 0
    s_waitcnt lgkmcnt(0)
    s_add_u32 s48, s64, s66
    s_add_u32 s48, s48, s68
    s_add_u32 s48, s48, s70
    s_add_u32 s48, s48, s72
    s_add_u32 s48, s48, s74
    s_add_u32 s48, s48, s76
    s_add_u32 s48, s48, s78
    s_add_u32 s48, s48, s80
    s_add_u32 s48, s48, s82
    s_add_u32 s48, s48, s84
    s_lshl_b32 s48, s48, 1
    s_sub_u32 s48, s48, s38
    s_waitcnt vmcnt(12)
    s_barrier
    ds_write_b128 v8, v[80:83] offset:16384
    ds_write_b128 v8, v[84:87] offset:17408
    ds_write_b128 v8, v[88:91] offset:18432
    ds_write_b128 v8, v[92:95] offset:19456
    ds_write_b128 v8, v[32:35] offset:20480
    ds_write_b128 v8, v[36:39] offset:21504
    ds_write_b128 v8, v[40:43] offset:22528
    ds_write_b128 v8, v[44:47] offset:23552
    ds_read_b64_tr_b16 v[48:49], v23 offset:24576
    ds_read_b64_tr_b16 v[50:51], v23 offset:25600
    ds_read_b64_tr_b16 v[52:53], v23 offset:28672
    ds_read_b64_tr_b16 v[54:55], v23 offset:29696
    ds_read_b64_tr_b16 v[56:57], v23 offset:24584
    ds_read_b64_tr_b16 v[58:59], v23 offset:25608
    ds_read_b64_tr_b16 v[60:61], v23 offset:28680
    ds_read_b64_tr_b16 v[62:63], v23 offset:29704
    ds_read_b64_tr_b16 v[64:65], v24 offset:24576
    ds_read_b64_tr_b16 v[66:67], v24 offset:25600
    ds_read_b64_tr_b16 v[68:69], v24 offset:28672
    ds_read_b64_tr_b16 v[70:71], v24 offset:29696
    ds_read_b64_tr_b16 v[72:73], v24 offset:24584
    ds_read_b64_tr_b16 v[74:75], v24 offset:25608
    ds_read_b64_tr_b16 v[76:77], v24 offset:28680
    ds_read_b64_tr_b16 v[78:79], v24 offset:29704
    s_waitcnt lgkmcnt(0)
    s_waitcnt vmcnt(4)
    s_lshl_b32 s33, s5, 1
    s_add_u32 s33, s33, s4
    s_lshl_b32 s33, s33, 2
    s_add_u32 s33, s33, 97925120
    s_cmp_eq_u32 s3, 3
    s_cselect_b32 s36, s33, 268435456
    s_waitcnt vmcnt(0)
    v_cmp_ge_u32 vcc, 1, v31
    s_and_b32 s39, vcc_lo, 0xfff
    s_cselect_b32 s47, 0, s47
    s_cmp_eq_u32 s47, 0
    s_cbranch_scc1 na_recurrent_scan__memory_aug_recurrent_mem_tr__dense_activation_mish__prompt_kernel_11
    s_memtime s[38:39]
    s_waitcnt lgkmcnt(0)
    s_add_u32 s38, s38, s48
    s_add_u32 s38, s38, 1500
    s_or_b32 s38, s38, 1
    v_mov_b32 v30, s38
    buffer_store_dword v30, off, s[8:11], s36 sc1
    s_and_b32 s39, s36, -256
    v_lshrrev_b32 v19, 2, v0
    buffer_load_dword v31, v19, s[8:11], s39 offen sc1
    s_add_u32 m0, s35, 8192
    v_lshlrev_b32 v17, 1, v0
    buffer_load_dword v17, s[8:11], s54 offen sc1 lds
    s_mov_b32 m0, s51
    s_nop 0
    buffer_load_dwordx4 v0, s[8:11], s53 offen offset:0 sc1 lds
    buffer_load_dwordx4 v0, s[8:11], s53 offen offset:1024 sc1 lds
na_recurrent_scan__memory_aug_recurrent_mem_tr__dense_activation_mish__prompt_kernel_11:
    s_barrier
    ds_write_b128 v8, v[48:51] offset:24576
    ds_write_b128 v8, v[52:55] offset:25600
    ds_write_b128 v8, v[56:59] offset:26624
    ds_write_b128 v8, v[60:63] offset:27648
    ds_write_b128 v8, v[64:67] offset:28672
    ds_write_b128 v8, v[68:71] offset:29696
    ds_write_b128 v8, v[72:75] offset:30720
    ds_write_b128 v8, v[76:79] offset:31744
    ds_read_b64_tr_b16 v[80:81], v23 offset:0
    ds_read_b64_tr_b16 v[82:83], v23 offset:1024
    ds_read_b64_tr_b16 v[84:85], v23 offset:4096
    ds_read_b64_tr_b16 v[86:87], v23 offset:5120
    ds_read_b64_tr_b16 v[88:89], v23 offset:8
    ds_read_b64_tr_b16 v[90:91], v23 offset:1032
    ds_read_b64_tr_b16 v[92:93], v23 offset:4104
    ds_read_b64_tr_b16 v[94:95], v23 offset:5128
    ds_read_b64_tr_b16 v[32:33], v24 offset:0
    ds_read_b64_tr_b16 v[34:35], v24 offset:1024
    ds_read_b64_tr_b16 v[36:37], v24 offset:4096
    ds_read_b64_tr_b16 v[38:39], v24 offset:5120
    ds_read_b64_tr_b16 v[40:41], v24 offset:8
    ds_read_b64_tr_b16 v[42:43], v24 offset:1032
    ds_read_b64_tr_b16 v[44:45], v24 offset:4104
    ds_read_b64_tr_b16 v[46:47], v24 offset:5128
    s_waitcnt lgkmcnt(0)
    s_barrier
    ds_write_b128 v8, v[80:83] offset:0
    ds_write_b128 v8, v[84:87] offset:1024
    ds_write_b128 v8, v[88:91] offset:2048
    ds_write_b128 v8, v[92:95] offset:3072
    ds_write_b128 v8, v[32:35] offset:4096
    ds_write_b128 v8, v[36:39] offset:5120
    ds_write_b128 v8, v[40:43] offset:6144
    ds_write_b128 v8, v[44:47] offset:7168
    s_waitcnt lgkmcnt(0)
    s_mov_b32 s44, 0
    s_mov_b32 s19, 1
    s_cmp_lg_u32 s47, 0
    s_cbranch_scc1 twok_recurrent_scan__memory_aug_recurrent_mem_tr__dense_activation_mish__prompt_kernel_13
tw_recurrent_scan__memory_aug_recurrent_mem_tr__dense_activation_mish__prompt_kernel_12:
    buffer_load_dwordx4 v[24:27], off, s[24:27], 0 offset:64 sc1
    buffer_load_dword v28, off, s[24:27], 0 offset:80 sc1
    s_waitcnt vmcnt(0)
    v_readfirstlane_b32 s92, v24
    v_readfirstlane_b32 s93, v25
    v_readfirstlane_b32 s94, v26
    v_readfirstlane_b32 s95, v27
    v_readfirstlane_b32 s91, v28
    s_cmp_eq_u32 s92, 1
    s_cselect_b32 s47, s93, 0
    s_cmp_lg_u64 s[94:95], 0
    s_cselect_b32 s47, s47, 0
    s_cmp_eq_u32 s91, 32
    s_cselect_b32 s47, s47, 0
    s_and_b32 s90, s94, 0xffff
    s_add_u32 s44, s44, 1
    s_cmp_gt_u32 s44, 100000
    s_cbranch_scc1 last_recurrent_scan__memory_aug_recurrent_mem_tr__dense_activation_mish__prompt_kernel_10
    s_sleep 2
    s_cmp_eq_u32 s47, 0
    s_cbranch_scc1 tw_recurrent_scan__memory_aug_recurrent_mem_tr__dense_activation_mish__prompt_kernel_12
kvs_recurrent_scan__memory_aug_recurrent_mem_tr__dense_activation_mish__prompt_kernel_15:
    buffer_load_dword v14, v13, s[8:11], s52 offen sc1
    s_waitcnt vmcnt(0)
    v_cmp_ge_u32 vcc, s19, v14
    s_and_b32 s39, vcc_lo, 0xfff
    s_cbranch_scc0 kok_recurrent_scan__memory_aug_recurrent_mem_tr__dense_activation_mish__prompt_kernel_14
    s_add_u32 s44, s44, 1
    s_cmp_gt_u32 s44, 100000
    s_cbranch_scc1 last_recurrent_scan__memory_aug_recurrent_mem_tr__dense_activation_mish__prompt_kernel_10
    s_sleep 16
    s_branch kvs_recurrent_scan__memory_aug_recurrent_mem_tr__dense_activation_mish__prompt_kernel_15
kok_recurrent_scan__memory_aug_recurrent_mem_tr__dense_activation_mish__prompt_kernel_14:
    s_memtime s[38:39]
    s_waitcnt lgkmcnt(0)
    s_add_u32 s38, s38, s48
    s_add_u32 s38, s38, 1300
    s_or_b32 s38, s38, 1
    v_mov_b32 v30, s38
    buffer_store_dword v30, off, s[8:11], s36 sc1
    s_and_b32 s39, s36, -256
    v_lshrrev_b32 v19, 2, v0
    buffer_load_dword v31, v19, s[8:11], s39 offen sc1
    s_add_u32 m0, s35, 8192
    v_lshlrev_b32 v17, 1, v0
    buffer_load_dword v17, s[8:11], s54 offen sc1 lds
    s_mov_b32 m0, s51
    s_nop 0
    buffer_load_dwordx4 v0, s[8:11], s53 offen offset:0 sc1 lds
    buffer_load_dwordx4 v0, s[8:11], s53 offen offset:1024 sc1 lds
twok_recurrent_scan__memory_aug_recurrent_mem_tr__dense_activation_mish__prompt_kernel_13:
    s_and_b32 s39, s47, 1
    s_lshl_b32 s39, s39, 13
    s_add_u32 s30, s30, s39
    s_add_u32 s31, s31, s39
    s_mul_i32 s39, s5, 2097152
    s_lshl_b32 s95, s3, 10
    s_lshl_b32 s55, s4, 12
    s_lshl_b32 s38, s3, 9
    s_add_u32 s55, s55, s38
    s_add_u32 s55, s55, s39
    s_add_u32 s55, s55, 6283264
    s_add_u32 s15, s39, 4235264
    s_mov_b32 s56, 0x05050505
    s_mov_b32 s57, 0x05050505
    s_mov_b32 s58, 0x0a0a0a0a
    s_mov_b32 s59, 0x0a0a0a0a
    s_mov_b32 s60, 0x50505050
    s_mov_b32 s61, 0x50505050
    s_mov_b32 s62, 0xa0a0a0a0
    s_mov_b32 s63, 0xa0a0a0a0
    s_mov_b32 s33, 0
    s_mov_b32 s43, 0
    s_mov_b32 s44, 0
    s_mov_b32 s45, 0
    s_mov_b32 s46, 0
    s_mov_b32 s49, 0
    s_lshl_b32 s50, s5, 6
    s_lshl_b32 s39, s4, 2
    s_add_u32 s50, s50, s39
    s_add_u32 s50, s50, 97920000
    s_cmp_eq_u32 s3, 3
    s_cselect_b32 s50, s50, 268435456
    s_cmp_lt_u32 s3, 2
    s_cselect_b32 s15, s15, s52
    s_cselect_b32 s21, 32768, 0
    s_cselect_b32 s93, 5, 0
    s_cselect_b32 s94, 0, 1
    s_lshl_b32 s20, s28, 8
    s_cmp_lt_u32 s28, 20
    s_cselect_b32 s20, s20, 268435456
    s_mov_b32 s14, 0x3e0293ee
    s_mov_b32 s16, 268435456
    s_mov_b32 s17, 0
    s_cmp_eq_u32 s4, 0
    s_cselect_b32 s92, -1, 0
    s_add_u32 s99, s30, 7168
    s_and_b32 s91, s5, 3
    s_lshl_b32 s91, s91, 8
    s_add_u32 s91, s91, s99
    s_cmp_eq_u32 s3, 3
    s_cselect_b32 s98, s91, s16
    s_add_u32 s91, s98, 15616
    s_cmp_lt_u32 s5, 4
    s_cselect_b32 s91, s91, s16
    s_cmp_eq_u32 s28, 96
    s_cselect_b32 s16, -1024, s16
    s_add_u32 s13, s32, s30
    s_add_u32 s13, s13, 16384
    s_add_u32 s12, s13, s16
    s_cmp_lt_u32 s28, 80
    s_cselect_b32 s13, s13, 268435456
    s_mov_b32 s35, s29
    s_add_u32 s36, s35, 4096
    s_mov_b32 s40, s31
    s_add_u32 s41, s40, 4096
    s_add_u32 s53, s53, 32768
    s_mul_i32 s26, s3, -24576
    s_add_u32 s26, s26, 131072
    s_mov_b32 s27, 0
    s_mov_b32 s22, 0
    s_movk_i32 s24, 1600
    s_mov_b32 s19, 1
    s_cmp_eq_u32 s3, 3
    s_movk_i32 s37, 590
    s_cselect_b32 s7, 700, s37
    s_add_u32 s37, s7, 0
    s_movk_i32 s6, 2440
    v_mov_b32 v92, -1
    v_mov_b32 v93, -1
    v_mov_b32 v94, -1
    v_mov_b32 v95, -1
    s_sub_u32 s38, s55, 32768
    buffer_store_dwordx2 v[92:93], v3, s[8:11], s38 offen sc1
    s_mov_b32 s25, s48
    v_mov_b32 v15, s25
    ds_write_b32 v13, v15 offset:14336
    s_waitcnt lgkmcnt(0)
    s_cmp_lg_u32 s90, 0x2020
    s_cbranch_scc1 slow_recurrent_scan__memory_aug_recurrent_mem_tr__dense_activation_mish__prompt_kernel_16
    s_lshl_b32 s39, s5, 5
    s_lshl_b32 s38, s4, 4
    s_add_u32 s39, s39, s38
    v_cmp_eq_u32 vcc, s39, v0
    s_waitcnt vmcnt(3)
    s_nop 0
    v_cndmask_b32 v41, v31, v30, vcc
    v_mov_b64 v[16:17], 0
    v_mov_b64 v[18:19], 0
    v_mov_b64 v[20:21], 0
    v_mov_b64 v[22:23], 0
    v_mov_b64 v[24:25], 0
    v_mov_b64 v[26:27], 0
    v_mov_b64 v[28:29], 0
    v_mov_b64 v[30:31], 0
    v_mov_b64 v[32:33], 0
    v_mov_b64 v[34:35], 0
    v_mov_b64 v[36:37], 0
    v_mov_b64 v[38:39], 0
    ds_read_b128 v[76:79], v8 offset:34816
    ds_read_b128 v[80:83], v8 offset:35840
    ds_read_b128 v[60:63], v8 offset:8192
    ds_read_b128 v[64:67], v8 offset:9216
    ds_read_b128 v[68:71], v8 offset:18432
    ds_read_b128 v[72:75], v8 offset:19456
    s_memtime s[96:97]
    s_waitcnt lgkmcnt(0)
    s_sub_u32 s97, s96, 1
    s_add_u32 s42, s97, s25
    s_sub_u32 s42, s42, 1000
    s_and_b32 s19, s33, 1
    s_mul_i32 s19, s19, 163840
    s_add_u32 s47, s19, s100
    s_add_u32 s48, s19, s101
    s_bfe_u32 s34, s33, 0x10001
    s_add_u32 s23, s47, s26
    s_xor_b32 s18, s35, 0x4000
    s_add_u32 s18, s18, s20
    v_lshlrev_b32 v14, s93, v13
    v_mov_b64 v[24:25], 0
    v_mov_b64 v[26:27], 0
    s_cmp_lg_u32 s3, 3
    s_cbranch_scc1 go_recurrent_scan__memory_aug_recurrent_mem_tr__dense_activation_mish__prompt_kernel_21
    v_lshrrev_b32 v40, 2, v0
    s_mov_b32 s39, 97925120
    s_branch st_recurrent_scan__memory_aug_recurrent_mem_tr__dense_activation_mish__prompt_kernel_20c
st_recurrent_scan__memory_aug_recurrent_mem_tr__dense_activation_mish__prompt_kernel_20:
    s_sleep 4
    buffer_load_dword v41, v40, s[8:11], s39 offen sc1
    s_add_u32 s44, s44, 1
    s_cmp_gt_u32 s44, 100000
    s_cbranch_scc1 last_recurrent_scan__memory_aug_recurrent_mem_tr__dense_activation_mish__prompt_kernel_10
    s_waitcnt vmcnt(0)
st_recurrent_scan__memory_aug_recurrent_mem_tr__dense_activation_mish__prompt_kernel_20c:
    v_cmp_eq_u32 vcc, 0, v41
    s_cbranch_vccnz st_recurrent_scan__memory_aug_recurrent_mem_tr__dense_activation_mish__prompt_kernel_20
    v_subrev_u32 v41, s42, v41
    s_nop 1
    v_max_i32_dpp v41, v41, v41 row_ror:1 row_mask:0xf bank_mask:0xf
    s_nop 1
    v_max_i32_dpp v41, v41, v41 row_ror:2 row_mask:0xf bank_mask:0xf
    s_nop 1
    v_max_i32_dpp v41, v41, v41 row_ror:4 row_mask:0xf bank_mask:0xf
    s_nop 1
    v_max_i32_dpp v41, v41, v41 row_ror:8 row_mask:0xf bank_mask:0xf
    s_nop 0
    v_readlane_b32 s0, v41, 0
    v_readlane_b32 s1, v41, 16
    v_readlane_b32 s18, v41, 32
    v_readlane_b32 s19, v41, 48
    s_max_i32 s0, s0, s1
    s_max_i32 s18, s18, s19
    s_max_i32 s0, s0, s18
    s_add_u32 s96, s0, s42
    s_add_u32 s0, s96, 2000
    s_not_b32 s0, s0
    v_mov_b32 v15, s0
    buffer_store_dword v15, off, s[8:11], s98
    s_sub_u32 s96, s96, s25
    s_memtime s[0:1]
    s_waitcnt lgkmcnt(0)
    s_sub_u32 s27, s96, s0
    s_cmpk_lt_u32 s27, 4000
    s_cselect_b32 s27, s27, 0
    .p2align 3
dl_recurrent_scan__memory_aug_recurrent_mem_tr__dense_activation_mish__prompt_kernel_22:
    s_sub_u32 s27, s27, 28
    s_cbranch_scc0 dl_recurrent_scan__memory_aug_recurrent_mem_tr__dense_activation_mish__prompt_kernel_22
go_recurrent_scan__memory_aug_recurrent_mem_tr__dense_activation_mish__prompt_kernel_21:
    s_sub_u32 s97, s96, 1
    s_add_u32 s42, s97, s25
    s_sub_u32 s42, s42, 1000
    s_mov_b32 s39, 268435456
    s_barrier
    s_branch entry_recurrent_scan__memory_aug_recurrent_mem_tr__dense_activation_mish__prompt_kernel_19
tloop_recurrent_scan__memory_aug_recurrent_mem_tr__dense_activation_mish__prompt_kernel_18:
    s_waitcnt vmcnt(2)
    ds_write_b32 v13, v44 offset:15360
    v_cmp_eq_u32 vcc, -1, v44
    s_waitcnt vmcnt(1)
    v_smfmac_f32_16x16x64_bf16 v[24:27], v[40:43], v[76:83], v1
    ds_write_b128 v9, v[40:43] offset:8192
    s_cbranch_vccnz cold_recurrent_scan__memory_aug_recurrent_mem_tr__dense_activation_mish__prompt_kernel_23
back_recurrent_scan__memory_aug_recurrent_mem_tr__dense_activation_mish__prompt_kernel_24:
    v_max3_u32 v15, v40, v41, v42
    v_smfmac_f32_16x16x64_bf16 v[28:31], v[40:43], v[60:67], v1
    s_waitcnt lgkmcnt(1)
    s_barrier
    ds_read_b128 v[48:51], v0 offset:15360
    buffer_load_dwordx4 v[52:55], v9, s[8:11], s40 offen sc1
    buffer_load_dword v56, v13, s[8:11], s41 offen sc1
    v_max3_u32 v15, v15, v43, v43
    v_smfmac_f32_16x16x64_bf16 v[32:35], v[40:43], v[68:75], v1
    ds_read_b128 v[76:79], v8 offset:32768
    ds_read_b128 v[80:83], v8 offset:33792
    v_cmp_eq_u32 vcc, -1, v15
    v_smfmac_f32_16x16x64_bf16 v[36:39], v[40:43], v[112:119], v1
    ds_read_b128 v[60:63], v8 offset:14336
    ds_read_b128 v[64:67], v8 offset:15360
    v_smfmac_f32_16x16x64_bf16 v[16:19], v[40:43], v[96:103], v1
    s_cbranch_vccnz cold_recurrent_scan__memory_aug_recurrent_mem_tr__dense_activation_mish__prompt_kernel_25
back_recurrent_scan__memory_aug_recurrent_mem_tr__dense_activation_mish__prompt_kernel_26:
    ds_read_b128 v[68:71], v8 offset:16384
    ds_read_b128 v[72:75], v8 offset:17408
    v_smfmac_f32_16x16x64_bf16 v[20:23], v[40:43], v[104:111], v1
    buffer_load_dwordx4 v[84:87], v0, s[8:11], s54 offen offset:0 sc1
    buffer_load_dwordx4 v[88:91], v0, s[8:11], s54 offen offset:1024 sc1
    s_waitcnt lgkmcnt(7)
    s_barrier
    s_waitcnt lgkmcnt(6)
    v_smfmac_f32_16x16x64_bf16 v[16:19], v[48:51], v[120:127], v1
    ds_read_b128 v[44:47], v10 offset:8192
    v_mov_b32 v3, v3
    v_smfmac_f32_16x16x64_bf16 v[20:23], v[48:51], v[128:135], v1
    buffer_load_dword v14, v14, s[8:11], s15 offen sc1
    ds_read_b32 v94, v95
    v_smfmac_f32_16x16x64_bf16 v[24:27], v[48:51], v[136:143], v1
    ds_read_b128 v[40:43], v11 offset:8192
    s_waitcnt lgkmcnt(7)
    v_smfmac_f32_16x16x64_bf16 v[28:31], v[48:51], v[76:83], v1
    ds_read_b128 v[76:79], v8 offset:20480
    s_waitcnt lgkmcnt(6)
    v_smfmac_f32_16x16x64_bf16 v[32:35], v[48:51], v[60:67], v1
    ds_read_b128 v[80:83], v8 offset:21504
    s_waitcnt lgkmcnt(5)
    v_smfmac_f32_16x16x64_bf16 v[36:39], v[48:51], v[68:75], v1
    ds_read_b128 v[60:63], v8 offset:22528
    s_waitcnt lgkmcnt(5)
    v_smfmac_f32_16x16x64_bf16 v[16:19], v[44:47], v[144:151], v1
    ds_read_b128 v[64:67], v8 offset:23552
    v_mov_b32 v3, v3
    v_smfmac_f32_16x16x64_bf16 v[20:23], v[44:47], v[152:159], v1
    ds_read_b128 v[48:51], v12 offset:8192
    v_mov_b32 v3, v3
    v_smfmac_f32_16x16x64_bf16 v[24:27], v[44:47], v[160:167], v1
    ds_read_b128 v[68:71], v8 offset:0
    v_mov_b32 v3, v3
    v_smfmac_f32_16x16x64_bf16 v[28:31], v[44:47], v[168:175], v1
    ds_read_b128 v[72:75], v8 offset:1024
    s_waitcnt lgkmcnt(5)
    v_smfmac_f32_16x16x64_bf16 v[32:35], v[44:47], v[76:83], v1
    ds_read_b128 v[76:79], v8 offset:2048
    s_waitcnt lgkmcnt(4)
    v_smfmac_f32_16x16x64_bf16 v[36:39], v[44:47], v[60:67], v1
    s_waitcnt lgkmcnt(3)
    s_barrier
    v_mov_b32 v3, v3
    v_smfmac_f32_16x16x64_bf16 v[16:19], v[40:43], v[176:183], v1
    ds_read_b128 v[80:83], v8 offset:3072
    v_readfirstlane_b32 s25, v94
    v_smfmac_f32_16x16x64_bf16 v[20:23], v[40:43], v[184:191], v1
    ds_read_b128 v[60:63], v8 offset:4096
    v_mov_b32 v3, v3
    v_smfmac_f32_16x16x64_bf16 v[24:27], v[40:43], v[192:199], v1
    ds_read_b128 v[64:67], v8 offset:5120
    v_mov_b32 v3, v3
    v_smfmac_f32_16x16x64_bf16 v[28:31], v[40:43], v[200:207], v1
    s_waitcnt lgkmcnt(4)
    v_mov_b32 v3, v3
    v_smfmac_f32_16x16x64_bf16 v[32:35], v[40:43], v[68:75], v1
    ds_read_b128 v[68:71], v8 offset:6144
    s_waitcnt lgkmcnt(3)
    v_smfmac_f32_16x16x64_bf16 v[36:39], v[40:43], v[76:83], v1
    s_waitcnt vmcnt(3)
    ds_write_b128 v9, v[52:55] offset:12288
    v_max3_u32 v15, v52, v53, v54
    v_smfmac_f32_16x16x64_bf16 v[16:19], v[48:51], v[208:215], v1
    ds_write_b32 v13, v56 offset:8192
    v_max3_u32 v15, v15, v55, v56
    v_smfmac_f32_16x16x64_bf16 v[20:23], v[48:51], v[216:223], v1
    ds_read_b128 v[72:75], v8 offset:7168
    v_cmp_eq_u32 vcc, -1, v15
    v_smfmac_f32_16x16x64_bf16 v[24:27], v[48:51], v[224:231], v1
    s_cbranch_vccnz cold_recurrent_scan__memory_aug_recurrent_mem_tr__dense_activation_mish__prompt_kernel_27
back_recurrent_scan__memory_aug_recurrent_mem_tr__dense_activation_mish__prompt_kernel_28:
    ds_read_b128 v[76:79], v8 offset:24576
    v_smfmac_f32_16x16x64_bf16 v[28:31], v[48:51], v[232:239], v1
    s_waitcnt lgkmcnt(2)
    s_barrier
    v_mov_b32 v3, v3
    v_smfmac_f32_16x16x64_bf16 v[32:35], v[48:51], v[60:67], v1
    ds_read_b128 v[56:59], v0 offset:8192
    s_waitcnt lgkmcnt(2)
    v_smfmac_f32_16x16x64_bf16 v[36:39], v[48:51], v[68:75], v1
    s_memtime s[96:97]
    ds_read_b128 v[44:47], v10 offset:12288
    v_smfmac_f32_16x16x64_bf16 v[24:27], v[52:55], a[0:7], v1
    buffer_store_dwordx2 v[92:93], v3, s[8:11], s55 offen sc1
    ds_read_b128 v[80:83], v8 offset:25600
    v_smfmac_f32_16x16x64_bf16 v[16:19], v[52:55], v[240:247], v1
    ds_read_b128 v[40:43], v11 offset:12288
    v_mov_b32 v3, v3
    v_smfmac_f32_16x16x64_bf16 v[28:31], v[52:55], a[8:15], v1
    s_add_u32 s96, s96, s25
    ds_read_b128 v[60:63], v8 offset:28672
    v_not_b32 v15, s96
    v_smfmac_f32_16x16x64_bf16 v[20:23], v[52:55], v[248:255], v1
    s_mov_b64 exec, 1
    buffer_atomic_umin v15, off, s[8:11], s98
    s_mov_b64 exec, -1
    s_waitcnt lgkmcnt(4)
    v_smfmac_f32_16x16x64_bf16 v[24:27], v[56:59], a[32:39], v1
    ds_read_b128 v[64:67], v8 offset:29696
    v_mov_b32 v15, s17
    v_smfmac_f32_16x16x64_bf16 v[16:19], v[56:59], a[16:23], v1
    buffer_store_dword v15, off, s[8:11], s50 sc1
    ds_read_b128 v[48:51], v12 offset:12288
    s_waitcnt lgkmcnt(5)
    v_smfmac_f32_16x16x64_bf16 v[24:27], v[44:47], a[80:87], v1
    ds_read_b128 v[68:71], v8 offset:26624
    v_mov_b32 v3, v3
    v_smfmac_f32_16x16x64_bf16 v[16:19], v[44:47], a[64:71], v1
    ds_read_b128 v[72:75], v8 offset:27648
    s_waitcnt lgkmcnt(6)
    s_waitcnt lgkmcnt(5)
    v_smfmac_f32_16x16x64_bf16 v[24:27], v[40:43], v[76:83], v1
    ds_read_b128 v[76:79], v8 offset:30720
    v_mov_b32 v15, -1
    v_smfmac_f32_16x16x64_bf16 v[16:19], v[40:43], a[112:119], v1
    buffer_store_dword v15, v13, s[8:11], s18 offen
    ds_read_b128 v[80:83], v8 offset:31744
    s_waitcnt lgkmcnt(5)
    s_waitcnt lgkmcnt(4)
    v_smfmac_f32_16x16x64_bf16 v[24:27], v[48:51], v[60:67], v1
    ds_read_b128 v[60:63], v8 offset:10240
    v_mov_b32 v3, v3
    v_smfmac_f32_16x16x64_bf16 v[16:19], v[48:51], a[144:151], v1
    s_waitcnt vmcnt(5)
    s_barrier
    v_mov_b32 v3, v3
    v_smfmac_f32_16x16x64_bf16 v[28:31], v[56:59], a[40:47], v1
    ds_read_b128 v[64:67], v8 offset:11264
    v_add_f32 v24, v24, v26
    v_smfmac_f32_16x16x64_bf16 v[28:31], v[44:47], a[88:95], v1
    ds_read_b128 v[92:95], v0 offset:4096
    s_waitcnt lgkmcnt(5)
    v_add_f32 v25, v25, v27
    v_smfmac_f32_16x16x64_bf16 v[28:31], v[40:43], v[68:75], v1
    ds_read_b128 v[68:71], v8 offset:12288
    s_waitcnt lgkmcnt(4)
    v_cvt_pk_bf16_f32 v26, v24, v25
    v_smfmac_f32_16x16x64_bf16 v[28:31], v[48:51], v[76:83], v1
    ds_read_b128 v[72:75], v8 offset:13312
    v_add_f32 v16, v16, v18
    v_smfmac_f32_16x16x64_bf16 v[20:23], v[56:59], a[24:31], v1
    ds_read_b128 v[76:79], v0 offset:0
    v_add_f32 v17, v17, v19
    v_smfmac_f32_16x16x64_bf16 v[20:23], v[44:47], a[72:79], v1
    ds_read_b128 v[80:83], v0 offset:2048
    v_cvt_pk_bf16_f32 v27, v16, v17
    v_smfmac_f32_16x16x64_bf16 v[20:23], v[40:43], a[120:127], v1
    ds_write_b64 v2, v[26:27] offset:8192
    v_add_f32 v28, v28, v30
    v_smfmac_f32_16x16x64_bf16 v[20:23], v[48:51], a[152:159], v1
    s_waitcnt lgkmcnt(6)
    v_add_f32 v29, v29, v31
    v_smfmac_f32_16x16x64_bf16 v[32:35], v[52:55], v[60:67], v1
    s_waitcnt lgkmcnt(3)
    v_cvt_pk_bf16_f32 v30, v28, v29
    v_smfmac_f32_16x16x64_bf16 v[36:39], v[52:55], v[68:75], v1
    v_add_f32 v20, v20, v22
    v_add_f32 v21, v21, v23
    v_cvt_pk_bf16_f32 v31, v20, v21
    ds_write_b64 v2, v[30:31] offset:8704
    v_smfmac_f32_16x16x64_bf16 v[32:35], v[56:59], a[48:55], v1
    ds_read_b128 v[52:55], v0 offset:6144
    v_mov_b32 v3, v3
    v_smfmac_f32_16x16x64_bf16 v[36:39], v[56:59], a[56:63], v1
    ds_read_b128 v[56:59], v0 offset:1024
    v_mov_b32 v3, v3
    v_smfmac_f32_16x16x64_bf16 v[32:35], v[44:47], a[96:103], v1
    v_mov_b32 v3, v3
    s_waitcnt lgkmcnt(2)
    s_barrier
    ds_read_b64_tr_b16 v[60:61], v3 offset:8192
    ds_read_b64_tr_b16 v[62:63], v3 offset:8704
    v_smfmac_f32_16x16x64_bf16 v[36:39], v[44:47], a[104:111], v1
    ds_read_b64_tr_b16 v[64:65], v3 offset:9216
    ds_read_b64_tr_b16 v[66:67], v3 offset:9728
    v_smfmac_f32_16x16x64_bf16 v[32:35], v[40:43], a[128:135], v1
    ds_read_b64_tr_b16 v[68:69], v3 offset:10240
    ds_read_b64_tr_b16 v[70:71], v3 offset:10752
    v_smfmac_f32_16x16x64_bf16 v[36:39], v[40:43], a[136:143], v1
    ds_read_b64_tr_b16 v[72:73], v3 offset:11264
    ds_read_b64_tr_b16 v[74:75], v3 offset:11776
    v_smfmac_f32_16x16x64_bf16 v[32:35], v[48:51], a[160:167], v1
    ds_read_b128 v[44:47], v0 offset:3072
    ds_read_b128 v[40:43], v0 offset:5120
    v_smfmac_f32_16x16x64_bf16 v[36:39], v[48:51], a[168:175], v1
    ds_read_b128 v[48:51], v0 offset:7168
    s_waitcnt lgkmcnt(9)
    v_mfma_f32_16x16x32_bf16 v[24:27], v[60:63], v[60:63], 0
    s_waitcnt lgkmcnt(7)
    s_movk_i32 s27, 0x1833
    v_mov_b32 v3, v3
    v_mfma_f32_16x16x32_bf16 v[24:27], v[64:67], v[64:67], v[24:27]
    s_waitcnt lgkmcnt(5)
    v_add_f32 v32, v32, v34
    v_add_f32 v33, v33, v35
    v_mfma_f32_16x16x32_bf16 v[24:27], v[68:71], v[68:71], v[24:27]
    s_waitcnt lgkmcnt(3)
    v_cvt_pk_bf16_f32 v30, v32, v33
    v_add_f32 v36, v36, v38
    v_mfma_f32_16x16x32_bf16 v[24:27], v[72:75], v[72:75], v[24:27]
    s_cmp_eq_u32 s33, 63
    v_add_f32 v37, v37, v39
    v_cvt_pk_bf16_f32 v31, v36, v37
    v_mfma_f32_16x16x32_bf16 v[16:19], v[76:79], v[60:63], 0
    s_cbranch_scc1 lastpub_recurrent_scan__memory_aug_recurrent_mem_tr__dense_activation_mish__prompt_kernel_17
    v_mov_b32 v3, v3
    v_mfma_f32_16x16x32_bf16 v[16:19], v[80:83], v[64:67], v[16:19]
    s_waitcnt lgkmcnt(0)
    v_mul_f32 v24, s14, v24
    v_mul_f32 v25, s14, v25
    v_mfma_f32_16x16x32_bf16 v[16:19], v[92:95], v[68:71], v[16:19]
    v_exp_f32 v24, v24
    v_mov_b32 v81, 0
    v_mfma_f32_16x16x32_bf16 v[16:19], v[52:55], v[72:75], v[16:19]
    v_exp_f32 v25, v25
    v_mov_b32 v82, 0
    v_mfma_f32_16x16x32_bf16 v[20:23], v[56:59], v[60:63], 0
    s_buffer_load_dword s1, s[8:11], s99 offset:256
    s_buffer_load_dword s0, s[8:11], s99 offset:0
    v_mov_b32 v92, 0x3f803f80
    v_mov_b32 v93, 0x3f803f80
    v_cvt_pk_bf16_f32 v80, v24, v25
    v_mfma_f32_16x16x32_bf16 v[20:23], v[44:47], v[64:67], v[20:23]
    s_buffer_load_dword s19, s[8:11], s99 offset:768
    s_buffer_load_dword s18, s[8:11], s99 offset:512
    v_mul_f32 v16, s14, v16
    v_mul_f32 v17, s14, v17
    v_cvt_pk_bf16_f32 v83, v24, v25
    v_mfma_f32_16x16x32_bf16 v[20:23], v[40:43], v[68:71], v[20:23]
    v_exp_f32 v16, v16
    v_mul_f32 v18, s14, v18
    v_mfma_f32_16x16x32_bf16 v[20:23], v[48:51], v[72:75], v[20:23]
    v_exp_f32 v17, v17
    v_mul_f32 v19, s14, v19
    v_mfma_f32_16x16x16_bf16 v[32:35], v[30:31], v[80:81], 0
    v_exp_f32 v18, v18
    v_exp_f32 v19, v19
    v_mfma_f32_16x16x16_bf16 v[36:39], v[30:31], v[82:83], 0
    v_mul_f32 v20, s14, v20
    v_mul_f32 v21, s14, v21
    v_exp_f32 v20, v20
    v_mfma_f32_16x16x16_bf16 v[24:27], v[80:81], v[92:93], 0
    v_mul_f32 v22, s14, v22
    v_mul_f32 v23, s14, v23
    v_exp_f32 v21, v21
    v_exp_f32 v22, v22
    v_exp_f32 v23, v23
    v_cvt_pk_bf16_f32 v76, v16, v17
    v_cvt_pk_bf16_f32 v77, v18, v19
    v_cvt_pk_bf16_f32 v78, v20, v21
    v_cvt_pk_bf16_f32 v79, v22, v23
    v_mov_b32 v94, 0x3f803f80
    v_mov_b32 v95, 0x3f803f80
    v_mfma_f32_16x16x32_bf16 v[32:35], v[84:87], v[76:79], v[32:35]
    v_lshrrev_b32 v20, 11, v5
    v_mov_b64 v[52:53], 0
    v_bfi_b32 v20, s27, v5, v20
    v_mfma_f32_16x16x32_bf16 v[36:39], v[88:91], v[76:79], v[36:39]
    s_barrier
    v_mov_b64 v[54:55], 0
    v_mov_b64 v[56:57], 0
    v_mov_b64 v[58:59], 0
    v_mfma_f32_16x16x32_bf16 v[24:27], v[76:79], v[92:95], v[24:27]
    v_cvt_pk_bf16_f32 v16, v32, v33
    v_cvt_pk_bf16_f32 v17, v34, v35
    v_mov_b64 v[44:45], 0
    v_mov_b64 v[46:47], 0
    v_cvt_pk_bf16_f32 v18, v36, v37
    v_cvt_pk_bf16_f32 v19, v38, v39
    ds_write_b128 v4, v[16:19] offset:12288
    buffer_load_dwordx4 v0, s[8:11], s53 offen offset:0 sc1 lds
    buffer_load_dwordx4 v0, s[8:11], s53 offen offset:1024 sc1 lds
    v_mov_b64 v[40:41], 0
    v_rcp_f32 v28, v26
    v_rcp_f32 v29, v27
    s_waitcnt lgkmcnt(0)
    s_barrier
    ds_read_b128 v[84:87], v0 offset:12288
    ds_read_b128 v[88:91], v0 offset:13312
    s_min_u32 s0, s0, s1
    s_min_u32 s18, s18, s19
    s_min_u32 s0, s0, s18
    s_not_b32 s0, s0
    s_sub_u32 s27, s0, s96
    s_add_u32 s96, s96, s6
    s_min_i32 s27, s27, s24
    s_max_i32 s27, s27, 0
    s_add_u32 s96, s96, s27
    s_waitcnt lgkmcnt(1)
    v_smfmac_f32_16x16x64_bf16 v[56:59], v[84:87], a[240:247], v1
    s_add_u32 s0, s96, s22
    v_and_b32 v15, s0, -2
    s_waitcnt lgkmcnt(0)
    v_max3_f32 v21, v26, v27, v28
    v_smfmac_f32_16x16x64_bf16 v[56:59], v[88:91], a[248:255], v1
    buffer_store_dword v15, off, s[8:11], s12 sc1
    s_sub_u32 s97, s96, s25
    v_max_f32 v21, v21, v29
    v_smfmac_f32_16x16x64_bf16 v[52:55], v[84:87], a[224:231], v1
    v_cmp_lt_f32 vcc, 0x5d800000, v21
    v_mov_b64 v[42:43], 0
    v_mov_b64 v[48:49], 0
    v_smfmac_f32_16x16x64_bf16 v[52:55], v[88:91], a[232:239], v1
    s_cbranch_vccnz gc_recurrent_scan__memory_aug_recurrent_mem_tr__dense_activation_mish__prompt_kernel_29
gb_recurrent_scan__memory_aug_recurrent_mem_tr__dense_activation_mish__prompt_kernel_30:
    s_sub_u32 s42, s96, 1000
    v_add_f32 v56, v56, v58
    v_smfmac_f32_16x16x64_bf16 v[40:43], v[84:87], a[176:183], v1
    s_sub_u32 s96, s97, s37
    s_add_u32 s33, s33, 1
    v_mov_b64 v[50:51], 0
    v_smfmac_f32_16x16x64_bf16 v[40:43], v[88:91], a[184:191], v1
    s_add_u32 s40, s40, 16384
    s_add_u32 s41, s41, 16384
    v_add_f32 v57, v57, v59
    v_smfmac_f32_16x16x64_bf16 v[44:47], v[84:87], a[192:199], v1
    s_add_u32 s35, s35, 8192
    s_bitset0_b32 s35, 15
    v_fma_mixlo_f16 v56, v56, v28, 0
    v_smfmac_f32_16x16x64_bf16 v[44:47], v[88:91], a[200:207], v1
    v_fma_mixhi_f16 v56, v57, v29, 0
    v_bfi_b32 v56, 1, s34, v56
    v_smfmac_f32_16x16x64_bf16 v[48:51], v[84:87], a[208:215], v1
    buffer_store_dword v56, v20, s[8:11], s23 offen
    v_add_f32 v52, v52, v54
    v_add_f32 v53, v53, v55
    v_smfmac_f32_16x16x64_bf16 v[48:51], v[88:91], a[216:223], v1
    v_fma_mixlo_f16 v19, v52, v28, 0
    v_fma_mixhi_f16 v19, v53, v29, 0
    v_add_f32 v40, v40, v42
    v_add_f32 v41, v41, v43
    v_fma_mixlo_f16 v16, v40, v28, 0
    v_fma_mixhi_f16 v16, v41, v29, 0
    v_bfi_b32 v16, 1, s34, v16
    v_add_f32 v44, v44, v46
    v_add_f32 v45, v45, v47
    v_fma_mixlo_f16 v17, v44, v28, 0
    v_fma_mixhi_f16 v17, v45, v29, 0
    v_add_f32 v48, v48, v50
    v_add_f32 v49, v49, v51
    v_fma_mixlo_f16 v18, v48, v28, 0
    v_fma_mixhi_f16 v18, v49, v29, 0
    buffer_store_dwordx4 v[16:19], v5, s[8:11], s47 offen
    s_memtime s[0:1]
    v_cndmask_b32 v24, 0, v6, s[56:57]
    v_cndmask_b32 v25, 0, v6, s[58:59]
    v_cndmask_b32 v26, 0, v6, s[60:61]
    v_cndmask_b32 v27, 0, v6, s[62:63]
    s_add_u32 s38, s35, s32
    s_add_u32 s36, s35, 4096
    s_mov_b32 s39, s13
    s_waitcnt lgkmcnt(0)
    s_sub_u32 s27, s96, s0
    s_cmpk_lt_u32 s27, 4000
    s_cselect_b32 s27, s27, 0
    s_cmp_ge_u32 s28, 80
    s_cbranch_scc1 nored_recurrent_scan__memory_aug_recurrent_mem_tr__dense_activation_mish__prompt_kernel_31
    .p2align 3
dl_recurrent_scan__memory_aug_recurrent_mem_tr__dense_activation_mish__prompt_kernel_32:
    s_sub_u32 s27, s27, 28
    s_cbranch_scc0 dl_recurrent_scan__memory_aug_recurrent_mem_tr__dense_activation_mish__prompt_kernel_32
    buffer_load_dwordx4 v[48:51], v0, s[8:11], s48 offen sc1
    buffer_load_dwordx4 v[52:55], v0, s[8:11], s48 offen offset:1024 sc1
    v_add_u32 v15, s95, v3
    v_mov_b64 v[92:93], v[30:31]
    s_cmp_eq_u32 s92, 0
    s_cbranch_scc1 fmsk_recurrent_scan__memory_aug_recurrent_mem_tr__dense_activation_mish__prompt_kernel_33
    ds_read_b64_tr_b16 v[92:93], v15 offset:8192
    ds_read_b64_tr_b16 v[94:95], v15 offset:8704
fmsk_recurrent_scan__memory_aug_recurrent_mem_tr__dense_activation_mish__prompt_kernel_33:
    ds_read_b128 v[76:79], v8 offset:34816
    ds_read_b128 v[80:83], v8 offset:35840
    ds_read_b128 v[60:63], v8 offset:8192
    ds_read_b128 v[64:67], v8 offset:9216
    ds_read_b128 v[68:71], v8 offset:18432
    ds_read_b128 v[72:75], v8 offset:19456
    v_mov_b64 v[16:17], 0
    v_mov_b64 v[18:19], 0
    v_mov_b64 v[20:21], 0
    v_mov_b64 v[22:23], 0
    v_mov_b64 v[28:29], 0
    v_mov_b64 v[30:31], 0
    s_add_u32 s13, s13, 16384
    s_add_u32 s12, s12, 16384
    s_add_u32 s53, s53, 32768
    s_cmp_eq_u32 s33, 1
    s_cselect_b32 s17, 2097152, 0
    s_sub_u32 s55, s55, s17
    s_sub_u32 s17, s33, 1
    s_add_u32 s54, s54, 32768
    s_add_u32 s55, s55, 32768
    s_add_u32 s15, s15, s21
    s_add_u32 s98, s98, 16384
    s_add_u32 s99, s99, 16384
    s_sub_u32 s6, s6, 100
    s_max_u32 s6, s6, 2440
    s_sub_u32 s37, s37, 100
    s_max_u32 s37, s37, s7
rl_recurrent_scan__memory_aug_recurrent_mem_tr__dense_activation_mish__prompt_kernel_34:
    s_waitcnt vmcnt(1)
    v_mfma_f32_16x16x32_f16 v[40:43], v[24:27], v[48:51], 0
    v_bitop3_b32 v56, v49, v50, s34 bitop3:0x7e
    s_waitcnt vmcnt(0)
    v_mfma_f32_16x16x32_f16 v[40:43], v[24:27], v[52:55], v[40:43]
    v_bitop3_b32 v58, v51, v53, s34 bitop3:0x7e
    v_bitop3_b32 v59, v54, v55, s34 bitop3:0x7e
    v_bitop3_b32 v44, v48, v52, s34 bitop3:0x7e
    v_or3_b32 v56, v56, v58, v59
    v_and_or_b32 v56, v56, s94, v44
    v_and_b32 v56, 1, v56
    v_cmp_ne_u32 vcc, 0, v56
    s_nop 0
    v_add_f32_dpp v40, v40, v40 row_ror:4 row_mask:0xf bank_mask:0xf
    v_add_f32_dpp v41, v41, v41 row_ror:4 row_mask:0xf bank_mask:0xf
    s_cbranch_vccnz rc_recurrent_scan__memory_aug_recurrent_mem_tr__dense_activation_mish__prompt_kernel_35
    v_add_f32_dpp v40, v40, v40 row_ror:8 row_mask:0xf bank_mask:0xf
    v_add_f32_dpp v41, v41, v41 row_ror:8 row_mask:0xf bank_mask:0xf
    v_cvt_pk_bf16_f32 v40, v40, v41
    v_min_u32 v45, 0xfffffffe, v40
    buffer_store_dword v45, v7, s[8:11], s38 offen
post_recurrent_scan__memory_aug_recurrent_mem_tr__dense_activation_mish__prompt_kernel_36:
    s_memtime s[0:1]
    s_waitcnt lgkmcnt(0)
    s_sub_u32 s27, s97, s0
    s_cmpk_lt_u32 s27, 4000
    s_cselect_b32 s27, s27, 0
join_recurrent_scan__memory_aug_recurrent_mem_tr__dense_activation_mish__prompt_kernel_37:
    .p2align 3
dl_recurrent_scan__memory_aug_recurrent_mem_tr__dense_activation_mish__prompt_kernel_38:
    s_sub_u32 s27, s27, 28
    s_cbranch_scc0 dl_recurrent_scan__memory_aug_recurrent_mem_tr__dense_activation_mish__prompt_kernel_38
entry_recurrent_scan__memory_aug_recurrent_mem_tr__dense_activation_mish__prompt_kernel_19:
    buffer_load_dword v44, v13, s[8:11], s36 offen sc1
    buffer_load_dwordx4 v[40:43], v9, s[8:11], s35 offen sc1
    buffer_store_dword v45, v7, s[8:11], s39 offen sc1
    s_and_b32 s19, s33, 1
    s_mul_i32 s19, s19, 163840
    s_add_u32 s47, s19, s100
    s_add_u32 s48, s19, s101
    s_bfe_u32 s34, s33, 0x10001
    s_add_u32 s23, s47, s26
    s_xor_b32 s18, s35, 0x4000
    s_add_u32 s18, s18, s20
    v_lshlrev_b32 v14, s93, v13
    v_mov_b64 v[24:25], 0
    v_mov_b64 v[26:27], 0
    s_cmp_eq_u32 s92, 0
    s_cbranch_scc1 fmsk_recurrent_scan__memory_aug_recurrent_mem_tr__dense_activation_mish__prompt_kernel_41
    s_or_b64 vcc, s[56:57], s[60:61]
    v_mov_b32_dpp v92, v92 quad_perm:[0,0,1,1] row_mask:0xf bank_mask:0xf
    v_mov_b32_dpp v93, v93 quad_perm:[0,0,1,1] row_mask:0xf bank_mask:0xf
    s_nop 0
    v_cndmask_b32_dpp v92, v94, v92, vcc quad_perm:[0,0,1,1] row_mask:0xf bank_mask:0xf
    v_cndmask_b32_dpp v93, v95, v93, vcc quad_perm:[0,0,1,1] row_mask:0xf bank_mask:0xf
fmsk_recurrent_scan__memory_aug_recurrent_mem_tr__dense_activation_mish__prompt_kernel_41:
    s_waitcnt vmcnt(4)
    v_mov_b64 v[32:33], 0
    v_mov_b64 v[34:35], 0
    v_mov_b64 v[36:37], 0
    v_mov_b64 v[38:39], 0
    s_waitcnt lgkmcnt(0)
    s_memtime s[0:1]
    s_cmp_eq_u32 s42, -1
    s_cbranch_scc1 tc_recurrent_scan__memory_aug_recurrent_mem_tr__dense_activation_mish__prompt_kernel_39
    s_sub_u32 s42, s42, s25
    s_add_i32 s42, s42, 225
    s_waitcnt lgkmcnt(0)
    s_sub_u32 s27, s42, s0
    s_cmpk_lt_u32 s27, 4000
    s_cselect_b32 s27, s27, 0
    .p2align 3
dl_recurrent_scan__memory_aug_recurrent_mem_tr__dense_activation_mish__prompt_kernel_40:
    s_sub_u32 s27, s27, 28
    s_cbranch_scc0 dl_recurrent_scan__memory_aug_recurrent_mem_tr__dense_activation_mish__prompt_kernel_40
    v_mov_b32 v95, 15104
    s_branch tloop_recurrent_scan__memory_aug_recurrent_mem_tr__dense_activation_mish__prompt_kernel_18
cold_recurrent_scan__memory_aug_recurrent_mem_tr__dense_activation_mish__prompt_kernel_23:
    buffer_load_dword v44, v13, s[8:11], s36 offen sc1
    buffer_load_dwordx4 v[40:43], v9, s[8:11], s35 offen sc1
    s_add_u32 s43, s43, 1
    s_cmp_gt_u32 s43, 20000
    s_cbranch_scc1 last_recurrent_scan__memory_aug_recurrent_mem_tr__dense_activation_mish__prompt_kernel_10
    s_waitcnt vmcnt(0) lgkmcnt(0)
    ds_write_b32 v13, v44 offset:15360
    ds_write_b128 v9, v[40:43] offset:8192
    v_cmp_eq_u32 vcc, -1, v44
    s_cbranch_vccnz cold_recurrent_scan__memory_aug_recurrent_mem_tr__dense_activation_mish__prompt_kernel_23
    v_mov_b64 v[24:25], 0
    v_mov_b64 v[26:27], 0
    s_nop 1
    v_smfmac_f32_16x16x64_bf16 v[24:27], v[40:43], v[76:83], v1
    s_waitcnt lgkmcnt(0)
    s_branch back_recurrent_scan__memory_aug_recurrent_mem_tr__dense_activation_mish__prompt_kernel_24
cold_recurrent_scan__memory_aug_recurrent_mem_tr__dense_activation_mish__prompt_kernel_25:
    buffer_load_dwordx4 v[40:43], v9, s[8:11], s35 offen sc1
    s_add_u32 s43, s43, 1
    s_cmp_gt_u32 s43, 20000
    s_cbranch_scc1 last_recurrent_scan__memory_aug_recurrent_mem_tr__dense_activation_mish__prompt_kernel_10
    s_waitcnt vmcnt(0) lgkmcnt(0)
    ds_write_b128 v9, v[40:43] offset:8192
    v_max3_u32 v15, v40, v41, v42
    v_max3_u32 v15, v15, v43, v43
    v_cmp_eq_u32 vcc, -1, v15
    s_cbranch_vccnz cold_recurrent_scan__memory_aug_recurrent_mem_tr__dense_activation_mish__prompt_kernel_25
    ds_read_b128 v[76:79], v8 offset:34816
    ds_read_b128 v[80:83], v8 offset:35840
    ds_read_b128 v[60:63], v8 offset:8192
    ds_read_b128 v[64:67], v8 offset:9216
    ds_read_b128 v[68:71], v8 offset:18432
    ds_read_b128 v[72:75], v8 offset:19456
    s_waitcnt lgkmcnt(0)
    v_mov_b64 v[24:25], 0
    v_mov_b64 v[26:27], 0
    v_mov_b64 v[28:29], 0
    v_mov_b64 v[30:31], 0
    v_mov_b64 v[32:33], 0
    v_mov_b64 v[34:35], 0
    v_mov_b64 v[36:37], 0
    v_mov_b64 v[38:39], 0
    v_mov_b64 v[16:17], 0
    v_mov_b64 v[18:19], 0
    v_smfmac_f32_16x16x64_bf16 v[24:27], v[40:43], v[76:83], v1
    v_smfmac_f32_16x16x64_bf16 v[28:31], v[40:43], v[60:67], v1
    v_smfmac_f32_16x16x64_bf16 v[32:35], v[40:43], v[68:75], v1
    v_smfmac_f32_16x16x64_bf16 v[36:39], v[40:43], v[112:119], v1
    v_smfmac_f32_16x16x64_bf16 v[16:19], v[40:43], v[96:103], v1
    ds_read_b128 v[76:79], v8 offset:32768
    ds_read_b128 v[80:83], v8 offset:33792
    ds_read_b128 v[60:63], v8 offset:14336
    ds_read_b128 v[64:67], v8 offset:15360
    s_waitcnt lgkmcnt(0)
    s_branch back_recurrent_scan__memory_aug_recurrent_mem_tr__dense_activation_mish__prompt_kernel_26
cold_recurrent_scan__memory_aug_recurrent_mem_tr__dense_activation_mish__prompt_kernel_27:
    buffer_load_dwordx4 v[52:55], v9, s[8:11], s40 offen sc1
    buffer_load_dword v56, v13, s[8:11], s41 offen sc1
    s_add_u32 s45, s45, 1
    s_cmp_gt_u32 s45, 20000
    s_cbranch_scc1 last_recurrent_scan__memory_aug_recurrent_mem_tr__dense_activation_mish__prompt_kernel_10
    s_waitcnt vmcnt(0) lgkmcnt(0)
    ds_write_b128 v9, v[52:55] offset:12288
    ds_write_b32 v13, v56 offset:8192
    v_max3_u32 v15, v52, v53, v54
    v_max3_u32 v15, v15, v55, v56
    v_cmp_eq_u32 vcc, -1, v15
    s_cbranch_vccnz cold_recurrent_scan__memory_aug_recurrent_mem_tr__dense_activation_mish__prompt_kernel_27
    s_waitcnt lgkmcnt(0)
    s_branch back_recurrent_scan__memory_aug_recurrent_mem_tr__dense_activation_mish__prompt_kernel_28
gc_recurrent_scan__memory_aug_recurrent_mem_tr__dense_activation_mish__prompt_kernel_29:
    s_waitcnt lgkmcnt(0)
    buffer_load_dwordx4 v[84:87], v0, s[8:11], s54 offen offset:0 sc1
    buffer_load_dwordx4 v[88:91], v0, s[8:11], s54 offen offset:1024 sc1
    s_waitcnt vmcnt(0)
    s_barrier
    ds_read_b64_tr_b16 v[40:41], v3 offset:8192
    ds_read_b64_tr_b16 v[42:43], v3 offset:8704
    s_sub_u32 s38, s53, s51
    s_sub_u32 s38, s38, 32768
    buffer_load_dwordx4 v[44:47], v0, s[8:11], s38 offen offset:0 sc1
    buffer_load_dwordx4 v[48:51], v0, s[8:11], s38 offen offset:1024 sc1
    s_waitcnt vmcnt(0) lgkmcnt(0)
    v_mfma_f32_16x16x32_bf16 v[24:27], v[40:43], v[40:43], 0
    v_mfma_f32_16x16x32_bf16 v[16:19], v[44:47], v[40:43], 0
    v_mfma_f32_16x16x32_bf16 v[20:23], v[48:51], v[40:43], 0
    s_nop 7
    ds_read_b64_tr_b16 v[40:41], v3 offset:9216
    ds_read_b64_tr_b16 v[42:43], v3 offset:9728
    s_sub_u32 s38, s53, s51
    s_sub_u32 s38, s38, 30720
    buffer_load_dwordx4 v[44:47], v0, s[8:11], s38 offen offset:0 sc1
    buffer_load_dwordx4 v[48:51], v0, s[8:11], s38 offen offset:1024 sc1
    s_waitcnt vmcnt(0) lgkmcnt(0)
    v_mfma_f32_16x16x32_bf16 v[24:27], v[40:43], v[40:43], v[24:27]
    v_mfma_f32_16x16x32_bf16 v[16:19], v[44:47], v[40:43], v[16:19]
    v_mfma_f32_16x16x32_bf16 v[20:23], v[48:51], v[40:43], v[20:23]
    s_nop 7
    ds_read_b64_tr_b16 v[40:41], v3 offset:10240
    ds_read_b64_tr_b16 v[42:43], v3 offset:10752
    s_sub_u32 s38, s53, s51
    s_sub_u32 s38, s38, 28672
    buffer_load_dwordx4 v[44:47], v0, s[8:11], s38 offen offset:0 sc1
    buffer_load_dwordx4 v[48:51], v0, s[8:11], s38 offen offset:1024 sc1
    s_waitcnt vmcnt(0) lgkmcnt(0)
    v_mfma_f32_16x16x32_bf16 v[24:27], v[40:43], v[40:43], v[24:27]
    v_mfma_f32_16x16x32_bf16 v[16:19], v[44:47], v[40:43], v[16:19]
    v_mfma_f32_16x16x32_bf16 v[20:23], v[48:51], v[40:43], v[20:23]
    s_nop 7
    ds_read_b64_tr_b16 v[40:41], v3 offset:11264
    ds_read_b64_tr_b16 v[42:43], v3 offset:11776
    s_sub_u32 s38, s53, s51
    s_sub_u32 s38, s38, 26624
    buffer_load_dwordx4 v[44:47], v0, s[8:11], s38 offen offset:0 sc1
    buffer_load_dwordx4 v[48:51], v0, s[8:11], s38 offen offset:1024 sc1
    s_waitcnt vmcnt(0) lgkmcnt(0)
    v_mfma_f32_16x16x32_bf16 v[24:27], v[40:43], v[40:43], v[24:27]
    v_mfma_f32_16x16x32_bf16 v[16:19], v[44:47], v[40:43], v[16:19]
    v_mfma_f32_16x16x32_bf16 v[20:23], v[48:51], v[40:43], v[20:23]
    s_nop 7
    v_max_f32 v28, v24, v25
    v_max3_f32 v28, v28, v16, v17
    v_max3_f32 v28, v28, v18, v19
    v_max3_f32 v28, v28, v20, v21
    v_max3_f32 v29, v28, v22, v23
    v_max3_f32 v28, v28, v22, v23
    s_nop 1
    v_permlane32_swap_b32 v28, v29
    v_max_f32 v26, v28, v29
    v_max_f32 v28, v28, v29
    s_nop 1
    v_permlane16_swap_b32 v28, v26
    v_max_f32 v28, v28, v26
    v_mul_f32 v28, s14, v28
    v_fma_f32 v24, v24, s14, -v28
    v_fma_f32 v25, v25, s14, -v28
    v_exp_f32 v24, v24
    v_exp_f32 v25, v25
    v_fma_f32 v16, v16, s14, -v28
    v_fma_f32 v17, v17, s14, -v28
    v_cvt_pk_bf16_f32 v80, v24, v25
    v_cvt_pk_bf16_f32 v83, v24, v25
    v_fma_f32 v18, v18, s14, -v28
    v_fma_f32 v19, v19, s14, -v28
    v_fma_f32 v20, v20, s14, -v28
    v_fma_f32 v21, v21, s14, -v28
    v_fma_f32 v22, v22, s14, -v28
    v_fma_f32 v23, v23, s14, -v28
    v_mfma_f32_16x16x16_bf16 v[32:35], v[30:31], v[80:81], 0
    v_exp_f32 v16, v16
    v_exp_f32 v17, v17
    v_mfma_f32_16x16x16_bf16 v[36:39], v[30:31], v[82:83], 0
    v_exp_f32 v18, v18
    v_exp_f32 v19, v19
    v_cvt_pk_bf16_f32 v76, v16, v17
    v_mfma_f32_16x16x16_bf16 v[24:27], v[80:81], v[92:93], 0
    v_exp_f32 v20, v20
    v_exp_f32 v21, v21
    v_cvt_pk_bf16_f32 v77, v18, v19
    v_exp_f32 v22, v22
    v_exp_f32 v23, v23
    v_cvt_pk_bf16_f32 v78, v20, v21
    v_cvt_pk_bf16_f32 v79, v22, v23
    s_nop 1
    v_mfma_f32_16x16x32_bf16 v[32:35], v[84:87], v[76:79], v[32:35]
    v_mov_b64 v[40:41], 0
    v_mov_b64 v[42:43], 0
    v_mov_b64 v[44:45], 0
    v_mfma_f32_16x16x32_bf16 v[36:39], v[88:91], v[76:79], v[36:39]
    v_mov_b64 v[46:47], 0
    v_mov_b64 v[48:49], 0
    v_mov_b64 v[50:51], 0
    v_mfma_f32_16x16x32_bf16 v[24:27], v[76:79], v[92:95], v[24:27]
    v_cvt_pk_bf16_f32 v16, v32, v33
    v_cvt_pk_bf16_f32 v17, v34, v35
    v_mov_b64 v[52:53], 0
    v_mov_b64 v[54:55], 0
    v_cvt_pk_bf16_f32 v18, v36, v37
    v_cvt_pk_bf16_f32 v19, v38, v39
    ds_write_b128 v4, v[16:19] offset:12288
    v_mov_b64 v[56:57], 0
    v_rcp_f32 v28, v26
    v_rcp_f32 v29, v27
    v_mov_b64 v[58:59], 0
    s_movk_i32 s38, 0x1833
    v_lshrrev_b32 v20, 11, v5
    v_bfi_b32 v20, s38, v5, v20
    s_waitcnt lgkmcnt(0)
    s_barrier
    ds_read_b128 v[84:87], v0 offset:12288
    ds_read_b128 v[88:91], v0 offset:13312
    s_waitcnt lgkmcnt(0)
    v_smfmac_f32_16x16x64_bf16 v[56:59], v[84:87], a[240:247], v1
    v_smfmac_f32_16x16x64_bf16 v[56:59], v[88:91], a[248:255], v1
    v_smfmac_f32_16x16x64_bf16 v[52:55], v[84:87], a[224:231], v1
    v_smfmac_f32_16x16x64_bf16 v[52:55], v[88:91], a[232:239], v1
    s_branch gb_recurrent_scan__memory_aug_recurrent_mem_tr__dense_activation_mish__prompt_kernel_30
rc_recurrent_scan__memory_aug_recurrent_mem_tr__dense_activation_mish__prompt_kernel_35:
    buffer_load_dwordx4 v[48:51], v0, s[8:11], s48 offen sc1
    buffer_load_dwordx4 v[52:55], v0, s[8:11], s48 offen offset:1024 sc1
    s_add_u32 s49, s49, 1
    s_cmp_gt_u32 s49, 20000
    s_cbranch_scc1 last_recurrent_scan__memory_aug_recurrent_mem_tr__dense_activation_mish__prompt_kernel_10
    s_branch rl_recurrent_scan__memory_aug_recurrent_mem_tr__dense_activation_mish__prompt_kernel_34
nored_recurrent_scan__memory_aug_recurrent_mem_tr__dense_activation_mish__prompt_kernel_31:
    s_cmp_lg_u32 s3, 3
    s_cbranch_scc1 nocal_recurrent_scan__memory_aug_recurrent_mem_tr__dense_activation_mish__prompt_kernel_43
    s_add_u32 s42, s40, 5120
    v_add_u32 v15, s95, v3
    v_mov_b64 v[92:93], v[30:31]
    s_cmp_eq_u32 s92, 0
    s_cbranch_scc1 fmsk_recurrent_scan__memory_aug_recurrent_mem_tr__dense_activation_mish__prompt_kernel_44
    ds_read_b64_tr_b16 v[92:93], v15 offset:8192
    ds_read_b64_tr_b16 v[94:95], v15 offset:8704
fmsk_recurrent_scan__memory_aug_recurrent_mem_tr__dense_activation_mish__prompt_kernel_44:
    .p2align 3
dl_recurrent_scan__memory_aug_recurrent_mem_tr__dense_activation_mish__prompt_kernel_45:
    s_sub_u32 s27, s27, 28
    s_cbranch_scc0 dl_recurrent_scan__memory_aug_recurrent_mem_tr__dense_activation_mish__prompt_kernel_45
    s_memtime s[38:39]
    s_memrealtime s[64:65]
    s_nop 0
    s_memrealtime s[66:67]
    s_nop 0
    s_memrealtime s[68:69]
    s_nop 0
    s_memrealtime s[70:71]
    s_nop 0
    s_memrealtime s[72:73]
    s_nop 0
    s_memrealtime s[74:75]
    s_nop 0
    s_memrealtime s[76:77]
    s_nop 0
    s_memrealtime s[78:79]
    s_nop 0
    s_memrealtime s[80:81]
    s_nop 0
    s_memrealtime s[82:83]
    s_nop 0
    s_memrealtime s[84:85]
    s_nop 0
    s_waitcnt lgkmcnt(0)
    s_buffer_load_dword s42, s[8:11], s42
    s_add_u32 s27, s64, s66
    s_add_u32 s27, s27, s68
    s_add_u32 s27, s27, s70
    s_add_u32 s27, s27, s72
    s_add_u32 s27, s27, s74
    s_add_u32 s27, s27, s76
    s_add_u32 s27, s27, s78
    s_add_u32 s27, s27, s80
    s_add_u32 s27, s27, s82
    s_add_u32 s27, s27, s84
    s_lshl_b32 s27, s27, 1
    s_sub_u32 s27, s27, s38
    v_mov_b32 v15, s27
    ds_write_b32 v13, v15 offset:14336
    s_sub_u32 s22, s27, s25
    s_mov_b32 s25, s27
    v_mov_b32 v15, -1
    buffer_store_dword v15, v13, s[8:11], s91 offen
    s_add_u32 s91, s91, 16384
    ds_read_b128 v[76:79], v8 offset:34816
    ds_read_b128 v[80:83], v8 offset:35840
    ds_read_b128 v[60:63], v8 offset:8192
    ds_read_b128 v[64:67], v8 offset:9216
    ds_read_b128 v[68:71], v8 offset:18432
    ds_read_b128 v[72:75], v8 offset:19456
    v_mov_b64 v[16:17], 0
    v_mov_b64 v[18:19], 0
    v_mov_b64 v[20:21], 0
    v_mov_b64 v[22:23], 0
    v_mov_b64 v[28:29], 0
    v_mov_b64 v[30:31], 0
    s_add_u32 s13, s13, 16384
    s_add_u32 s12, s12, 16384
    s_add_u32 s53, s53, 32768
    s_cmp_eq_u32 s33, 1
    s_cselect_b32 s17, 2097152, 0
    s_sub_u32 s55, s55, s17
    s_sub_u32 s17, s33, 1
    s_add_u32 s54, s54, 32768
    s_add_u32 s55, s55, 32768
    s_add_u32 s15, s15, s21
    s_add_u32 s98, s98, 16384
    s_add_u32 s99, s99, 16384
    s_sub_u32 s6, s6, 100
    s_max_u32 s6, s6, 2440
    s_sub_u32 s37, s37, 100
    s_max_u32 s37, s37, s7
    s_add_u32 s38, s38, 300
    s_sub_u32 s27, s97, s38
    s_cmpk_lt_u32 s27, 4000
    s_cselect_b32 s27, s27, 0
    s_add_u32 s19, s33, 1
    s_min_u32 s19, s19, 63
    s_waitcnt vmcnt(6)
    v_cmp_ge_u32 vcc, s19, v14
    s_and_b32 s39, vcc_lo, 0xfff
    s_cbranch_scc0 kvb_recurrent_scan__memory_aug_recurrent_mem_tr__dense_activation_mish__prompt_kernel_42
kvs_recurrent_scan__memory_aug_recurrent_mem_tr__dense_activation_mish__prompt_kernel_46:
    buffer_load_dword v14, v13, s[8:11], s52 offen sc1
    s_waitcnt vmcnt(0)
    v_cmp_ge_u32 vcc, s19, v14
    s_and_b32 s39, vcc_lo, 0xfff
    s_cbranch_scc0 kvb_recurrent_scan__memory_aug_recurrent_mem_tr__dense_activation_mish__prompt_kernel_42
    s_add_u32 s44, s44, 1
    s_cmp_gt_u32 s44, 100000
    s_cbranch_scc1 last_recurrent_scan__memory_aug_recurrent_mem_tr__dense_activation_mish__prompt_kernel_10
    s_sleep 16
    s_branch kvs_recurrent_scan__memory_aug_recurrent_mem_tr__dense_activation_mish__prompt_kernel_46
kvb_recurrent_scan__memory_aug_recurrent_mem_tr__dense_activation_mish__prompt_kernel_42:
    s_mov_b32 s39, 268435456
    s_branch join_recurrent_scan__memory_aug_recurrent_mem_tr__dense_activation_mish__prompt_kernel_37
nocal_recurrent_scan__memory_aug_recurrent_mem_tr__dense_activation_mish__prompt_kernel_43:
    v_add_u32 v15, s95, v3
    v_mov_b64 v[92:93], v[30:31]
    s_cmp_eq_u32 s92, 0
    s_cbranch_scc1 fmsk_recurrent_scan__memory_aug_recurrent_mem_tr__dense_activation_mish__prompt_kernel_47
    ds_read_b64_tr_b16 v[92:93], v15 offset:8192
    ds_read_b64_tr_b16 v[94:95], v15 offset:8704
fmsk_recurrent_scan__memory_aug_recurrent_mem_tr__dense_activation_mish__prompt_kernel_47:
    ds_read_b128 v[76:79], v8 offset:34816
    ds_read_b128 v[80:83], v8 offset:35840
    ds_read_b128 v[60:63], v8 offset:8192
    ds_read_b128 v[64:67], v8 offset:9216
    ds_read_b128 v[68:71], v8 offset:18432
    ds_read_b128 v[72:75], v8 offset:19456
    v_mov_b64 v[16:17], 0
    v_mov_b64 v[18:19], 0
    v_mov_b64 v[20:21], 0
    v_mov_b64 v[22:23], 0
    v_mov_b64 v[28:29], 0
    v_mov_b64 v[30:31], 0
    s_add_u32 s13, s13, 16384
    s_add_u32 s12, s12, 16384
    s_add_u32 s53, s53, 32768
    s_cmp_eq_u32 s33, 1
    s_cselect_b32 s17, 2097152, 0
    s_sub_u32 s55, s55, s17
    s_sub_u32 s17, s33, 1
    s_add_u32 s54, s54, 32768
    s_add_u32 s55, s55, 32768
    s_add_u32 s15, s15, s21
    s_add_u32 s98, s98, 16384
    s_add_u32 s99, s99, 16384
    s_sub_u32 s6, s6, 100
    s_max_u32 s6, s6, 2440
    s_sub_u32 s37, s37, 100
    s_max_u32 s37, s37, s7
    s_mov_b32 s39, 268435456
    s_waitcnt vmcnt(5)
    s_branch post_recurrent_scan__memory_aug_recurrent_mem_tr__dense_activation_mish__prompt_kernel_36
tc_recurrent_scan__memory_aug_recurrent_mem_tr__dense_activation_mish__prompt_kernel_39:
    s_add_u32 s44, s44, 1
    s_add_u32 s38, s40, 5120
    buffer_load_dword v15, off, s[8:11], s38 sc1
    s_waitcnt vmcnt(0)
    s_memtime s[0:1]
    v_readfirstlane_b32 s42, v15
    s_mov_b32 s27, 0
    s_waitcnt lgkmcnt(0)
    s_sub_u32 s38, s0, s97
    s_cmp_gt_u32 s38, 3000
    s_cbranch_scc1 dl_recurrent_scan__memory_aug_recurrent_mem_tr__dense_activation_mish__prompt_kernel_40
    s_cmp_eq_u32 s42, -1
    s_cbranch_scc1 tc_recurrent_scan__memory_aug_recurrent_mem_tr__dense_activation_mish__prompt_kernel_39
    s_sub_u32 s42, s42, s25
    s_sub_u32 s27, s42, s0
    s_add_i32 s27, s27, 225
    s_cmpk_lt_u32 s27, 4000
    s_cselect_b32 s27, s27, 0
    s_branch dl_recurrent_scan__memory_aug_recurrent_mem_tr__dense_activation_mish__prompt_kernel_40
lastpub_recurrent_scan__memory_aug_recurrent_mem_tr__dense_activation_mish__prompt_kernel_17:
    s_add_u32 s55, s55, 32768
    s_waitcnt vmcnt(0)
    v_add_u32 v15, s95, v3
    v_mov_b64 v[92:93], v[30:31]
    s_cmp_eq_u32 s92, 0
    s_cbranch_scc1 fmsk_recurrent_scan__memory_aug_recurrent_mem_tr__dense_activation_mish__prompt_kernel_48
    ds_read_b64_tr_b16 v[92:93], v15 offset:8192
    ds_read_b64_tr_b16 v[94:95], v15 offset:8704
fmsk_recurrent_scan__memory_aug_recurrent_mem_tr__dense_activation_mish__prompt_kernel_48:
    s_waitcnt lgkmcnt(0)
    s_cmp_eq_u32 s92, 0
    s_cbranch_scc1 fmsk_recurrent_scan__memory_aug_recurrent_mem_tr__dense_activation_mish__prompt_kernel_49
    s_or_b64 vcc, s[56:57], s[60:61]
    v_mov_b32_dpp v92, v92 quad_perm:[0,0,1,1] row_mask:0xf bank_mask:0xf
    v_mov_b32_dpp v93, v93 quad_perm:[0,0,1,1] row_mask:0xf bank_mask:0xf
    s_nop 0
    v_cndmask_b32_dpp v92, v94, v92, vcc quad_perm:[0,0,1,1] row_mask:0xf bank_mask:0xf
    v_cndmask_b32_dpp v93, v95, v93, vcc quad_perm:[0,0,1,1] row_mask:0xf bank_mask:0xf
fmsk_recurrent_scan__memory_aug_recurrent_mem_tr__dense_activation_mish__prompt_kernel_49:
    buffer_store_dwordx2 v[92:93], v3, s[8:11], s55 offen sc1
    v_mov_b32 v15, 64
    s_waitcnt vmcnt(0)
    s_barrier
    buffer_store_dword v15, off, s[8:11], s50 sc1
    s_branch last_recurrent_scan__memory_aug_recurrent_mem_tr__dense_activation_mish__prompt_kernel_10
slow_recurrent_scan__memory_aug_recurrent_mem_tr__dense_activation_mish__prompt_kernel_16:
    s_lshl_b32 s39, s5, 5
    s_lshl_b32 s38, s4, 4
    s_add_u32 s39, s39, s38
    v_cmp_eq_u32 vcc, s39, v0
    s_waitcnt vmcnt(3)
    s_nop 0
    v_cndmask_b32 v41, v31, v30, vcc
    v_mov_b64 v[16:17], 0
    v_mov_b64 v[18:19], 0
    v_mov_b64 v[20:21], 0
    v_mov_b64 v[22:23], 0
    v_mov_b64 v[24:25], 0
    v_mov_b64 v[26:27], 0
    v_mov_b64 v[28:29], 0
    v_mov_b64 v[30:31], 0
    v_mov_b64 v[32:33], 0
    v_mov_b64 v[34:35], 0
    v_mov_b64 v[36:37], 0
    v_mov_b64 v[38:39], 0
    ds_read_b128 v[76:79], v8 offset:34816
    ds_read_b128 v[80:83], v8 offset:35840
    ds_read_b128 v[60:63], v8 offset:8192
    ds_read_b128 v[64:67], v8 offset:9216
    ds_read_b128 v[68:71], v8 offset:18432
    ds_read_b128 v[72:75], v8 offset:19456
    s_memtime s[96:97]
    s_waitcnt lgkmcnt(0)
    s_sub_u32 s97, s96, 1
    s_add_u32 s42, s97, s25
    s_sub_u32 s42, s42, 1000
    s_and_b32 s19, s33, 1
    s_mul_i32 s19, s19, 163840
    s_add_u32 s47, s19, s100
    s_add_u32 s48, s19, s101
    s_bfe_u32 s34, s33, 0x10001
    s_add_u32 s23, s47, s26
    s_xor_b32 s18, s35, 0x4000
    s_add_u32 s18, s18, s20
    v_lshlrev_b32 v14, s93, v13
    v_mov_b64 v[24:25], 0
    v_mov_b64 v[26:27], 0
    s_cmp_lg_u32 s3, 3
    s_cbranch_scc1 go_recurrent_scan__memory_aug_recurrent_mem_tr__dense_activation_mish__prompt_kernel_54
    v_lshrrev_b32 v40, 2, v0
    s_mov_b32 s39, 97925120
    s_branch st_recurrent_scan__memory_aug_recurrent_mem_tr__dense_activation_mish__prompt_kernel_53c
st_recurrent_scan__memory_aug_recurrent_mem_tr__dense_activation_mish__prompt_kernel_53:
    s_sleep 4
    buffer_load_dword v41, v40, s[8:11], s39 offen sc1
    s_add_u32 s44, s44, 1
    s_cmp_gt_u32 s44, 100000
    s_cbranch_scc1 last_recurrent_scan__memory_aug_recurrent_mem_tr__dense_activation_mish__prompt_kernel_10
    s_waitcnt vmcnt(0)
st_recurrent_scan__memory_aug_recurrent_mem_tr__dense_activation_mish__prompt_kernel_53c:
    v_cmp_eq_u32 vcc, 0, v41
    s_cbranch_vccnz st_recurrent_scan__memory_aug_recurrent_mem_tr__dense_activation_mish__prompt_kernel_53
    v_subrev_u32 v41, s42, v41
    s_nop 1
    v_max_i32_dpp v41, v41, v41 row_ror:1 row_mask:0xf bank_mask:0xf
    s_nop 1
    v_max_i32_dpp v41, v41, v41 row_ror:2 row_mask:0xf bank_mask:0xf
    s_nop 1
    v_max_i32_dpp v41, v41, v41 row_ror:4 row_mask:0xf bank_mask:0xf
    s_nop 1
    v_max_i32_dpp v41, v41, v41 row_ror:8 row_mask:0xf bank_mask:0xf
    s_nop 0
    v_readlane_b32 s0, v41, 0
    v_readlane_b32 s1, v41, 16
    v_readlane_b32 s18, v41, 32
    v_readlane_b32 s19, v41, 48
    s_max_i32 s0, s0, s1
    s_max_i32 s18, s18, s19
    s_max_i32 s0, s0, s18
    s_add_u32 s96, s0, s42
    s_add_u32 s0, s96, 2000
    s_not_b32 s0, s0
    v_mov_b32 v15, s0
    buffer_store_dword v15, off, s[8:11], s98 sc1
    s_sub_u32 s96, s96, s25
    s_memtime s[0:1]
    s_waitcnt lgkmcnt(0)
    s_sub_u32 s27, s96, s0
    s_cmpk_lt_u32 s27, 4000
    s_cselect_b32 s27, s27, 0
    .p2align 3
dl_recurrent_scan__memory_aug_recurrent_mem_tr__dense_activation_mish__prompt_kernel_55:
    s_sub_u32 s27, s27, 28
    s_cbranch_scc0 dl_recurrent_scan__memory_aug_recurrent_mem_tr__dense_activation_mish__prompt_kernel_55
go_recurrent_scan__memory_aug_recurrent_mem_tr__dense_activation_mish__prompt_kernel_54:
    s_sub_u32 s97, s96, 1
    s_add_u32 s42, s97, s25
    s_sub_u32 s42, s42, 1000
    s_mov_b32 s39, 268435456
    s_barrier
    s_branch entry_recurrent_scan__memory_aug_recurrent_mem_tr__dense_activation_mish__prompt_kernel_52
tloop_recurrent_scan__memory_aug_recurrent_mem_tr__dense_activation_mish__prompt_kernel_51:
    s_waitcnt vmcnt(2)
    ds_write_b32 v13, v44 offset:15360
    v_cmp_eq_u32 vcc, -1, v44
    s_waitcnt vmcnt(1)
    v_smfmac_f32_16x16x64_bf16 v[24:27], v[40:43], v[76:83], v1
    ds_write_b128 v9, v[40:43] offset:8192
    s_cbranch_vccnz cold_recurrent_scan__memory_aug_recurrent_mem_tr__dense_activation_mish__prompt_kernel_56
back_recurrent_scan__memory_aug_recurrent_mem_tr__dense_activation_mish__prompt_kernel_57:
    v_max3_u32 v15, v40, v41, v42
    v_smfmac_f32_16x16x64_bf16 v[28:31], v[40:43], v[60:67], v1
    s_waitcnt lgkmcnt(1)
    s_barrier
    ds_read_b128 v[48:51], v0 offset:15360
    buffer_load_dwordx4 v[52:55], v9, s[8:11], s40 offen sc1
    buffer_load_dword v56, v13, s[8:11], s41 offen sc1
    v_max3_u32 v15, v15, v43, v43
    v_smfmac_f32_16x16x64_bf16 v[32:35], v[40:43], v[68:75], v1
    ds_read_b128 v[76:79], v8 offset:32768
    ds_read_b128 v[80:83], v8 offset:33792
    v_cmp_eq_u32 vcc, -1, v15
    v_smfmac_f32_16x16x64_bf16 v[36:39], v[40:43], v[112:119], v1
    ds_read_b128 v[60:63], v8 offset:14336
    ds_read_b128 v[64:67], v8 offset:15360
    v_smfmac_f32_16x16x64_bf16 v[16:19], v[40:43], v[96:103], v1
    s_cbranch_vccnz cold_recurrent_scan__memory_aug_recurrent_mem_tr__dense_activation_mish__prompt_kernel_58
back_recurrent_scan__memory_aug_recurrent_mem_tr__dense_activation_mish__prompt_kernel_59:
    ds_read_b128 v[68:71], v8 offset:16384
    ds_read_b128 v[72:75], v8 offset:17408
    v_smfmac_f32_16x16x64_bf16 v[20:23], v[40:43], v[104:111], v1
    buffer_load_dwordx4 v[84:87], v0, s[8:11], s54 offen offset:0 sc1
    buffer_load_dwordx4 v[88:91], v0, s[8:11], s54 offen offset:1024 sc1
    s_waitcnt lgkmcnt(7)
    s_barrier
    s_waitcnt lgkmcnt(6)
    v_smfmac_f32_16x16x64_bf16 v[16:19], v[48:51], v[120:127], v1
    ds_read_b128 v[44:47], v10 offset:8192
    v_mov_b32 v3, v3
    v_smfmac_f32_16x16x64_bf16 v[20:23], v[48:51], v[128:135], v1
    buffer_load_dword v14, v14, s[8:11], s15 offen sc1
    ds_read_b32 v94, v95
    v_smfmac_f32_16x16x64_bf16 v[24:27], v[48:51], v[136:143], v1
    ds_read_b128 v[40:43], v11 offset:8192
    s_waitcnt lgkmcnt(7)
    v_smfmac_f32_16x16x64_bf16 v[28:31], v[48:51], v[76:83], v1
    ds_read_b128 v[76:79], v8 offset:20480
    s_waitcnt lgkmcnt(6)
    v_smfmac_f32_16x16x64_bf16 v[32:35], v[48:51], v[60:67], v1
    ds_read_b128 v[80:83], v8 offset:21504
    s_waitcnt lgkmcnt(5)
    v_smfmac_f32_16x16x64_bf16 v[36:39], v[48:51], v[68:75], v1
    ds_read_b128 v[60:63], v8 offset:22528
    s_waitcnt lgkmcnt(5)
    v_smfmac_f32_16x16x64_bf16 v[16:19], v[44:47], v[144:151], v1
    ds_read_b128 v[64:67], v8 offset:23552
    v_mov_b32 v3, v3
    v_smfmac_f32_16x16x64_bf16 v[20:23], v[44:47], v[152:159], v1
    ds_read_b128 v[48:51], v12 offset:8192
    v_mov_b32 v3, v3
    v_smfmac_f32_16x16x64_bf16 v[24:27], v[44:47], v[160:167], v1
    ds_read_b128 v[68:71], v8 offset:0
    v_mov_b32 v3, v3
    v_smfmac_f32_16x16x64_bf16 v[28:31], v[44:47], v[168:175], v1
    ds_read_b128 v[72:75], v8 offset:1024
    s_waitcnt lgkmcnt(5)
    v_smfmac_f32_16x16x64_bf16 v[32:35], v[44:47], v[76:83], v1
    ds_read_b128 v[76:79], v8 offset:2048
    s_waitcnt lgkmcnt(4)
    v_smfmac_f32_16x16x64_bf16 v[36:39], v[44:47], v[60:67], v1
    s_waitcnt lgkmcnt(3)
    s_barrier
    v_mov_b32 v3, v3
    v_smfmac_f32_16x16x64_bf16 v[16:19], v[40:43], v[176:183], v1
    ds_read_b128 v[80:83], v8 offset:3072
    v_readfirstlane_b32 s25, v94
    v_smfmac_f32_16x16x64_bf16 v[20:23], v[40:43], v[184:191], v1
    ds_read_b128 v[60:63], v8 offset:4096
    v_mov_b32 v3, v3
    v_smfmac_f32_16x16x64_bf16 v[24:27], v[40:43], v[192:199], v1
    ds_read_b128 v[64:67], v8 offset:5120
    v_mov_b32 v3, v3
    v_smfmac_f32_16x16x64_bf16 v[28:31], v[40:43], v[200:207], v1
    s_waitcnt lgkmcnt(4)
    v_mov_b32 v3, v3
    v_smfmac_f32_16x16x64_bf16 v[32:35], v[40:43], v[68:75], v1
    ds_read_b128 v[68:71], v8 offset:6144
    s_waitcnt lgkmcnt(3)
    v_smfmac_f32_16x16x64_bf16 v[36:39], v[40:43], v[76:83], v1
    s_waitcnt vmcnt(3)
    ds_write_b128 v9, v[52:55] offset:12288
    v_max3_u32 v15, v52, v53, v54
    v_smfmac_f32_16x16x64_bf16 v[16:19], v[48:51], v[208:215], v1
    ds_write_b32 v13, v56 offset:8192
    v_max3_u32 v15, v15, v55, v56
    v_smfmac_f32_16x16x64_bf16 v[20:23], v[48:51], v[216:223], v1
    ds_read_b128 v[72:75], v8 offset:7168
    v_cmp_eq_u32 vcc, -1, v15
    v_smfmac_f32_16x16x64_bf16 v[24:27], v[48:51], v[224:231], v1
    s_cbranch_vccnz cold_recurrent_scan__memory_aug_recurrent_mem_tr__dense_activation_mish__prompt_kernel_60
back_recurrent_scan__memory_aug_recurrent_mem_tr__dense_activation_mish__prompt_kernel_61:
    ds_read_b128 v[76:79], v8 offset:24576
    v_smfmac_f32_16x16x64_bf16 v[28:31], v[48:51], v[232:239], v1
    s_waitcnt lgkmcnt(2)
    s_barrier
    v_mov_b32 v3, v3
    v_smfmac_f32_16x16x64_bf16 v[32:35], v[48:51], v[60:67], v1
    ds_read_b128 v[56:59], v0 offset:8192
    s_waitcnt lgkmcnt(2)
    v_smfmac_f32_16x16x64_bf16 v[36:39], v[48:51], v[68:75], v1
    s_memtime s[96:97]
    ds_read_b128 v[44:47], v10 offset:12288
    v_smfmac_f32_16x16x64_bf16 v[24:27], v[52:55], a[0:7], v1
    buffer_store_dwordx2 v[92:93], v3, s[8:11], s55 offen sc1
    ds_read_b128 v[80:83], v8 offset:25600
    v_smfmac_f32_16x16x64_bf16 v[16:19], v[52:55], v[240:247], v1
    ds_read_b128 v[40:43], v11 offset:12288
    v_mov_b32 v3, v3
    v_smfmac_f32_16x16x64_bf16 v[28:31], v[52:55], a[8:15], v1
    s_add_u32 s96, s96, s25
    ds_read_b128 v[60:63], v8 offset:28672
    v_not_b32 v15, s96
    v_smfmac_f32_16x16x64_bf16 v[20:23], v[52:55], v[248:255], v1
    s_mov_b64 exec, 1
    buffer_atomic_umin v15, off, s[8:11], s98 sc1
    s_mov_b64 exec, -1
    s_waitcnt lgkmcnt(4)
    v_smfmac_f32_16x16x64_bf16 v[24:27], v[56:59], a[32:39], v1
    ds_read_b128 v[64:67], v8 offset:29696
    v_mov_b32 v15, s17
    v_smfmac_f32_16x16x64_bf16 v[16:19], v[56:59], a[16:23], v1
    buffer_store_dword v15, off, s[8:11], s50 sc1
    ds_read_b128 v[48:51], v12 offset:12288
    s_waitcnt lgkmcnt(5)
    v_smfmac_f32_16x16x64_bf16 v[24:27], v[44:47], a[80:87], v1
    ds_read_b128 v[68:71], v8 offset:26624
    v_mov_b32 v3, v3
    v_smfmac_f32_16x16x64_bf16 v[16:19], v[44:47], a[64:71], v1
    ds_read_b128 v[72:75], v8 offset:27648
    s_waitcnt lgkmcnt(6)
    s_waitcnt lgkmcnt(5)
    v_smfmac_f32_16x16x64_bf16 v[24:27], v[40:43], v[76:83], v1
    ds_read_b128 v[76:79], v8 offset:30720
    v_mov_b32 v15, -1
    v_smfmac_f32_16x16x64_bf16 v[16:19], v[40:43], a[112:119], v1
    buffer_store_dword v15, v13, s[8:11], s18 offen sc1
    ds_read_b128 v[80:83], v8 offset:31744
    s_waitcnt lgkmcnt(5)
    s_waitcnt lgkmcnt(4)
    v_smfmac_f32_16x16x64_bf16 v[24:27], v[48:51], v[60:67], v1
    ds_read_b128 v[60:63], v8 offset:10240
    v_mov_b32 v3, v3
    v_smfmac_f32_16x16x64_bf16 v[16:19], v[48:51], a[144:151], v1
    s_waitcnt vmcnt(5)
    s_barrier
    v_mov_b32 v3, v3
    v_smfmac_f32_16x16x64_bf16 v[28:31], v[56:59], a[40:47], v1
    ds_read_b128 v[64:67], v8 offset:11264
    v_add_f32 v24, v24, v26
    v_smfmac_f32_16x16x64_bf16 v[28:31], v[44:47], a[88:95], v1
    ds_read_b128 v[92:95], v0 offset:4096
    s_waitcnt lgkmcnt(5)
    v_add_f32 v25, v25, v27
    v_smfmac_f32_16x16x64_bf16 v[28:31], v[40:43], v[68:75], v1
    ds_read_b128 v[68:71], v8 offset:12288
    s_waitcnt lgkmcnt(4)
    v_cvt_pk_bf16_f32 v26, v24, v25
    v_smfmac_f32_16x16x64_bf16 v[28:31], v[48:51], v[76:83], v1
    ds_read_b128 v[72:75], v8 offset:13312
    v_add_f32 v16, v16, v18
    v_smfmac_f32_16x16x64_bf16 v[20:23], v[56:59], a[24:31], v1
    ds_read_b128 v[76:79], v0 offset:0
    v_add_f32 v17, v17, v19
    v_smfmac_f32_16x16x64_bf16 v[20:23], v[44:47], a[72:79], v1
    ds_read_b128 v[80:83], v0 offset:2048
    v_cvt_pk_bf16_f32 v27, v16, v17
    v_smfmac_f32_16x16x64_bf16 v[20:23], v[40:43], a[120:127], v1
    ds_write_b64 v2, v[26:27] offset:8192
    v_add_f32 v28, v28, v30
    v_smfmac_f32_16x16x64_bf16 v[20:23], v[48:51], a[152:159], v1
    s_waitcnt lgkmcnt(6)
    v_add_f32 v29, v29, v31
    v_smfmac_f32_16x16x64_bf16 v[32:35], v[52:55], v[60:67], v1
    s_waitcnt lgkmcnt(3)
    v_cvt_pk_bf16_f32 v30, v28, v29
    v_smfmac_f32_16x16x64_bf16 v[36:39], v[52:55], v[68:75], v1
    v_add_f32 v20, v20, v22
    v_add_f32 v21, v21, v23
    v_cvt_pk_bf16_f32 v31, v20, v21
    ds_write_b64 v2, v[30:31] offset:8704
    v_smfmac_f32_16x16x64_bf16 v[32:35], v[56:59], a[48:55], v1
    ds_read_b128 v[52:55], v0 offset:6144
    v_mov_b32 v3, v3
    v_smfmac_f32_16x16x64_bf16 v[36:39], v[56:59], a[56:63], v1
    ds_read_b128 v[56:59], v0 offset:1024
    v_mov_b32 v3, v3
    v_smfmac_f32_16x16x64_bf16 v[32:35], v[44:47], a[96:103], v1
    v_mov_b32 v3, v3
    s_waitcnt lgkmcnt(2)
    s_barrier
    ds_read_b64_tr_b16 v[60:61], v3 offset:8192
    ds_read_b64_tr_b16 v[62:63], v3 offset:8704
    v_smfmac_f32_16x16x64_bf16 v[36:39], v[44:47], a[104:111], v1
    ds_read_b64_tr_b16 v[64:65], v3 offset:9216
    ds_read_b64_tr_b16 v[66:67], v3 offset:9728
    v_smfmac_f32_16x16x64_bf16 v[32:35], v[40:43], a[128:135], v1
    ds_read_b64_tr_b16 v[68:69], v3 offset:10240
    ds_read_b64_tr_b16 v[70:71], v3 offset:10752
    v_smfmac_f32_16x16x64_bf16 v[36:39], v[40:43], a[136:143], v1
    ds_read_b64_tr_b16 v[72:73], v3 offset:11264
    ds_read_b64_tr_b16 v[74:75], v3 offset:11776
    v_smfmac_f32_16x16x64_bf16 v[32:35], v[48:51], a[160:167], v1
    ds_read_b128 v[44:47], v0 offset:3072
    ds_read_b128 v[40:43], v0 offset:5120
    v_smfmac_f32_16x16x64_bf16 v[36:39], v[48:51], a[168:175], v1
    ds_read_b128 v[48:51], v0 offset:7168
    s_waitcnt lgkmcnt(9)
    v_mfma_f32_16x16x32_bf16 v[24:27], v[60:63], v[60:63], 0
    s_waitcnt lgkmcnt(7)
    s_movk_i32 s27, 0x1833
    v_mov_b32 v3, v3
    v_mfma_f32_16x16x32_bf16 v[24:27], v[64:67], v[64:67], v[24:27]
    s_waitcnt lgkmcnt(5)
    v_add_f32 v32, v32, v34
    v_add_f32 v33, v33, v35
    v_mfma_f32_16x16x32_bf16 v[24:27], v[68:71], v[68:71], v[24:27]
    s_waitcnt lgkmcnt(3)
    v_cvt_pk_bf16_f32 v30, v32, v33
    v_add_f32 v36, v36, v38
    v_mfma_f32_16x16x32_bf16 v[24:27], v[72:75], v[72:75], v[24:27]
    s_cmp_eq_u32 s33, 63
    v_add_f32 v37, v37, v39
    v_cvt_pk_bf16_f32 v31, v36, v37
    v_mfma_f32_16x16x32_bf16 v[16:19], v[76:79], v[60:63], 0
    s_cbranch_scc1 lastpub_recurrent_scan__memory_aug_recurrent_mem_tr__dense_activation_mish__prompt_kernel_50
    v_mov_b32 v3, v3
    v_mfma_f32_16x16x32_bf16 v[16:19], v[80:83], v[64:67], v[16:19]
    s_waitcnt lgkmcnt(0)
    v_mul_f32 v24, s14, v24
    v_mul_f32 v25, s14, v25
    v_mfma_f32_16x16x32_bf16 v[16:19], v[92:95], v[68:71], v[16:19]
    v_exp_f32 v24, v24
    v_mov_b32 v81, 0
    v_mfma_f32_16x16x32_bf16 v[16:19], v[52:55], v[72:75], v[16:19]
    v_exp_f32 v25, v25
    v_mov_b32 v82, 0
    v_mfma_f32_16x16x32_bf16 v[20:23], v[56:59], v[60:63], 0
    s_buffer_load_dword s1, s[8:11], s99 offset:256
    s_buffer_load_dword s0, s[8:11], s99 offset:0
    v_mov_b32 v92, 0x3f803f80
    v_mov_b32 v93, 0x3f803f80
    v_cvt_pk_bf16_f32 v80, v24, v25
    v_mfma_f32_16x16x32_bf16 v[20:23], v[44:47], v[64:67], v[20:23]
    s_buffer_load_dword s19, s[8:11], s99 offset:768
    s_buffer_load_dword s18, s[8:11], s99 offset:512
    v_mul_f32 v16, s14, v16
    v_mul_f32 v17, s14, v17
    v_cvt_pk_bf16_f32 v83, v24, v25
    v_mfma_f32_16x16x32_bf16 v[20:23], v[40:43], v[68:71], v[20:23]
    v_exp_f32 v16, v16
    v_mul_f32 v18, s14, v18
    v_mfma_f32_16x16x32_bf16 v[20:23], v[48:51], v[72:75], v[20:23]
    v_exp_f32 v17, v17
    v_mul_f32 v19, s14, v19
    v_mfma_f32_16x16x16_bf16 v[32:35], v[30:31], v[80:81], 0
    v_exp_f32 v18, v18
    v_exp_f32 v19, v19
    v_mfma_f32_16x16x16_bf16 v[36:39], v[30:31], v[82:83], 0
    v_mul_f32 v20, s14, v20
    v_mul_f32 v21, s14, v21
    v_exp_f32 v20, v20
    v_mfma_f32_16x16x16_bf16 v[24:27], v[80:81], v[92:93], 0
    v_mul_f32 v22, s14, v22
    v_mul_f32 v23, s14, v23
    v_exp_f32 v21, v21
    v_exp_f32 v22, v22
    v_exp_f32 v23, v23
    v_cvt_pk_bf16_f32 v76, v16, v17
    v_cvt_pk_bf16_f32 v77, v18, v19
    v_cvt_pk_bf16_f32 v78, v20, v21
    v_cvt_pk_bf16_f32 v79, v22, v23
    v_mov_b32 v94, 0x3f803f80
    v_mov_b32 v95, 0x3f803f80
    v_mfma_f32_16x16x32_bf16 v[32:35], v[84:87], v[76:79], v[32:35]
    v_lshrrev_b32 v20, 11, v5
    v_mov_b64 v[52:53], 0
    v_bfi_b32 v20, s27, v5, v20
    v_mfma_f32_16x16x32_bf16 v[36:39], v[88:91], v[76:79], v[36:39]
    s_barrier
    v_mov_b64 v[54:55], 0
    v_mov_b64 v[56:57], 0
    v_mov_b64 v[58:59], 0
    v_mfma_f32_16x16x32_bf16 v[24:27], v[76:79], v[92:95], v[24:27]
    v_cvt_pk_bf16_f32 v16, v32, v33
    v_cvt_pk_bf16_f32 v17, v34, v35
    v_mov_b64 v[44:45], 0
    v_mov_b64 v[46:47], 0
    v_cvt_pk_bf16_f32 v18, v36, v37
    v_cvt_pk_bf16_f32 v19, v38, v39
    ds_write_b128 v4, v[16:19] offset:12288
    buffer_load_dwordx4 v0, s[8:11], s53 offen offset:0 sc1 lds
    buffer_load_dwordx4 v0, s[8:11], s53 offen offset:1024 sc1 lds
    v_mov_b64 v[40:41], 0
    v_rcp_f32 v28, v26
    v_rcp_f32 v29, v27
    s_waitcnt lgkmcnt(0)
    s_barrier
    ds_read_b128 v[84:87], v0 offset:12288
    ds_read_b128 v[88:91], v0 offset:13312
    s_min_u32 s0, s0, s1
    s_min_u32 s18, s18, s19
    s_min_u32 s0, s0, s18
    s_not_b32 s0, s0
    s_sub_u32 s27, s0, s96
    s_add_u32 s96, s96, s6
    s_min_i32 s27, s27, s24
    s_max_i32 s27, s27, 0
    s_add_u32 s96, s96, s27
    s_waitcnt lgkmcnt(1)
    v_smfmac_f32_16x16x64_bf16 v[56:59], v[84:87], a[240:247], v1
    s_add_u32 s0, s96, s22
    v_and_b32 v15, s0, -2
    s_waitcnt lgkmcnt(0)
    v_max3_f32 v21, v26, v27, v28
    v_smfmac_f32_16x16x64_bf16 v[56:59], v[88:91], a[248:255], v1
    buffer_store_dword v15, off, s[8:11], s12 sc1
    s_sub_u32 s97, s96, s25
    v_max_f32 v21, v21, v29
    v_smfmac_f32_16x16x64_bf16 v[52:55], v[84:87], a[224:231], v1
    v_cmp_lt_f32 vcc, 0x5d800000, v21
    v_mov_b64 v[42:43], 0
    v_mov_b64 v[48:49], 0
    v_smfmac_f32_16x16x64_bf16 v[52:55], v[88:91], a[232:239], v1
    s_cbranch_vccnz gc_recurrent_scan__memory_aug_recurrent_mem_tr__dense_activation_mish__prompt_kernel_62
gb_recurrent_scan__memory_aug_recurrent_mem_tr__dense_activation_mish__prompt_kernel_63:
    s_sub_u32 s42, s96, 1000
    v_add_f32 v56, v56, v58
    v_smfmac_f32_16x16x64_bf16 v[40:43], v[84:87], a[176:183], v1
    s_sub_u32 s96, s97, s37
    s_add_u32 s33, s33, 1
    v_mov_b64 v[50:51], 0
    v_smfmac_f32_16x16x64_bf16 v[40:43], v[88:91], a[184:191], v1
    s_add_u32 s40, s40, 16384
    s_add_u32 s41, s41, 16384
    v_add_f32 v57, v57, v59
    v_smfmac_f32_16x16x64_bf16 v[44:47], v[84:87], a[192:199], v1
    s_add_u32 s35, s35, 8192
    s_bitset0_b32 s35, 15
    v_fma_mixlo_f16 v56, v56, v28, 0
    v_smfmac_f32_16x16x64_bf16 v[44:47], v[88:91], a[200:207], v1
    v_fma_mixhi_f16 v56, v57, v29, 0
    v_bfi_b32 v56, 1, s34, v56
    v_smfmac_f32_16x16x64_bf16 v[48:51], v[84:87], a[208:215], v1
    buffer_store_dword v56, v20, s[8:11], s23 offen sc1
    v_add_f32 v52, v52, v54
    v_add_f32 v53, v53, v55
    v_smfmac_f32_16x16x64_bf16 v[48:51], v[88:91], a[216:223], v1
    v_fma_mixlo_f16 v19, v52, v28, 0
    v_fma_mixhi_f16 v19, v53, v29, 0
    v_add_f32 v40, v40, v42
    v_add_f32 v41, v41, v43
    v_fma_mixlo_f16 v16, v40, v28, 0
    v_fma_mixhi_f16 v16, v41, v29, 0
    v_bfi_b32 v16, 1, s34, v16
    v_add_f32 v44, v44, v46
    v_add_f32 v45, v45, v47
    v_fma_mixlo_f16 v17, v44, v28, 0
    v_fma_mixhi_f16 v17, v45, v29, 0
    v_add_f32 v48, v48, v50
    v_add_f32 v49, v49, v51
    v_fma_mixlo_f16 v18, v48, v28, 0
    v_fma_mixhi_f16 v18, v49, v29, 0
    buffer_store_dwordx4 v[16:19], v5, s[8:11], s47 offen sc1
    s_memtime s[0:1]
    v_cndmask_b32 v24, 0, v6, s[56:57]
    v_cndmask_b32 v25, 0, v6, s[58:59]
    v_cndmask_b32 v26, 0, v6, s[60:61]
    v_cndmask_b32 v27, 0, v6, s[62:63]
    s_add_u32 s38, s35, s32
    s_add_u32 s36, s35, 4096
    s_mov_b32 s39, s13
    s_waitcnt lgkmcnt(0)
    s_sub_u32 s27, s96, s0
    s_cmpk_lt_u32 s27, 4000
    s_cselect_b32 s27, s27, 0
    s_cmp_ge_u32 s28, 80
    s_cbranch_scc1 nored_recurrent_scan__memory_aug_recurrent_mem_tr__dense_activation_mish__prompt_kernel_64
    .p2align 3
dl_recurrent_scan__memory_aug_recurrent_mem_tr__dense_activation_mish__prompt_kernel_65:
    s_sub_u32 s27, s27, 28
    s_cbranch_scc0 dl_recurrent_scan__memory_aug_recurrent_mem_tr__dense_activation_mish__prompt_kernel_65
    buffer_load_dwordx4 v[48:51], v0, s[8:11], s48 offen sc1
    buffer_load_dwordx4 v[52:55], v0, s[8:11], s48 offen offset:1024 sc1
    v_add_u32 v15, s95, v3
    v_mov_b64 v[92:93], v[30:31]
    s_cmp_eq_u32 s92, 0
    s_cbranch_scc1 fmsk_recurrent_scan__memory_aug_recurrent_mem_tr__dense_activation_mish__prompt_kernel_66
    ds_read_b64_tr_b16 v[92:93], v15 offset:8192
    ds_read_b64_tr_b16 v[94:95], v15 offset:8704
fmsk_recurrent_scan__memory_aug_recurrent_mem_tr__dense_activation_mish__prompt_kernel_66:
    ds_read_b128 v[76:79], v8 offset:34816
    ds_read_b128 v[80:83], v8 offset:35840
    ds_read_b128 v[60:63], v8 offset:8192
    ds_read_b128 v[64:67], v8 offset:9216
    ds_read_b128 v[68:71], v8 offset:18432
    ds_read_b128 v[72:75], v8 offset:19456
    v_mov_b64 v[16:17], 0
    v_mov_b64 v[18:19], 0
    v_mov_b64 v[20:21], 0
    v_mov_b64 v[22:23], 0
    v_mov_b64 v[28:29], 0
    v_mov_b64 v[30:31], 0
    s_add_u32 s13, s13, 16384
    s_add_u32 s12, s12, 16384
    s_add_u32 s53, s53, 32768
    s_cmp_eq_u32 s33, 1
    s_cselect_b32 s17, 2097152, 0
    s_sub_u32 s55, s55, s17
    s_sub_u32 s17, s33, 1
    s_add_u32 s54, s54, 32768
    s_add_u32 s55, s55, 32768
    s_add_u32 s15, s15, s21
    s_add_u32 s98, s98, 16384
    s_add_u32 s99, s99, 16384
    s_sub_u32 s6, s6, 100
    s_max_u32 s6, s6, 2440
    s_sub_u32 s37, s37, 100
    s_max_u32 s37, s37, s7
rl_recurrent_scan__memory_aug_recurrent_mem_tr__dense_activation_mish__prompt_kernel_67:
    s_waitcnt vmcnt(1)
    v_mfma_f32_16x16x32_f16 v[40:43], v[24:27], v[48:51], 0
    v_bitop3_b32 v56, v49, v50, s34 bitop3:0x7e
    s_waitcnt vmcnt(0)
    v_mfma_f32_16x16x32_f16 v[40:43], v[24:27], v[52:55], v[40:43]
    v_bitop3_b32 v58, v51, v53, s34 bitop3:0x7e
    v_bitop3_b32 v59, v54, v55, s34 bitop3:0x7e
    v_bitop3_b32 v44, v48, v52, s34 bitop3:0x7e
    v_or3_b32 v56, v56, v58, v59
    v_and_or_b32 v56, v56, s94, v44
    v_and_b32 v56, 1, v56
    v_cmp_ne_u32 vcc, 0, v56
    s_nop 0
    v_add_f32_dpp v40, v40, v40 row_ror:4 row_mask:0xf bank_mask:0xf
    v_add_f32_dpp v41, v41, v41 row_ror:4 row_mask:0xf bank_mask:0xf
    s_cbranch_vccnz rc_recurrent_scan__memory_aug_recurrent_mem_tr__dense_activation_mish__prompt_kernel_68
    v_add_f32_dpp v40, v40, v40 row_ror:8 row_mask:0xf bank_mask:0xf
    v_add_f32_dpp v41, v41, v41 row_ror:8 row_mask:0xf bank_mask:0xf
    v_cvt_pk_bf16_f32 v40, v40, v41
    v_min_u32 v45, 0xfffffffe, v40
    buffer_store_dword v45, v7, s[8:11], s38 offen sc1
post_recurrent_scan__memory_aug_recurrent_mem_tr__dense_activation_mish__prompt_kernel_69:
    s_memtime s[0:1]
    s_waitcnt lgkmcnt(0)
    s_sub_u32 s27, s97, s0
    s_cmpk_lt_u32 s27, 4000
    s_cselect_b32 s27, s27, 0
join_recurrent_scan__memory_aug_recurrent_mem_tr__dense_activation_mish__prompt_kernel_70:
    .p2align 3
dl_recurrent_scan__memory_aug_recurrent_mem_tr__dense_activation_mish__prompt_kernel_71:
    s_sub_u32 s27, s27, 28
    s_cbranch_scc0 dl_recurrent_scan__memory_aug_recurrent_mem_tr__dense_activation_mish__prompt_kernel_71
entry_recurrent_scan__memory_aug_recurrent_mem_tr__dense_activation_mish__prompt_kernel_52:
    buffer_load_dword v44, v13, s[8:11], s36 offen sc1
    buffer_load_dwordx4 v[40:43], v9, s[8:11], s35 offen sc1
    buffer_store_dword v45, v7, s[8:11], s39 offen sc1
    s_and_b32 s19, s33, 1
    s_mul_i32 s19, s19, 163840
    s_add_u32 s47, s19, s100
    s_add_u32 s48, s19, s101
    s_bfe_u32 s34, s33, 0x10001
    s_add_u32 s23, s47, s26
    s_xor_b32 s18, s35, 0x4000
    s_add_u32 s18, s18, s20
    v_lshlrev_b32 v14, s93, v13
    v_mov_b64 v[24:25], 0
    v_mov_b64 v[26:27], 0
    s_cmp_eq_u32 s92, 0
    s_cbranch_scc1 fmsk_recurrent_scan__memory_aug_recurrent_mem_tr__dense_activation_mish__prompt_kernel_74
    s_or_b64 vcc, s[56:57], s[60:61]
    v_mov_b32_dpp v92, v92 quad_perm:[0,0,1,1] row_mask:0xf bank_mask:0xf
    v_mov_b32_dpp v93, v93 quad_perm:[0,0,1,1] row_mask:0xf bank_mask:0xf
    s_nop 0
    v_cndmask_b32_dpp v92, v94, v92, vcc quad_perm:[0,0,1,1] row_mask:0xf bank_mask:0xf
    v_cndmask_b32_dpp v93, v95, v93, vcc quad_perm:[0,0,1,1] row_mask:0xf bank_mask:0xf
fmsk_recurrent_scan__memory_aug_recurrent_mem_tr__dense_activation_mish__prompt_kernel_74:
    s_waitcnt vmcnt(4)
    v_mov_b64 v[32:33], 0
    v_mov_b64 v[34:35], 0
    v_mov_b64 v[36:37], 0
    v_mov_b64 v[38:39], 0
    s_waitcnt lgkmcnt(0)
    s_memtime s[0:1]
    s_cmp_eq_u32 s42, -1
    s_cbranch_scc1 tc_recurrent_scan__memory_aug_recurrent_mem_tr__dense_activation_mish__prompt_kernel_72
    s_sub_u32 s42, s42, s25
    s_add_i32 s42, s42, 225
    s_waitcnt lgkmcnt(0)
    s_sub_u32 s27, s42, s0
    s_cmpk_lt_u32 s27, 4000
    s_cselect_b32 s27, s27, 0
    .p2align 3
dl_recurrent_scan__memory_aug_recurrent_mem_tr__dense_activation_mish__prompt_kernel_73:
    s_sub_u32 s27, s27, 28
    s_cbranch_scc0 dl_recurrent_scan__memory_aug_recurrent_mem_tr__dense_activation_mish__prompt_kernel_73
    v_mov_b32 v95, 15104
    s_branch tloop_recurrent_scan__memory_aug_recurrent_mem_tr__dense_activation_mish__prompt_kernel_51
cold_recurrent_scan__memory_aug_recurrent_mem_tr__dense_activation_mish__prompt_kernel_56:
    buffer_load_dword v44, v13, s[8:11], s36 offen sc1
    buffer_load_dwordx4 v[40:43], v9, s[8:11], s35 offen sc1
    s_add_u32 s43, s43, 1
    s_cmp_gt_u32 s43, 20000
    s_cbranch_scc1 last_recurrent_scan__memory_aug_recurrent_mem_tr__dense_activation_mish__prompt_kernel_10
    s_waitcnt vmcnt(0) lgkmcnt(0)
    ds_write_b32 v13, v44 offset:15360
    ds_write_b128 v9, v[40:43] offset:8192
    v_cmp_eq_u32 vcc, -1, v44
    s_cbranch_vccnz cold_recurrent_scan__memory_aug_recurrent_mem_tr__dense_activation_mish__prompt_kernel_56
    v_mov_b64 v[24:25], 0
    v_mov_b64 v[26:27], 0
    s_nop 1
    v_smfmac_f32_16x16x64_bf16 v[24:27], v[40:43], v[76:83], v1
    s_waitcnt lgkmcnt(0)
    s_branch back_recurrent_scan__memory_aug_recurrent_mem_tr__dense_activation_mish__prompt_kernel_57
cold_recurrent_scan__memory_aug_recurrent_mem_tr__dense_activation_mish__prompt_kernel_58:
    buffer_load_dwordx4 v[40:43], v9, s[8:11], s35 offen sc1
    s_add_u32 s43, s43, 1
    s_cmp_gt_u32 s43, 20000
    s_cbranch_scc1 last_recurrent_scan__memory_aug_recurrent_mem_tr__dense_activation_mish__prompt_kernel_10
    s_waitcnt vmcnt(0) lgkmcnt(0)
    ds_write_b128 v9, v[40:43] offset:8192
    v_max3_u32 v15, v40, v41, v42
    v_max3_u32 v15, v15, v43, v43
    v_cmp_eq_u32 vcc, -1, v15
    s_cbranch_vccnz cold_recurrent_scan__memory_aug_recurrent_mem_tr__dense_activation_mish__prompt_kernel_58
    ds_read_b128 v[76:79], v8 offset:34816
    ds_read_b128 v[80:83], v8 offset:35840
    ds_read_b128 v[60:63], v8 offset:8192
    ds_read_b128 v[64:67], v8 offset:9216
    ds_read_b128 v[68:71], v8 offset:18432
    ds_read_b128 v[72:75], v8 offset:19456
    s_waitcnt lgkmcnt(0)
    v_mov_b64 v[24:25], 0
    v_mov_b64 v[26:27], 0
    v_mov_b64 v[28:29], 0
    v_mov_b64 v[30:31], 0
    v_mov_b64 v[32:33], 0
    v_mov_b64 v[34:35], 0
    v_mov_b64 v[36:37], 0
    v_mov_b64 v[38:39], 0
    v_mov_b64 v[16:17], 0
    v_mov_b64 v[18:19], 0
    v_smfmac_f32_16x16x64_bf16 v[24:27], v[40:43], v[76:83], v1
    v_smfmac_f32_16x16x64_bf16 v[28:31], v[40:43], v[60:67], v1
    v_smfmac_f32_16x16x64_bf16 v[32:35], v[40:43], v[68:75], v1
    v_smfmac_f32_16x16x64_bf16 v[36:39], v[40:43], v[112:119], v1
    v_smfmac_f32_16x16x64_bf16 v[16:19], v[40:43], v[96:103], v1
    ds_read_b128 v[76:79], v8 offset:32768
    ds_read_b128 v[80:83], v8 offset:33792
    ds_read_b128 v[60:63], v8 offset:14336
    ds_read_b128 v[64:67], v8 offset:15360
    s_waitcnt lgkmcnt(0)
    s_branch back_recurrent_scan__memory_aug_recurrent_mem_tr__dense_activation_mish__prompt_kernel_59
cold_recurrent_scan__memory_aug_recurrent_mem_tr__dense_activation_mish__prompt_kernel_60:
    buffer_load_dwordx4 v[52:55], v9, s[8:11], s40 offen sc1
    buffer_load_dword v56, v13, s[8:11], s41 offen sc1
    s_add_u32 s45, s45, 1
    s_cmp_gt_u32 s45, 20000
    s_cbranch_scc1 last_recurrent_scan__memory_aug_recurrent_mem_tr__dense_activation_mish__prompt_kernel_10
    s_waitcnt vmcnt(0) lgkmcnt(0)
    ds_write_b128 v9, v[52:55] offset:12288
    ds_write_b32 v13, v56 offset:8192
    v_max3_u32 v15, v52, v53, v54
    v_max3_u32 v15, v15, v55, v56
    v_cmp_eq_u32 vcc, -1, v15
    s_cbranch_vccnz cold_recurrent_scan__memory_aug_recurrent_mem_tr__dense_activation_mish__prompt_kernel_60
    s_waitcnt lgkmcnt(0)
    s_branch back_recurrent_scan__memory_aug_recurrent_mem_tr__dense_activation_mish__prompt_kernel_61
gc_recurrent_scan__memory_aug_recurrent_mem_tr__dense_activation_mish__prompt_kernel_62:
    s_waitcnt lgkmcnt(0)
    buffer_load_dwordx4 v[84:87], v0, s[8:11], s54 offen offset:0 sc1
    buffer_load_dwordx4 v[88:91], v0, s[8:11], s54 offen offset:1024 sc1
    s_waitcnt vmcnt(0)
    s_barrier
    ds_read_b64_tr_b16 v[40:41], v3 offset:8192
    ds_read_b64_tr_b16 v[42:43], v3 offset:8704
    s_sub_u32 s38, s53, s51
    s_sub_u32 s38, s38, 32768
    buffer_load_dwordx4 v[44:47], v0, s[8:11], s38 offen offset:0 sc1
    buffer_load_dwordx4 v[48:51], v0, s[8:11], s38 offen offset:1024 sc1
    s_waitcnt vmcnt(0) lgkmcnt(0)
    v_mfma_f32_16x16x32_bf16 v[24:27], v[40:43], v[40:43], 0
    v_mfma_f32_16x16x32_bf16 v[16:19], v[44:47], v[40:43], 0
    v_mfma_f32_16x16x32_bf16 v[20:23], v[48:51], v[40:43], 0
    s_nop 7
    ds_read_b64_tr_b16 v[40:41], v3 offset:9216
    ds_read_b64_tr_b16 v[42:43], v3 offset:9728
    s_sub_u32 s38, s53, s51
    s_sub_u32 s38, s38, 30720
    buffer_load_dwordx4 v[44:47], v0, s[8:11], s38 offen offset:0 sc1
    buffer_load_dwordx4 v[48:51], v0, s[8:11], s38 offen offset:1024 sc1
    s_waitcnt vmcnt(0) lgkmcnt(0)
    v_mfma_f32_16x16x32_bf16 v[24:27], v[40:43], v[40:43], v[24:27]
    v_mfma_f32_16x16x32_bf16 v[16:19], v[44:47], v[40:43], v[16:19]
    v_mfma_f32_16x16x32_bf16 v[20:23], v[48:51], v[40:43], v[20:23]
    s_nop 7
    ds_read_b64_tr_b16 v[40:41], v3 offset:10240
    ds_read_b64_tr_b16 v[42:43], v3 offset:10752
    s_sub_u32 s38, s53, s51
    s_sub_u32 s38, s38, 28672
    buffer_load_dwordx4 v[44:47], v0, s[8:11], s38 offen offset:0 sc1
    buffer_load_dwordx4 v[48:51], v0, s[8:11], s38 offen offset:1024 sc1
    s_waitcnt vmcnt(0) lgkmcnt(0)
    v_mfma_f32_16x16x32_bf16 v[24:27], v[40:43], v[40:43], v[24:27]
    v_mfma_f32_16x16x32_bf16 v[16:19], v[44:47], v[40:43], v[16:19]
    v_mfma_f32_16x16x32_bf16 v[20:23], v[48:51], v[40:43], v[20:23]
    s_nop 7
    ds_read_b64_tr_b16 v[40:41], v3 offset:11264
    ds_read_b64_tr_b16 v[42:43], v3 offset:11776
    s_sub_u32 s38, s53, s51
    s_sub_u32 s38, s38, 26624
    buffer_load_dwordx4 v[44:47], v0, s[8:11], s38 offen offset:0 sc1
    buffer_load_dwordx4 v[48:51], v0, s[8:11], s38 offen offset:1024 sc1
    s_waitcnt vmcnt(0) lgkmcnt(0)
    v_mfma_f32_16x16x32_bf16 v[24:27], v[40:43], v[40:43], v[24:27]
    v_mfma_f32_16x16x32_bf16 v[16:19], v[44:47], v[40:43], v[16:19]
    v_mfma_f32_16x16x32_bf16 v[20:23], v[48:51], v[40:43], v[20:23]
    s_nop 7
    v_max_f32 v28, v24, v25
    v_max3_f32 v28, v28, v16, v17
    v_max3_f32 v28, v28, v18, v19
    v_max3_f32 v28, v28, v20, v21
    v_max3_f32 v29, v28, v22, v23
    v_max3_f32 v28, v28, v22, v23
    s_nop 1
    v_permlane32_swap_b32 v28, v29
    v_max_f32 v26, v28, v29
    v_max_f32 v28, v28, v29
    s_nop 1
    v_permlane16_swap_b32 v28, v26
    v_max_f32 v28, v28, v26
    v_mul_f32 v28, s14, v28
    v_fma_f32 v24, v24, s14, -v28
    v_fma_f32 v25, v25, s14, -v28
    v_exp_f32 v24, v24
    v_exp_f32 v25, v25
    v_fma_f32 v16, v16, s14, -v28
    v_fma_f32 v17, v17, s14, -v28
    v_cvt_pk_bf16_f32 v80, v24, v25
    v_cvt_pk_bf16_f32 v83, v24, v25
    v_fma_f32 v18, v18, s14, -v28
    v_fma_f32 v19, v19, s14, -v28
    v_fma_f32 v20, v20, s14, -v28
    v_fma_f32 v21, v21, s14, -v28
    v_fma_f32 v22, v22, s14, -v28
    v_fma_f32 v23, v23, s14, -v28
    v_mfma_f32_16x16x16_bf16 v[32:35], v[30:31], v[80:81], 0
    v_exp_f32 v16, v16
    v_exp_f32 v17, v17
    v_mfma_f32_16x16x16_bf16 v[36:39], v[30:31], v[82:83], 0
    v_exp_f32 v18, v18
    v_exp_f32 v19, v19
    v_cvt_pk_bf16_f32 v76, v16, v17
    v_mfma_f32_16x16x16_bf16 v[24:27], v[80:81], v[92:93], 0
    v_exp_f32 v20, v20
    v_exp_f32 v21, v21
    v_cvt_pk_bf16_f32 v77, v18, v19
    v_exp_f32 v22, v22
    v_exp_f32 v23, v23
    v_cvt_pk_bf16_f32 v78, v20, v21
    v_cvt_pk_bf16_f32 v79, v22, v23
    s_nop 1
    v_mfma_f32_16x16x32_bf16 v[32:35], v[84:87], v[76:79], v[32:35]
    v_mov_b64 v[40:41], 0
    v_mov_b64 v[42:43], 0
    v_mov_b64 v[44:45], 0
    v_mfma_f32_16x16x32_bf16 v[36:39], v[88:91], v[76:79], v[36:39]
    v_mov_b64 v[46:47], 0
    v_mov_b64 v[48:49], 0
    v_mov_b64 v[50:51], 0
    v_mfma_f32_16x16x32_bf16 v[24:27], v[76:79], v[92:95], v[24:27]
    v_cvt_pk_bf16_f32 v16, v32, v33
    v_cvt_pk_bf16_f32 v17, v34, v35
    v_mov_b64 v[52:53], 0
    v_mov_b64 v[54:55], 0
    v_cvt_pk_bf16_f32 v18, v36, v37
    v_cvt_pk_bf16_f32 v19, v38, v39
    ds_write_b128 v4, v[16:19] offset:12288
    v_mov_b64 v[56:57], 0
    v_rcp_f32 v28, v26
    v_rcp_f32 v29, v27
    v_mov_b64 v[58:59], 0
    s_movk_i32 s38, 0x1833
    v_lshrrev_b32 v20, 11, v5
    v_bfi_b32 v20, s38, v5, v20
    s_waitcnt lgkmcnt(0)
    s_barrier
    ds_read_b128 v[84:87], v0 offset:12288
    ds_read_b128 v[88:91], v0 offset:13312
    s_waitcnt lgkmcnt(0)
    v_smfmac_f32_16x16x64_bf16 v[56:59], v[84:87], a[240:247], v1
    v_smfmac_f32_16x16x64_bf16 v[56:59], v[88:91], a[248:255], v1
    v_smfmac_f32_16x16x64_bf16 v[52:55], v[84:87], a[224:231], v1
    v_smfmac_f32_16x16x64_bf16 v[52:55], v[88:91], a[232:239], v1
    s_branch gb_recurrent_scan__memory_aug_recurrent_mem_tr__dense_activation_mish__prompt_kernel_63
rc_recurrent_scan__memory_aug_recurrent_mem_tr__dense_activation_mish__prompt_kernel_68:
    buffer_load_dwordx4 v[48:51], v0, s[8:11], s48 offen sc1
    buffer_load_dwordx4 v[52:55], v0, s[8:11], s48 offen offset:1024 sc1
    s_add_u32 s49, s49, 1
    s_cmp_gt_u32 s49, 20000
    s_cbranch_scc1 last_recurrent_scan__memory_aug_recurrent_mem_tr__dense_activation_mish__prompt_kernel_10
    s_branch rl_recurrent_scan__memory_aug_recurrent_mem_tr__dense_activation_mish__prompt_kernel_67
nored_recurrent_scan__memory_aug_recurrent_mem_tr__dense_activation_mish__prompt_kernel_64:
    s_cmp_lg_u32 s3, 3
    s_cbranch_scc1 nocal_recurrent_scan__memory_aug_recurrent_mem_tr__dense_activation_mish__prompt_kernel_76
    s_add_u32 s42, s40, 5120
    v_add_u32 v15, s95, v3
    v_mov_b64 v[92:93], v[30:31]
    s_cmp_eq_u32 s92, 0
    s_cbranch_scc1 fmsk_recurrent_scan__memory_aug_recurrent_mem_tr__dense_activation_mish__prompt_kernel_77
    ds_read_b64_tr_b16 v[92:93], v15 offset:8192
    ds_read_b64_tr_b16 v[94:95], v15 offset:8704
fmsk_recurrent_scan__memory_aug_recurrent_mem_tr__dense_activation_mish__prompt_kernel_77:
    .p2align 3
dl_recurrent_scan__memory_aug_recurrent_mem_tr__dense_activation_mish__prompt_kernel_78:
    s_sub_u32 s27, s27, 28
    s_cbranch_scc0 dl_recurrent_scan__memory_aug_recurrent_mem_tr__dense_activation_mish__prompt_kernel_78
    s_memtime s[38:39]
    s_memrealtime s[64:65]
    s_nop 0
    s_memrealtime s[66:67]
    s_nop 0
    s_memrealtime s[68:69]
    s_nop 0
    s_memrealtime s[70:71]
    s_nop 0
    s_memrealtime s[72:73]
    s_nop 0
    s_memrealtime s[74:75]
    s_nop 0
    s_memrealtime s[76:77]
    s_nop 0
    s_memrealtime s[78:79]
    s_nop 0
    s_memrealtime s[80:81]
    s_nop 0
    s_memrealtime s[82:83]
    s_nop 0
    s_memrealtime s[84:85]
    s_nop 0
    s_waitcnt lgkmcnt(0)
    s_buffer_load_dword s42, s[8:11], s42
    s_add_u32 s27, s64, s66
    s_add_u32 s27, s27, s68
    s_add_u32 s27, s27, s70
    s_add_u32 s27, s27, s72
    s_add_u32 s27, s27, s74
    s_add_u32 s27, s27, s76
    s_add_u32 s27, s27, s78
    s_add_u32 s27, s27, s80
    s_add_u32 s27, s27, s82
    s_add_u32 s27, s27, s84
    s_lshl_b32 s27, s27, 1
    s_sub_u32 s27, s27, s38
    v_mov_b32 v15, s27
    ds_write_b32 v13, v15 offset:14336
    s_sub_u32 s22, s27, s25
    s_mov_b32 s25, s27
    v_mov_b32 v15, -1
    buffer_store_dword v15, v13, s[8:11], s91 offen sc1
    s_add_u32 s91, s91, 16384
    ds_read_b128 v[76:79], v8 offset:34816
    ds_read_b128 v[80:83], v8 offset:35840
    ds_read_b128 v[60:63], v8 offset:8192
    ds_read_b128 v[64:67], v8 offset:9216
    ds_read_b128 v[68:71], v8 offset:18432
    ds_read_b128 v[72:75], v8 offset:19456
    v_mov_b64 v[16:17], 0
    v_mov_b64 v[18:19], 0
    v_mov_b64 v[20:21], 0
    v_mov_b64 v[22:23], 0
    v_mov_b64 v[28:29], 0
    v_mov_b64 v[30:31], 0
    s_add_u32 s13, s13, 16384
    s_add_u32 s12, s12, 16384
    s_add_u32 s53, s53, 32768
    s_cmp_eq_u32 s33, 1
    s_cselect_b32 s17, 2097152, 0
    s_sub_u32 s55, s55, s17
    s_sub_u32 s17, s33, 1
    s_add_u32 s54, s54, 32768
    s_add_u32 s55, s55, 32768
    s_add_u32 s15, s15, s21
    s_add_u32 s98, s98, 16384
    s_add_u32 s99, s99, 16384
    s_sub_u32 s6, s6, 100
    s_max_u32 s6, s6, 2440
    s_sub_u32 s37, s37, 100
    s_max_u32 s37, s37, s7
    s_add_u32 s38, s38, 300
    s_sub_u32 s27, s97, s38
    s_cmpk_lt_u32 s27, 4000
    s_cselect_b32 s27, s27, 0
    s_add_u32 s19, s33, 1
    s_min_u32 s19, s19, 63
    s_waitcnt vmcnt(6)
    v_cmp_ge_u32 vcc, s19, v14
    s_and_b32 s39, vcc_lo, 0xfff
    s_cbranch_scc0 kvb_recurrent_scan__memory_aug_recurrent_mem_tr__dense_activation_mish__prompt_kernel_75
kvs_recurrent_scan__memory_aug_recurrent_mem_tr__dense_activation_mish__prompt_kernel_79:
    buffer_load_dword v14, v13, s[8:11], s52 offen sc1
    s_waitcnt vmcnt(0)
    v_cmp_ge_u32 vcc, s19, v14
    s_and_b32 s39, vcc_lo, 0xfff
    s_cbranch_scc0 kvb_recurrent_scan__memory_aug_recurrent_mem_tr__dense_activation_mish__prompt_kernel_75
    s_add_u32 s44, s44, 1
    s_cmp_gt_u32 s44, 100000
    s_cbranch_scc1 last_recurrent_scan__memory_aug_recurrent_mem_tr__dense_activation_mish__prompt_kernel_10
    s_sleep 16
    s_branch kvs_recurrent_scan__memory_aug_recurrent_mem_tr__dense_activation_mish__prompt_kernel_79
kvb_recurrent_scan__memory_aug_recurrent_mem_tr__dense_activation_mish__prompt_kernel_75:
    s_mov_b32 s39, 268435456
    s_branch join_recurrent_scan__memory_aug_recurrent_mem_tr__dense_activation_mish__prompt_kernel_70
nocal_recurrent_scan__memory_aug_recurrent_mem_tr__dense_activation_mish__prompt_kernel_76:
    v_add_u32 v15, s95, v3
    v_mov_b64 v[92:93], v[30:31]
    s_cmp_eq_u32 s92, 0
    s_cbranch_scc1 fmsk_recurrent_scan__memory_aug_recurrent_mem_tr__dense_activation_mish__prompt_kernel_80
    ds_read_b64_tr_b16 v[92:93], v15 offset:8192
    ds_read_b64_tr_b16 v[94:95], v15 offset:8704
fmsk_recurrent_scan__memory_aug_recurrent_mem_tr__dense_activation_mish__prompt_kernel_80:
    ds_read_b128 v[76:79], v8 offset:34816
    ds_read_b128 v[80:83], v8 offset:35840
    ds_read_b128 v[60:63], v8 offset:8192
    ds_read_b128 v[64:67], v8 offset:9216
    ds_read_b128 v[68:71], v8 offset:18432
    ds_read_b128 v[72:75], v8 offset:19456
    v_mov_b64 v[16:17], 0
    v_mov_b64 v[18:19], 0
    v_mov_b64 v[20:21], 0
    v_mov_b64 v[22:23], 0
    v_mov_b64 v[28:29], 0
    v_mov_b64 v[30:31], 0
    s_add_u32 s13, s13, 16384
    s_add_u32 s12, s12, 16384
    s_add_u32 s53, s53, 32768
    s_cmp_eq_u32 s33, 1
    s_cselect_b32 s17, 2097152, 0
    s_sub_u32 s55, s55, s17
    s_sub_u32 s17, s33, 1
    s_add_u32 s54, s54, 32768
    s_add_u32 s55, s55, 32768
    s_add_u32 s15, s15, s21
    s_add_u32 s98, s98, 16384
    s_add_u32 s99, s99, 16384
    s_sub_u32 s6, s6, 100
    s_max_u32 s6, s6, 2440
    s_sub_u32 s37, s37, 100
    s_max_u32 s37, s37, s7
    s_mov_b32 s39, 268435456
    s_waitcnt vmcnt(5)
    s_branch post_recurrent_scan__memory_aug_recurrent_mem_tr__dense_activation_mish__prompt_kernel_69
tc_recurrent_scan__memory_aug_recurrent_mem_tr__dense_activation_mish__prompt_kernel_72:
    s_add_u32 s44, s44, 1
    s_add_u32 s38, s40, 5120
    buffer_load_dword v15, off, s[8:11], s38 sc1
    s_waitcnt vmcnt(0)
    s_memtime s[0:1]
    v_readfirstlane_b32 s42, v15
    s_mov_b32 s27, 0
    s_waitcnt lgkmcnt(0)
    s_sub_u32 s38, s0, s97
    s_cmp_gt_u32 s38, 3000
    s_cbranch_scc1 dl_recurrent_scan__memory_aug_recurrent_mem_tr__dense_activation_mish__prompt_kernel_73
    s_cmp_eq_u32 s42, -1
    s_cbranch_scc1 tc_recurrent_scan__memory_aug_recurrent_mem_tr__dense_activation_mish__prompt_kernel_72
    s_sub_u32 s42, s42, s25
    s_sub_u32 s27, s42, s0
    s_add_i32 s27, s27, 225
    s_cmpk_lt_u32 s27, 4000
    s_cselect_b32 s27, s27, 0
    s_branch dl_recurrent_scan__memory_aug_recurrent_mem_tr__dense_activation_mish__prompt_kernel_73
lastpub_recurrent_scan__memory_aug_recurrent_mem_tr__dense_activation_mish__prompt_kernel_50:
    s_add_u32 s55, s55, 32768
    s_waitcnt vmcnt(0)
    v_add_u32 v15, s95, v3
    v_mov_b64 v[92:93], v[30:31]
    s_cmp_eq_u32 s92, 0
    s_cbranch_scc1 fmsk_recurrent_scan__memory_aug_recurrent_mem_tr__dense_activation_mish__prompt_kernel_81
    ds_read_b64_tr_b16 v[92:93], v15 offset:8192
    ds_read_b64_tr_b16 v[94:95], v15 offset:8704
fmsk_recurrent_scan__memory_aug_recurrent_mem_tr__dense_activation_mish__prompt_kernel_81:
    s_waitcnt lgkmcnt(0)
    s_cmp_eq_u32 s92, 0
    s_cbranch_scc1 fmsk_recurrent_scan__memory_aug_recurrent_mem_tr__dense_activation_mish__prompt_kernel_82
    s_or_b64 vcc, s[56:57], s[60:61]
    v_mov_b32_dpp v92, v92 quad_perm:[0,0,1,1] row_mask:0xf bank_mask:0xf
    v_mov_b32_dpp v93, v93 quad_perm:[0,0,1,1] row_mask:0xf bank_mask:0xf
    s_nop 0
    v_cndmask_b32_dpp v92, v94, v92, vcc quad_perm:[0,0,1,1] row_mask:0xf bank_mask:0xf
    v_cndmask_b32_dpp v93, v95, v93, vcc quad_perm:[0,0,1,1] row_mask:0xf bank_mask:0xf
fmsk_recurrent_scan__memory_aug_recurrent_mem_tr__dense_activation_mish__prompt_kernel_82:
    buffer_store_dwordx2 v[92:93], v3, s[8:11], s55 offen sc1
    v_mov_b32 v15, 64
    s_waitcnt vmcnt(0)
    s_barrier
    buffer_store_dword v15, off, s[8:11], s50 sc1
    s_branch last_recurrent_scan__memory_aug_recurrent_mem_tr__dense_activation_mish__prompt_kernel_10
last_recurrent_scan__memory_aug_recurrent_mem_tr__dense_activation_mish__prompt_kernel_10:
    s_endpgm
worker_recurrent_scan__memory_aug_recurrent_mem_tr__dense_activation_mish__prompt_kernel_9:
    s_sub_u32 s5, 31, s5
    s_lshl_b32 s2, s5, 3
    s_add_u32 s2, s2, s4
    s_cmp_lg_u32 s2, 250
    s_cbranch_scc1 nw0_recurrent_scan__memory_aug_recurrent_mem_tr__dense_activation_mish__prompt_kernel_84
    s_cmp_lg_u32 s3, 0
    s_cbranch_scc1 nw0_recurrent_scan__memory_aug_recurrent_mem_tr__dense_activation_mish__prompt_kernel_84
    s_mov_b32 s6, 97910784
    v_mov_b32 v4, 0
    v_mov_b32 v5, 0
    v_mov_b32 v6, 0
    v_mov_b32 v7, 0
    v_lshlrev_b32 v8, 4, v0
    buffer_store_dwordx4 v[4:7], v8, s[8:11], s6 offen offset:0 sc1
    buffer_store_dwordx4 v[4:7], v8, s[8:11], s6 offen offset:1024 sc1
    buffer_store_dwordx4 v[4:7], v8, s[8:11], s6 offen offset:2048 sc1
    buffer_store_dwordx4 v[4:7], v8, s[8:11], s6 offen offset:3072 sc1
    s_add_u32 s6, s6, 4096
    buffer_store_dwordx4 v[4:7], v8, s[8:11], s6 offen offset:0 sc1
    buffer_store_dwordx4 v[4:7], v8, s[8:11], s6 offen offset:1024 sc1
    buffer_store_dwordx4 v[4:7], v8, s[8:11], s6 offen offset:2048 sc1
    buffer_store_dwordx4 v[4:7], v8, s[8:11], s6 offen offset:3072 sc1
    s_add_u32 s6, s6, 4096
    buffer_store_dwordx4 v[4:7], v8, s[8:11], s6 offen offset:0 sc1
    buffer_store_dwordx4 v[4:7], v8, s[8:11], s6 offen offset:1024 sc1
    buffer_store_dwordx4 v[4:7], v8, s[8:11], s6 offen offset:2048 sc1
    buffer_store_dwordx4 v[4:7], v8, s[8:11], s6 offen offset:3072 sc1
    s_add_u32 s6, s6, 4096
    buffer_store_dwordx4 v[4:7], v8, s[8:11], s6 offen offset:0 sc1
    buffer_store_dwordx4 v[4:7], v8, s[8:11], s6 offen offset:1024 sc1
    buffer_store_dwordx4 v[4:7], v8, s[8:11], s6 offen offset:2048 sc1
    buffer_store_dwordx4 v[4:7], v8, s[8:11], s6 offen offset:3072 sc1
    v_mov_b32 v9, 1
    s_waitcnt vmcnt(0)
    buffer_store_dword v9, off, s[24:27], 0 offset:64 sc1
    s_mov_b32 s30, -1
    s_mov_b32 s31, -1
    s_mov_b32 s32, 98572288
    s_mov_b32 s33, 0
    v_lshlrev_b32 v5, 2, v0
    s_mov_b64 exec, 0xffff
pol_recurrent_scan__memory_aug_recurrent_mem_tr__dense_activation_mish__prompt_kernel_87:
    s_memtime s[34:35]
    s_waitcnt lgkmcnt(0)
    buffer_store_dword v5, v5, s[8:11], s32 offen sc1
    s_waitcnt vmcnt(0)
    s_memtime s[36:37]
    s_add_u32 s32, s32, 8192
    s_waitcnt lgkmcnt(0)
    s_sub_u32 s36, s36, s34
    s_min_u32 s30, s30, s36
    s_memtime s[34:35]
    s_waitcnt lgkmcnt(0)
    buffer_store_dword v5, v5, s[8:11], s32 offen sc1
    s_waitcnt vmcnt(0)
    s_memtime s[36:37]
    s_add_u32 s32, s32, 8192
    s_waitcnt lgkmcnt(0)
    s_sub_u32 s36, s36, s34
    s_min_u32 s31, s31, s36
    s_add_u32 s33, s33, 1
    s_cmp_lt_u32 s33, 8
    s_cbranch_scc1 pol_recurrent_scan__memory_aug_recurrent_mem_tr__dense_activation_mish__prompt_kernel_87
    s_cmp_lt_u32 s31, s30
    s_cselect_b32 s33, 3, 2
    v_mov_b32 v6, s33
    buffer_store_dword v6, off, s[24:27], 0 offset:68 sc1
    s_mov_b64 exec, -1
nw0_recurrent_scan__memory_aug_recurrent_mem_tr__dense_activation_mish__prompt_kernel_84:
    s_sub_u32 s7, 31, s5
    s_mul_i32 s7, s7, 6
    s_add_u32 s7, s7, s4
    s_sub_u32 s7, s7, 3
    s_cmp_ge_u32 s7, 32
    s_cbranch_scc1 noln_recurrent_scan__memory_aug_recurrent_mem_tr__dense_activation_mish__prompt_kernel_83
    s_lshl_b32 s6, s3, 5
    s_add_u32 s6, s6, s7
    s_mov_b32 s12, s64
    s_and_b32 s13, s65, 0xffff
    s_mov_b32 s14, 2621440
    s_mov_b32 s15, 0x20000
    v_and_b32 v1, 15, v0
    v_lshrrev_b32 v2, 4, v0
    v_mul_u32_u24 v1, 1280, v1
    v_lshl_add_u32 v1, v2, 4, v1
    s_mul_i32 s30, s6, 20480
    v_lshlrev_b32 v2, 4, v0
    buffer_load_dwordx4 v[16:19], v1, s[12:15], s30 offen offset:0
    buffer_load_dwordx4 v[20:23], v1, s[12:15], s30 offen offset:64
    buffer_load_dwordx4 v[24:27], v1, s[12:15], s30 offen offset:128
    buffer_load_dwordx4 v[28:31], v1, s[12:15], s30 offen offset:192
    buffer_load_dwordx4 v[32:35], v1, s[12:15], s30 offen offset:256
    buffer_load_dwordx4 v[36:39], v1, s[12:15], s30 offen offset:320
    buffer_load_dwordx4 v[40:43], v1, s[12:15], s30 offen offset:384
    buffer_load_dwordx4 v[44:47], v1, s[12:15], s30 offen offset:448
    buffer_load_dwordx4 v[48:51], v1, s[12:15], s30 offen offset:512
    buffer_load_dwordx4 v[52:55], v1, s[12:15], s30 offen offset:576
    buffer_load_dwordx4 v[56:59], v1, s[12:15], s30 offen offset:640
    buffer_load_dwordx4 v[60:63], v1, s[12:15], s30 offen offset:704
    buffer_load_dwordx4 v[64:67], v1, s[12:15], s30 offen offset:768
    buffer_load_dwordx4 v[68:71], v1, s[12:15], s30 offen offset:832
    buffer_load_dwordx4 v[72:75], v1, s[12:15], s30 offen offset:896
    buffer_load_dwordx4 v[76:79], v1, s[12:15], s30 offen offset:960
    buffer_load_dwordx4 v[80:83], v1, s[12:15], s30 offen offset:1024
    buffer_load_dwordx4 v[84:87], v1, s[12:15], s30 offen offset:1088
    buffer_load_dwordx4 v[88:91], v1, s[12:15], s30 offen offset:1152
    buffer_load_dwordx4 v[92:95], v1, s[12:15], s30 offen offset:1216
    s_lshr_b32 s31, s6, 1
    s_mul_i32 s31, s31, 40960
    s_and_b32 s32, s6, 1
    s_lshl_b32 s32, s32, 10
    s_add_u32 s31, s31, s32
    s_add_u32 s31, s31, 0
    v_mov_b32 v4, 0
    v_mov_b32 v5, 0
    v_mov_b32 v6, 0
    v_mov_b32 v7, 0
    s_waitcnt vmcnt(19)
    v_lshlrev_b32 v96, 16, v16
    v_and_b32 v97, 0xffff0000, v16
    v_lshlrev_b32 v98, 16, v17
    v_and_b32 v99, 0xffff0000, v17
    v_lshlrev_b32 v100, 16, v18
    v_and_b32 v101, 0xffff0000, v18
    v_lshlrev_b32 v102, 16, v19
    v_and_b32 v103, 0xffff0000, v19
    v_pk_add_f32 v[4:5], v[4:5], v[96:97]
    v_pk_add_f32 v[6:7], v[6:7], v[98:99]
    v_pk_add_f32 v[4:5], v[4:5], v[100:101]
    v_pk_add_f32 v[6:7], v[6:7], v[102:103]
    s_waitcnt vmcnt(18)
    v_lshlrev_b32 v104, 16, v20
    v_and_b32 v105, 0xffff0000, v20
    v_lshlrev_b32 v106, 16, v21
    v_and_b32 v107, 0xffff0000, v21
    v_lshlrev_b32 v108, 16, v22
    v_and_b32 v109, 0xffff0000, v22
    v_lshlrev_b32 v110, 16, v23
    v_and_b32 v111, 0xffff0000, v23
    v_pk_add_f32 v[4:5], v[4:5], v[104:105]
    v_pk_add_f32 v[6:7], v[6:7], v[106:107]
    v_pk_add_f32 v[4:5], v[4:5], v[108:109]
    v_pk_add_f32 v[6:7], v[6:7], v[110:111]
    s_waitcnt vmcnt(17)
    v_lshlrev_b32 v112, 16, v24
    v_and_b32 v113, 0xffff0000, v24
    v_lshlrev_b32 v114, 16, v25
    v_and_b32 v115, 0xffff0000, v25
    v_lshlrev_b32 v116, 16, v26
    v_and_b32 v117, 0xffff0000, v26
    v_lshlrev_b32 v118, 16, v27
    v_and_b32 v119, 0xffff0000, v27
    v_pk_add_f32 v[4:5], v[4:5], v[112:113]
    v_pk_add_f32 v[6:7], v[6:7], v[114:115]
    v_pk_add_f32 v[4:5], v[4:5], v[116:117]
    v_pk_add_f32 v[6:7], v[6:7], v[118:119]
    s_waitcnt vmcnt(16)
    v_lshlrev_b32 v120, 16, v28
    v_and_b32 v121, 0xffff0000, v28
    v_lshlrev_b32 v122, 16, v29
    v_and_b32 v123, 0xffff0000, v29
    v_lshlrev_b32 v124, 16, v30
    v_and_b32 v125, 0xffff0000, v30
    v_lshlrev_b32 v126, 16, v31
    v_and_b32 v127, 0xffff0000, v31
    v_pk_add_f32 v[4:5], v[4:5], v[120:121]
    v_pk_add_f32 v[6:7], v[6:7], v[122:123]
    v_pk_add_f32 v[4:5], v[4:5], v[124:125]
    v_pk_add_f32 v[6:7], v[6:7], v[126:127]
    s_waitcnt vmcnt(15)
    v_lshlrev_b32 v128, 16, v32
    v_and_b32 v129, 0xffff0000, v32
    v_lshlrev_b32 v130, 16, v33
    v_and_b32 v131, 0xffff0000, v33
    v_lshlrev_b32 v132, 16, v34
    v_and_b32 v133, 0xffff0000, v34
    v_lshlrev_b32 v134, 16, v35
    v_and_b32 v135, 0xffff0000, v35
    v_pk_add_f32 v[4:5], v[4:5], v[128:129]
    v_pk_add_f32 v[6:7], v[6:7], v[130:131]
    v_pk_add_f32 v[4:5], v[4:5], v[132:133]
    v_pk_add_f32 v[6:7], v[6:7], v[134:135]
    s_waitcnt vmcnt(14)
    v_lshlrev_b32 v136, 16, v36
    v_and_b32 v137, 0xffff0000, v36
    v_lshlrev_b32 v138, 16, v37
    v_and_b32 v139, 0xffff0000, v37
    v_lshlrev_b32 v140, 16, v38
    v_and_b32 v141, 0xffff0000, v38
    v_lshlrev_b32 v142, 16, v39
    v_and_b32 v143, 0xffff0000, v39
    v_pk_add_f32 v[4:5], v[4:5], v[136:137]
    v_pk_add_f32 v[6:7], v[6:7], v[138:139]
    v_pk_add_f32 v[4:5], v[4:5], v[140:141]
    v_pk_add_f32 v[6:7], v[6:7], v[142:143]
    s_waitcnt vmcnt(13)
    v_lshlrev_b32 v144, 16, v40
    v_and_b32 v145, 0xffff0000, v40
    v_lshlrev_b32 v146, 16, v41
    v_and_b32 v147, 0xffff0000, v41
    v_lshlrev_b32 v148, 16, v42
    v_and_b32 v149, 0xffff0000, v42
    v_lshlrev_b32 v150, 16, v43
    v_and_b32 v151, 0xffff0000, v43
    v_pk_add_f32 v[4:5], v[4:5], v[144:145]
    v_pk_add_f32 v[6:7], v[6:7], v[146:147]
    v_pk_add_f32 v[4:5], v[4:5], v[148:149]
    v_pk_add_f32 v[6:7], v[6:7], v[150:151]
    s_waitcnt vmcnt(12)
    v_lshlrev_b32 v152, 16, v44
    v_and_b32 v153, 0xffff0000, v44
    v_lshlrev_b32 v154, 16, v45
    v_and_b32 v155, 0xffff0000, v45
    v_lshlrev_b32 v156, 16, v46
    v_and_b32 v157, 0xffff0000, v46
    v_lshlrev_b32 v158, 16, v47
    v_and_b32 v159, 0xffff0000, v47
    v_pk_add_f32 v[4:5], v[4:5], v[152:153]
    v_pk_add_f32 v[6:7], v[6:7], v[154:155]
    v_pk_add_f32 v[4:5], v[4:5], v[156:157]
    v_pk_add_f32 v[6:7], v[6:7], v[158:159]
    s_waitcnt vmcnt(11)
    v_lshlrev_b32 v160, 16, v48
    v_and_b32 v161, 0xffff0000, v48
    v_lshlrev_b32 v162, 16, v49
    v_and_b32 v163, 0xffff0000, v49
    v_lshlrev_b32 v164, 16, v50
    v_and_b32 v165, 0xffff0000, v50
    v_lshlrev_b32 v166, 16, v51
    v_and_b32 v167, 0xffff0000, v51
    v_pk_add_f32 v[4:5], v[4:5], v[160:161]
    v_pk_add_f32 v[6:7], v[6:7], v[162:163]
    v_pk_add_f32 v[4:5], v[4:5], v[164:165]
    v_pk_add_f32 v[6:7], v[6:7], v[166:167]
    s_waitcnt vmcnt(10)
    v_lshlrev_b32 v168, 16, v52
    v_and_b32 v169, 0xffff0000, v52
    v_lshlrev_b32 v170, 16, v53
    v_and_b32 v171, 0xffff0000, v53
    v_lshlrev_b32 v172, 16, v54
    v_and_b32 v173, 0xffff0000, v54
    v_lshlrev_b32 v174, 16, v55
    v_and_b32 v175, 0xffff0000, v55
    v_pk_add_f32 v[4:5], v[4:5], v[168:169]
    v_pk_add_f32 v[6:7], v[6:7], v[170:171]
    v_pk_add_f32 v[4:5], v[4:5], v[172:173]
    v_pk_add_f32 v[6:7], v[6:7], v[174:175]
    s_waitcnt vmcnt(9)
    v_lshlrev_b32 v176, 16, v56
    v_and_b32 v177, 0xffff0000, v56
    v_lshlrev_b32 v178, 16, v57
    v_and_b32 v179, 0xffff0000, v57
    v_lshlrev_b32 v180, 16, v58
    v_and_b32 v181, 0xffff0000, v58
    v_lshlrev_b32 v182, 16, v59
    v_and_b32 v183, 0xffff0000, v59
    v_pk_add_f32 v[4:5], v[4:5], v[176:177]
    v_pk_add_f32 v[6:7], v[6:7], v[178:179]
    v_pk_add_f32 v[4:5], v[4:5], v[180:181]
    v_pk_add_f32 v[6:7], v[6:7], v[182:183]
    s_waitcnt vmcnt(8)
    v_lshlrev_b32 v184, 16, v60
    v_and_b32 v185, 0xffff0000, v60
    v_lshlrev_b32 v186, 16, v61
    v_and_b32 v187, 0xffff0000, v61
    v_lshlrev_b32 v188, 16, v62
    v_and_b32 v189, 0xffff0000, v62
    v_lshlrev_b32 v190, 16, v63
    v_and_b32 v191, 0xffff0000, v63
    v_pk_add_f32 v[4:5], v[4:5], v[184:185]
    v_pk_add_f32 v[6:7], v[6:7], v[186:187]
    v_pk_add_f32 v[4:5], v[4:5], v[188:189]
    v_pk_add_f32 v[6:7], v[6:7], v[190:191]
    s_waitcnt vmcnt(7)
    v_lshlrev_b32 v192, 16, v64
    v_and_b32 v193, 0xffff0000, v64
    v_lshlrev_b32 v194, 16, v65
    v_and_b32 v195, 0xffff0000, v65
    v_lshlrev_b32 v196, 16, v66
    v_and_b32 v197, 0xffff0000, v66
    v_lshlrev_b32 v198, 16, v67
    v_and_b32 v199, 0xffff0000, v67
    v_pk_add_f32 v[4:5], v[4:5], v[192:193]
    v_pk_add_f32 v[6:7], v[6:7], v[194:195]
    v_pk_add_f32 v[4:5], v[4:5], v[196:197]
    v_pk_add_f32 v[6:7], v[6:7], v[198:199]
    s_waitcnt vmcnt(6)
    v_lshlrev_b32 v200, 16, v68
    v_and_b32 v201, 0xffff0000, v68
    v_lshlrev_b32 v202, 16, v69
    v_and_b32 v203, 0xffff0000, v69
    v_lshlrev_b32 v204, 16, v70
    v_and_b32 v205, 0xffff0000, v70
    v_lshlrev_b32 v206, 16, v71
    v_and_b32 v207, 0xffff0000, v71
    v_pk_add_f32 v[4:5], v[4:5], v[200:201]
    v_pk_add_f32 v[6:7], v[6:7], v[202:203]
    v_pk_add_f32 v[4:5], v[4:5], v[204:205]
    v_pk_add_f32 v[6:7], v[6:7], v[206:207]
    s_waitcnt vmcnt(5)
    v_lshlrev_b32 v208, 16, v72
    v_and_b32 v209, 0xffff0000, v72
    v_lshlrev_b32 v210, 16, v73
    v_and_b32 v211, 0xffff0000, v73
    v_lshlrev_b32 v212, 16, v74
    v_and_b32 v213, 0xffff0000, v74
    v_lshlrev_b32 v214, 16, v75
    v_and_b32 v215, 0xffff0000, v75
    v_pk_add_f32 v[4:5], v[4:5], v[208:209]
    v_pk_add_f32 v[6:7], v[6:7], v[210:211]
    v_pk_add_f32 v[4:5], v[4:5], v[212:213]
    v_pk_add_f32 v[6:7], v[6:7], v[214:215]
    s_waitcnt vmcnt(4)
    v_lshlrev_b32 v216, 16, v76
    v_and_b32 v217, 0xffff0000, v76
    v_lshlrev_b32 v218, 16, v77
    v_and_b32 v219, 0xffff0000, v77
    v_lshlrev_b32 v220, 16, v78
    v_and_b32 v221, 0xffff0000, v78
    v_lshlrev_b32 v222, 16, v79
    v_and_b32 v223, 0xffff0000, v79
    v_pk_add_f32 v[4:5], v[4:5], v[216:217]
    v_pk_add_f32 v[6:7], v[6:7], v[218:219]
    v_pk_add_f32 v[4:5], v[4:5], v[220:221]
    v_pk_add_f32 v[6:7], v[6:7], v[222:223]
    s_waitcnt vmcnt(3)
    v_lshlrev_b32 v224, 16, v80
    v_and_b32 v225, 0xffff0000, v80
    v_lshlrev_b32 v226, 16, v81
    v_and_b32 v227, 0xffff0000, v81
    v_lshlrev_b32 v228, 16, v82
    v_and_b32 v229, 0xffff0000, v82
    v_lshlrev_b32 v230, 16, v83
    v_and_b32 v231, 0xffff0000, v83
    v_pk_add_f32 v[4:5], v[4:5], v[224:225]
    v_pk_add_f32 v[6:7], v[6:7], v[226:227]
    v_pk_add_f32 v[4:5], v[4:5], v[228:229]
    v_pk_add_f32 v[6:7], v[6:7], v[230:231]
    s_waitcnt vmcnt(2)
    v_lshlrev_b32 v232, 16, v84
    v_and_b32 v233, 0xffff0000, v84
    v_lshlrev_b32 v234, 16, v85
    v_and_b32 v235, 0xffff0000, v85
    v_lshlrev_b32 v236, 16, v86
    v_and_b32 v237, 0xffff0000, v86
    v_lshlrev_b32 v238, 16, v87
    v_and_b32 v239, 0xffff0000, v87
    v_pk_add_f32 v[4:5], v[4:5], v[232:233]
    v_pk_add_f32 v[6:7], v[6:7], v[234:235]
    v_pk_add_f32 v[4:5], v[4:5], v[236:237]
    v_pk_add_f32 v[6:7], v[6:7], v[238:239]
    s_waitcnt vmcnt(1)
    v_lshlrev_b32 v240, 16, v88
    v_and_b32 v241, 0xffff0000, v88
    v_lshlrev_b32 v242, 16, v89
    v_and_b32 v243, 0xffff0000, v89
    v_lshlrev_b32 v244, 16, v90
    v_and_b32 v245, 0xffff0000, v90
    v_lshlrev_b32 v246, 16, v91
    v_and_b32 v247, 0xffff0000, v91
    v_pk_add_f32 v[4:5], v[4:5], v[240:241]
    v_pk_add_f32 v[6:7], v[6:7], v[242:243]
    v_pk_add_f32 v[4:5], v[4:5], v[244:245]
    v_pk_add_f32 v[6:7], v[6:7], v[246:247]
    s_waitcnt vmcnt(0)
    v_lshlrev_b32 v248, 16, v92
    v_and_b32 v249, 0xffff0000, v92
    v_lshlrev_b32 v250, 16, v93
    v_and_b32 v251, 0xffff0000, v93
    v_lshlrev_b32 v252, 16, v94
    v_and_b32 v253, 0xffff0000, v94
    v_lshlrev_b32 v254, 16, v95
    v_and_b32 v255, 0xffff0000, v95
    v_pk_add_f32 v[4:5], v[4:5], v[248:249]
    v_pk_add_f32 v[6:7], v[6:7], v[250:251]
    v_pk_add_f32 v[4:5], v[4:5], v[252:253]
    v_pk_add_f32 v[6:7], v[6:7], v[254:255]
    v_pk_add_f32 v[4:5], v[4:5], v[6:7]
    v_add_f32 v4, v4, v5
    v_mov_b32 v5, v4
    s_nop 1
    v_permlane32_swap_b32 v4, v5
    v_add_f32 v4, v4, v5
    v_mov_b32 v5, v4
    s_nop 1
    v_permlane16_swap_b32 v4, v5
    v_add_f32 v4, v4, v5
    v_mul_f32 v4, 0x3acccccd, v4
    v_mov_b32 v5, v4
    v_mov_b32 v8, 0
    v_mov_b32 v9, 0
    v_mov_b32 v10, 0
    v_mov_b32 v11, 0
    v_pk_add_f32 v[12:13], v[96:97], v[4:5] neg_lo:[0,1] neg_hi:[0,1]
    v_pk_fma_f32 v[8:9], v[12:13], v[12:13], v[8:9]
    v_pk_add_f32 v[14:15], v[98:99], v[4:5] neg_lo:[0,1] neg_hi:[0,1]
    v_pk_fma_f32 v[10:11], v[14:15], v[14:15], v[10:11]
    v_pk_add_f32 v[12:13], v[100:101], v[4:5] neg_lo:[0,1] neg_hi:[0,1]
    v_pk_fma_f32 v[8:9], v[12:13], v[12:13], v[8:9]
    v_pk_add_f32 v[14:15], v[102:103], v[4:5] neg_lo:[0,1] neg_hi:[0,1]
    v_pk_fma_f32 v[10:11], v[14:15], v[14:15], v[10:11]
    v_pk_add_f32 v[12:13], v[104:105], v[4:5] neg_lo:[0,1] neg_hi:[0,1]
    v_pk_fma_f32 v[8:9], v[12:13], v[12:13], v[8:9]
    v_pk_add_f32 v[14:15], v[106:107], v[4:5] neg_lo:[0,1] neg_hi:[0,1]
    v_pk_fma_f32 v[10:11], v[14:15], v[14:15], v[10:11]
    v_pk_add_f32 v[12:13], v[108:109], v[4:5] neg_lo:[0,1] neg_hi:[0,1]
    v_pk_fma_f32 v[8:9], v[12:13], v[12:13], v[8:9]
    v_pk_add_f32 v[14:15], v[110:111], v[4:5] neg_lo:[0,1] neg_hi:[0,1]
    v_pk_fma_f32 v[10:11], v[14:15], v[14:15], v[10:11]
    v_pk_add_f32 v[12:13], v[112:113], v[4:5] neg_lo:[0,1] neg_hi:[0,1]
    v_pk_fma_f32 v[8:9], v[12:13], v[12:13], v[8:9]
    v_pk_add_f32 v[14:15], v[114:115], v[4:5] neg_lo:[0,1] neg_hi:[0,1]
    v_pk_fma_f32 v[10:11], v[14:15], v[14:15], v[10:11]
    v_pk_add_f32 v[12:13], v[116:117], v[4:5] neg_lo:[0,1] neg_hi:[0,1]
    v_pk_fma_f32 v[8:9], v[12:13], v[12:13], v[8:9]
    v_pk_add_f32 v[14:15], v[118:119], v[4:5] neg_lo:[0,1] neg_hi:[0,1]
    v_pk_fma_f32 v[10:11], v[14:15], v[14:15], v[10:11]
    v_pk_add_f32 v[12:13], v[120:121], v[4:5] neg_lo:[0,1] neg_hi:[0,1]
    v_pk_fma_f32 v[8:9], v[12:13], v[12:13], v[8:9]
    v_pk_add_f32 v[14:15], v[122:123], v[4:5] neg_lo:[0,1] neg_hi:[0,1]
    v_pk_fma_f32 v[10:11], v[14:15], v[14:15], v[10:11]
    v_pk_add_f32 v[12:13], v[124:125], v[4:5] neg_lo:[0,1] neg_hi:[0,1]
    v_pk_fma_f32 v[8:9], v[12:13], v[12:13], v[8:9]
    v_pk_add_f32 v[14:15], v[126:127], v[4:5] neg_lo:[0,1] neg_hi:[0,1]
    v_pk_fma_f32 v[10:11], v[14:15], v[14:15], v[10:11]
    v_pk_add_f32 v[12:13], v[128:129], v[4:5] neg_lo:[0,1] neg_hi:[0,1]
    v_pk_fma_f32 v[8:9], v[12:13], v[12:13], v[8:9]
    v_pk_add_f32 v[14:15], v[130:131], v[4:5] neg_lo:[0,1] neg_hi:[0,1]
    v_pk_fma_f32 v[10:11], v[14:15], v[14:15], v[10:11]
    v_pk_add_f32 v[12:13], v[132:133], v[4:5] neg_lo:[0,1] neg_hi:[0,1]
    v_pk_fma_f32 v[8:9], v[12:13], v[12:13], v[8:9]
    v_pk_add_f32 v[14:15], v[134:135], v[4:5] neg_lo:[0,1] neg_hi:[0,1]
    v_pk_fma_f32 v[10:11], v[14:15], v[14:15], v[10:11]
    v_pk_add_f32 v[12:13], v[136:137], v[4:5] neg_lo:[0,1] neg_hi:[0,1]
    v_pk_fma_f32 v[8:9], v[12:13], v[12:13], v[8:9]
    v_pk_add_f32 v[14:15], v[138:139], v[4:5] neg_lo:[0,1] neg_hi:[0,1]
    v_pk_fma_f32 v[10:11], v[14:15], v[14:15], v[10:11]
    v_pk_add_f32 v[12:13], v[140:141], v[4:5] neg_lo:[0,1] neg_hi:[0,1]
    v_pk_fma_f32 v[8:9], v[12:13], v[12:13], v[8:9]
    v_pk_add_f32 v[14:15], v[142:143], v[4:5] neg_lo:[0,1] neg_hi:[0,1]
    v_pk_fma_f32 v[10:11], v[14:15], v[14:15], v[10:11]
    v_pk_add_f32 v[12:13], v[144:145], v[4:5] neg_lo:[0,1] neg_hi:[0,1]
    v_pk_fma_f32 v[8:9], v[12:13], v[12:13], v[8:9]
    v_pk_add_f32 v[14:15], v[146:147], v[4:5] neg_lo:[0,1] neg_hi:[0,1]
    v_pk_fma_f32 v[10:11], v[14:15], v[14:15], v[10:11]
    v_pk_add_f32 v[12:13], v[148:149], v[4:5] neg_lo:[0,1] neg_hi:[0,1]
    v_pk_fma_f32 v[8:9], v[12:13], v[12:13], v[8:9]
    v_pk_add_f32 v[14:15], v[150:151], v[4:5] neg_lo:[0,1] neg_hi:[0,1]
    v_pk_fma_f32 v[10:11], v[14:15], v[14:15], v[10:11]
    v_pk_add_f32 v[12:13], v[152:153], v[4:5] neg_lo:[0,1] neg_hi:[0,1]
    v_pk_fma_f32 v[8:9], v[12:13], v[12:13], v[8:9]
    v_pk_add_f32 v[14:15], v[154:155], v[4:5] neg_lo:[0,1] neg_hi:[0,1]
    v_pk_fma_f32 v[10:11], v[14:15], v[14:15], v[10:11]
    v_pk_add_f32 v[12:13], v[156:157], v[4:5] neg_lo:[0,1] neg_hi:[0,1]
    v_pk_fma_f32 v[8:9], v[12:13], v[12:13], v[8:9]
    v_pk_add_f32 v[14:15], v[158:159], v[4:5] neg_lo:[0,1] neg_hi:[0,1]
    v_pk_fma_f32 v[10:11], v[14:15], v[14:15], v[10:11]
    v_pk_add_f32 v[12:13], v[160:161], v[4:5] neg_lo:[0,1] neg_hi:[0,1]
    v_pk_fma_f32 v[8:9], v[12:13], v[12:13], v[8:9]
    v_pk_add_f32 v[14:15], v[162:163], v[4:5] neg_lo:[0,1] neg_hi:[0,1]
    v_pk_fma_f32 v[10:11], v[14:15], v[14:15], v[10:11]
    v_pk_add_f32 v[12:13], v[164:165], v[4:5] neg_lo:[0,1] neg_hi:[0,1]
    v_pk_fma_f32 v[8:9], v[12:13], v[12:13], v[8:9]
    v_pk_add_f32 v[14:15], v[166:167], v[4:5] neg_lo:[0,1] neg_hi:[0,1]
    v_pk_fma_f32 v[10:11], v[14:15], v[14:15], v[10:11]
    v_pk_add_f32 v[12:13], v[168:169], v[4:5] neg_lo:[0,1] neg_hi:[0,1]
    v_pk_fma_f32 v[8:9], v[12:13], v[12:13], v[8:9]
    v_pk_add_f32 v[14:15], v[170:171], v[4:5] neg_lo:[0,1] neg_hi:[0,1]
    v_pk_fma_f32 v[10:11], v[14:15], v[14:15], v[10:11]
    v_pk_add_f32 v[12:13], v[172:173], v[4:5] neg_lo:[0,1] neg_hi:[0,1]
    v_pk_fma_f32 v[8:9], v[12:13], v[12:13], v[8:9]
    v_pk_add_f32 v[14:15], v[174:175], v[4:5] neg_lo:[0,1] neg_hi:[0,1]
    v_pk_fma_f32 v[10:11], v[14:15], v[14:15], v[10:11]
    v_pk_add_f32 v[12:13], v[176:177], v[4:5] neg_lo:[0,1] neg_hi:[0,1]
    v_pk_fma_f32 v[8:9], v[12:13], v[12:13], v[8:9]
    v_pk_add_f32 v[14:15], v[178:179], v[4:5] neg_lo:[0,1] neg_hi:[0,1]
    v_pk_fma_f32 v[10:11], v[14:15], v[14:15], v[10:11]
    v_pk_add_f32 v[12:13], v[180:181], v[4:5] neg_lo:[0,1] neg_hi:[0,1]
    v_pk_fma_f32 v[8:9], v[12:13], v[12:13], v[8:9]
    v_pk_add_f32 v[14:15], v[182:183], v[4:5] neg_lo:[0,1] neg_hi:[0,1]
    v_pk_fma_f32 v[10:11], v[14:15], v[14:15], v[10:11]
    v_pk_add_f32 v[12:13], v[184:185], v[4:5] neg_lo:[0,1] neg_hi:[0,1]
    v_pk_fma_f32 v[8:9], v[12:13], v[12:13], v[8:9]
    v_pk_add_f32 v[14:15], v[186:187], v[4:5] neg_lo:[0,1] neg_hi:[0,1]
    v_pk_fma_f32 v[10:11], v[14:15], v[14:15], v[10:11]
    v_pk_add_f32 v[12:13], v[188:189], v[4:5] neg_lo:[0,1] neg_hi:[0,1]
    v_pk_fma_f32 v[8:9], v[12:13], v[12:13], v[8:9]
    v_pk_add_f32 v[14:15], v[190:191], v[4:5] neg_lo:[0,1] neg_hi:[0,1]
    v_pk_fma_f32 v[10:11], v[14:15], v[14:15], v[10:11]
    v_pk_add_f32 v[12:13], v[192:193], v[4:5] neg_lo:[0,1] neg_hi:[0,1]
    v_pk_fma_f32 v[8:9], v[12:13], v[12:13], v[8:9]
    v_pk_add_f32 v[14:15], v[194:195], v[4:5] neg_lo:[0,1] neg_hi:[0,1]
    v_pk_fma_f32 v[10:11], v[14:15], v[14:15], v[10:11]
    v_pk_add_f32 v[12:13], v[196:197], v[4:5] neg_lo:[0,1] neg_hi:[0,1]
    v_pk_fma_f32 v[8:9], v[12:13], v[12:13], v[8:9]
    v_pk_add_f32 v[14:15], v[198:199], v[4:5] neg_lo:[0,1] neg_hi:[0,1]
    v_pk_fma_f32 v[10:11], v[14:15], v[14:15], v[10:11]
    v_pk_add_f32 v[12:13], v[200:201], v[4:5] neg_lo:[0,1] neg_hi:[0,1]
    v_pk_fma_f32 v[8:9], v[12:13], v[12:13], v[8:9]
    v_pk_add_f32 v[14:15], v[202:203], v[4:5] neg_lo:[0,1] neg_hi:[0,1]
    v_pk_fma_f32 v[10:11], v[14:15], v[14:15], v[10:11]
    v_pk_add_f32 v[12:13], v[204:205], v[4:5] neg_lo:[0,1] neg_hi:[0,1]
    v_pk_fma_f32 v[8:9], v[12:13], v[12:13], v[8:9]
    v_pk_add_f32 v[14:15], v[206:207], v[4:5] neg_lo:[0,1] neg_hi:[0,1]
    v_pk_fma_f32 v[10:11], v[14:15], v[14:15], v[10:11]
    v_pk_add_f32 v[12:13], v[208:209], v[4:5] neg_lo:[0,1] neg_hi:[0,1]
    v_pk_fma_f32 v[8:9], v[12:13], v[12:13], v[8:9]
    v_pk_add_f32 v[14:15], v[210:211], v[4:5] neg_lo:[0,1] neg_hi:[0,1]
    v_pk_fma_f32 v[10:11], v[14:15], v[14:15], v[10:11]
    v_pk_add_f32 v[12:13], v[212:213], v[4:5] neg_lo:[0,1] neg_hi:[0,1]
    v_pk_fma_f32 v[8:9], v[12:13], v[12:13], v[8:9]
    v_pk_add_f32 v[14:15], v[214:215], v[4:5] neg_lo:[0,1] neg_hi:[0,1]
    v_pk_fma_f32 v[10:11], v[14:15], v[14:15], v[10:11]
    v_pk_add_f32 v[12:13], v[216:217], v[4:5] neg_lo:[0,1] neg_hi:[0,1]
    v_pk_fma_f32 v[8:9], v[12:13], v[12:13], v[8:9]
    v_pk_add_f32 v[14:15], v[218:219], v[4:5] neg_lo:[0,1] neg_hi:[0,1]
    v_pk_fma_f32 v[10:11], v[14:15], v[14:15], v[10:11]
    v_pk_add_f32 v[12:13], v[220:221], v[4:5] neg_lo:[0,1] neg_hi:[0,1]
    v_pk_fma_f32 v[8:9], v[12:13], v[12:13], v[8:9]
    v_pk_add_f32 v[14:15], v[222:223], v[4:5] neg_lo:[0,1] neg_hi:[0,1]
    v_pk_fma_f32 v[10:11], v[14:15], v[14:15], v[10:11]
    v_pk_add_f32 v[12:13], v[224:225], v[4:5] neg_lo:[0,1] neg_hi:[0,1]
    v_pk_fma_f32 v[8:9], v[12:13], v[12:13], v[8:9]
    v_pk_add_f32 v[14:15], v[226:227], v[4:5] neg_lo:[0,1] neg_hi:[0,1]
    v_pk_fma_f32 v[10:11], v[14:15], v[14:15], v[10:11]
    v_pk_add_f32 v[12:13], v[228:229], v[4:5] neg_lo:[0,1] neg_hi:[0,1]
    v_pk_fma_f32 v[8:9], v[12:13], v[12:13], v[8:9]
    v_pk_add_f32 v[14:15], v[230:231], v[4:5] neg_lo:[0,1] neg_hi:[0,1]
    v_pk_fma_f32 v[10:11], v[14:15], v[14:15], v[10:11]
    v_pk_add_f32 v[12:13], v[232:233], v[4:5] neg_lo:[0,1] neg_hi:[0,1]
    v_pk_fma_f32 v[8:9], v[12:13], v[12:13], v[8:9]
    v_pk_add_f32 v[14:15], v[234:235], v[4:5] neg_lo:[0,1] neg_hi:[0,1]
    v_pk_fma_f32 v[10:11], v[14:15], v[14:15], v[10:11]
    v_pk_add_f32 v[12:13], v[236:237], v[4:5] neg_lo:[0,1] neg_hi:[0,1]
    v_pk_fma_f32 v[8:9], v[12:13], v[12:13], v[8:9]
    v_pk_add_f32 v[14:15], v[238:239], v[4:5] neg_lo:[0,1] neg_hi:[0,1]
    v_pk_fma_f32 v[10:11], v[14:15], v[14:15], v[10:11]
    v_pk_add_f32 v[12:13], v[240:241], v[4:5] neg_lo:[0,1] neg_hi:[0,1]
    v_pk_fma_f32 v[8:9], v[12:13], v[12:13], v[8:9]
    v_pk_add_f32 v[14:15], v[242:243], v[4:5] neg_lo:[0,1] neg_hi:[0,1]
    v_pk_fma_f32 v[10:11], v[14:15], v[14:15], v[10:11]
    v_pk_add_f32 v[12:13], v[244:245], v[4:5] neg_lo:[0,1] neg_hi:[0,1]
    v_pk_fma_f32 v[8:9], v[12:13], v[12:13], v[8:9]
    v_pk_add_f32 v[14:15], v[246:247], v[4:5] neg_lo:[0,1] neg_hi:[0,1]
    v_pk_fma_f32 v[10:11], v[14:15], v[14:15], v[10:11]
    v_pk_add_f32 v[12:13], v[248:249], v[4:5] neg_lo:[0,1] neg_hi:[0,1]
    v_pk_fma_f32 v[8:9], v[12:13], v[12:13], v[8:9]
    v_pk_add_f32 v[14:15], v[250:251], v[4:5] neg_lo:[0,1] neg_hi:[0,1]
    v_pk_fma_f32 v[10:11], v[14:15], v[14:15], v[10:11]
    v_pk_add_f32 v[12:13], v[252:253], v[4:5] neg_lo:[0,1] neg_hi:[0,1]
    v_pk_fma_f32 v[8:9], v[12:13], v[12:13], v[8:9]
    v_pk_add_f32 v[14:15], v[254:255], v[4:5] neg_lo:[0,1] neg_hi:[0,1]
    v_pk_fma_f32 v[10:11], v[14:15], v[14:15], v[10:11]
    v_pk_add_f32 v[8:9], v[8:9], v[10:11]
    v_add_f32 v8, v8, v9
    v_mov_b32 v9, v8
    s_nop 1
    v_permlane32_swap_b32 v8, v9
    v_add_f32 v8, v8, v9
    v_mov_b32 v9, v8
    s_nop 1
    v_permlane16_swap_b32 v8, v9
    v_add_f32 v8, v8, v9
    v_mul_f32 v8, 0x3acccccd, v8
    v_cvt_pk_bf16_f32 v8, v8, v8
    v_lshlrev_b32 v8, 16, v8
    v_add_f32 v8, 0x3727c5ac, v8
    v_cvt_pk_bf16_f32 v8, v8, v8
    v_lshlrev_b32 v8, 16, v8
    v_sqrt_f32 v8, v8
    s_nop 0
    v_cvt_pk_bf16_f32 v8, v8, v8
    v_lshlrev_b32 v8, 16, v8
    v_rcp_f32 v8, v8
    v_cvt_pk_bf16_f32 v4, v4, v4
    v_lshlrev_b32 v4, 16, v4
    v_mov_b32 v5, v4
    v_mov_b32 v9, v8
    v_pk_add_f32 v[96:97], v[96:97], v[4:5] neg_lo:[0,1] neg_hi:[0,1]
    v_cvt_pk_bf16_f32 v16, v96, v97
    v_lshlrev_b32 v96, 16, v16
    v_and_b32 v97, 0xffff0000, v16
    v_pk_mul_f32 v[96:97], v[96:97], v[8:9]
    v_cvt_pk_bf16_f32 v16, v96, v97
    v_pk_add_f32 v[98:99], v[98:99], v[4:5] neg_lo:[0,1] neg_hi:[0,1]
    v_cvt_pk_bf16_f32 v17, v98, v99
    v_lshlrev_b32 v98, 16, v17
    v_and_b32 v99, 0xffff0000, v17
    v_pk_mul_f32 v[98:99], v[98:99], v[8:9]
    v_cvt_pk_bf16_f32 v17, v98, v99
    v_pk_add_f32 v[100:101], v[100:101], v[4:5] neg_lo:[0,1] neg_hi:[0,1]
    v_cvt_pk_bf16_f32 v18, v100, v101
    v_lshlrev_b32 v100, 16, v18
    v_and_b32 v101, 0xffff0000, v18
    v_pk_mul_f32 v[100:101], v[100:101], v[8:9]
    v_cvt_pk_bf16_f32 v18, v100, v101
    v_pk_add_f32 v[102:103], v[102:103], v[4:5] neg_lo:[0,1] neg_hi:[0,1]
    v_cvt_pk_bf16_f32 v19, v102, v103
    v_lshlrev_b32 v102, 16, v19
    v_and_b32 v103, 0xffff0000, v19
    v_pk_mul_f32 v[102:103], v[102:103], v[8:9]
    v_cvt_pk_bf16_f32 v19, v102, v103
    buffer_store_dwordx4 v[16:19], v2, s[8:11], s31 offen offset:0 sc1
    v_pk_add_f32 v[104:105], v[104:105], v[4:5] neg_lo:[0,1] neg_hi:[0,1]
    v_cvt_pk_bf16_f32 v20, v104, v105
    v_lshlrev_b32 v104, 16, v20
    v_and_b32 v105, 0xffff0000, v20
    v_pk_mul_f32 v[104:105], v[104:105], v[8:9]
    v_cvt_pk_bf16_f32 v20, v104, v105
    v_pk_add_f32 v[106:107], v[106:107], v[4:5] neg_lo:[0,1] neg_hi:[0,1]
    v_cvt_pk_bf16_f32 v21, v106, v107
    v_lshlrev_b32 v106, 16, v21
    v_and_b32 v107, 0xffff0000, v21
    v_pk_mul_f32 v[106:107], v[106:107], v[8:9]
    v_cvt_pk_bf16_f32 v21, v106, v107
    v_pk_add_f32 v[108:109], v[108:109], v[4:5] neg_lo:[0,1] neg_hi:[0,1]
    v_cvt_pk_bf16_f32 v22, v108, v109
    v_lshlrev_b32 v108, 16, v22
    v_and_b32 v109, 0xffff0000, v22
    v_pk_mul_f32 v[108:109], v[108:109], v[8:9]
    v_cvt_pk_bf16_f32 v22, v108, v109
    v_pk_add_f32 v[110:111], v[110:111], v[4:5] neg_lo:[0,1] neg_hi:[0,1]
    v_cvt_pk_bf16_f32 v23, v110, v111
    v_lshlrev_b32 v110, 16, v23
    v_and_b32 v111, 0xffff0000, v23
    v_pk_mul_f32 v[110:111], v[110:111], v[8:9]
    v_cvt_pk_bf16_f32 v23, v110, v111
    buffer_store_dwordx4 v[20:23], v2, s[8:11], s31 offen offset:2048 sc1
    v_pk_add_f32 v[112:113], v[112:113], v[4:5] neg_lo:[0,1] neg_hi:[0,1]
    v_cvt_pk_bf16_f32 v24, v112, v113
    v_lshlrev_b32 v112, 16, v24
    v_and_b32 v113, 0xffff0000, v24
    v_pk_mul_f32 v[112:113], v[112:113], v[8:9]
    v_cvt_pk_bf16_f32 v24, v112, v113
    v_pk_add_f32 v[114:115], v[114:115], v[4:5] neg_lo:[0,1] neg_hi:[0,1]
    v_cvt_pk_bf16_f32 v25, v114, v115
    v_lshlrev_b32 v114, 16, v25
    v_and_b32 v115, 0xffff0000, v25
    v_pk_mul_f32 v[114:115], v[114:115], v[8:9]
    v_cvt_pk_bf16_f32 v25, v114, v115
    v_pk_add_f32 v[116:117], v[116:117], v[4:5] neg_lo:[0,1] neg_hi:[0,1]
    v_cvt_pk_bf16_f32 v26, v116, v117
    v_lshlrev_b32 v116, 16, v26
    v_and_b32 v117, 0xffff0000, v26
    v_pk_mul_f32 v[116:117], v[116:117], v[8:9]
    v_cvt_pk_bf16_f32 v26, v116, v117
    v_pk_add_f32 v[118:119], v[118:119], v[4:5] neg_lo:[0,1] neg_hi:[0,1]
    v_cvt_pk_bf16_f32 v27, v118, v119
    v_lshlrev_b32 v118, 16, v27
    v_and_b32 v119, 0xffff0000, v27
    v_pk_mul_f32 v[118:119], v[118:119], v[8:9]
    v_cvt_pk_bf16_f32 v27, v118, v119
    s_add_u32 s31, s31, 4096
    buffer_store_dwordx4 v[24:27], v2, s[8:11], s31 offen offset:0 sc1
    v_pk_add_f32 v[120:121], v[120:121], v[4:5] neg_lo:[0,1] neg_hi:[0,1]
    v_cvt_pk_bf16_f32 v28, v120, v121
    v_lshlrev_b32 v120, 16, v28
    v_and_b32 v121, 0xffff0000, v28
    v_pk_mul_f32 v[120:121], v[120:121], v[8:9]
    v_cvt_pk_bf16_f32 v28, v120, v121
    v_pk_add_f32 v[122:123], v[122:123], v[4:5] neg_lo:[0,1] neg_hi:[0,1]
    v_cvt_pk_bf16_f32 v29, v122, v123
    v_lshlrev_b32 v122, 16, v29
    v_and_b32 v123, 0xffff0000, v29
    v_pk_mul_f32 v[122:123], v[122:123], v[8:9]
    v_cvt_pk_bf16_f32 v29, v122, v123
    v_pk_add_f32 v[124:125], v[124:125], v[4:5] neg_lo:[0,1] neg_hi:[0,1]
    v_cvt_pk_bf16_f32 v30, v124, v125
    v_lshlrev_b32 v124, 16, v30
    v_and_b32 v125, 0xffff0000, v30
    v_pk_mul_f32 v[124:125], v[124:125], v[8:9]
    v_cvt_pk_bf16_f32 v30, v124, v125
    v_pk_add_f32 v[126:127], v[126:127], v[4:5] neg_lo:[0,1] neg_hi:[0,1]
    v_cvt_pk_bf16_f32 v31, v126, v127
    v_lshlrev_b32 v126, 16, v31
    v_and_b32 v127, 0xffff0000, v31
    v_pk_mul_f32 v[126:127], v[126:127], v[8:9]
    v_cvt_pk_bf16_f32 v31, v126, v127
    buffer_store_dwordx4 v[28:31], v2, s[8:11], s31 offen offset:2048 sc1
    v_pk_add_f32 v[128:129], v[128:129], v[4:5] neg_lo:[0,1] neg_hi:[0,1]
    v_cvt_pk_bf16_f32 v32, v128, v129
    v_lshlrev_b32 v128, 16, v32
    v_and_b32 v129, 0xffff0000, v32
    v_pk_mul_f32 v[128:129], v[128:129], v[8:9]
    v_cvt_pk_bf16_f32 v32, v128, v129
    v_pk_add_f32 v[130:131], v[130:131], v[4:5] neg_lo:[0,1] neg_hi:[0,1]
    v_cvt_pk_bf16_f32 v33, v130, v131
    v_lshlrev_b32 v130, 16, v33
    v_and_b32 v131, 0xffff0000, v33
    v_pk_mul_f32 v[130:131], v[130:131], v[8:9]
    v_cvt_pk_bf16_f32 v33, v130, v131
    v_pk_add_f32 v[132:133], v[132:133], v[4:5] neg_lo:[0,1] neg_hi:[0,1]
    v_cvt_pk_bf16_f32 v34, v132, v133
    v_lshlrev_b32 v132, 16, v34
    v_and_b32 v133, 0xffff0000, v34
    v_pk_mul_f32 v[132:133], v[132:133], v[8:9]
    v_cvt_pk_bf16_f32 v34, v132, v133
    v_pk_add_f32 v[134:135], v[134:135], v[4:5] neg_lo:[0,1] neg_hi:[0,1]
    v_cvt_pk_bf16_f32 v35, v134, v135
    v_lshlrev_b32 v134, 16, v35
    v_and_b32 v135, 0xffff0000, v35
    v_pk_mul_f32 v[134:135], v[134:135], v[8:9]
    v_cvt_pk_bf16_f32 v35, v134, v135
    s_add_u32 s31, s31, 4096
    buffer_store_dwordx4 v[32:35], v2, s[8:11], s31 offen offset:0 sc1
    v_pk_add_f32 v[136:137], v[136:137], v[4:5] neg_lo:[0,1] neg_hi:[0,1]
    v_cvt_pk_bf16_f32 v36, v136, v137
    v_lshlrev_b32 v136, 16, v36
    v_and_b32 v137, 0xffff0000, v36
    v_pk_mul_f32 v[136:137], v[136:137], v[8:9]
    v_cvt_pk_bf16_f32 v36, v136, v137
    v_pk_add_f32 v[138:139], v[138:139], v[4:5] neg_lo:[0,1] neg_hi:[0,1]
    v_cvt_pk_bf16_f32 v37, v138, v139
    v_lshlrev_b32 v138, 16, v37
    v_and_b32 v139, 0xffff0000, v37
    v_pk_mul_f32 v[138:139], v[138:139], v[8:9]
    v_cvt_pk_bf16_f32 v37, v138, v139
    v_pk_add_f32 v[140:141], v[140:141], v[4:5] neg_lo:[0,1] neg_hi:[0,1]
    v_cvt_pk_bf16_f32 v38, v140, v141
    v_lshlrev_b32 v140, 16, v38
    v_and_b32 v141, 0xffff0000, v38
    v_pk_mul_f32 v[140:141], v[140:141], v[8:9]
    v_cvt_pk_bf16_f32 v38, v140, v141
    v_pk_add_f32 v[142:143], v[142:143], v[4:5] neg_lo:[0,1] neg_hi:[0,1]
    v_cvt_pk_bf16_f32 v39, v142, v143
    v_lshlrev_b32 v142, 16, v39
    v_and_b32 v143, 0xffff0000, v39
    v_pk_mul_f32 v[142:143], v[142:143], v[8:9]
    v_cvt_pk_bf16_f32 v39, v142, v143
    buffer_store_dwordx4 v[36:39], v2, s[8:11], s31 offen offset:2048 sc1
    v_pk_add_f32 v[144:145], v[144:145], v[4:5] neg_lo:[0,1] neg_hi:[0,1]
    v_cvt_pk_bf16_f32 v40, v144, v145
    v_lshlrev_b32 v144, 16, v40
    v_and_b32 v145, 0xffff0000, v40
    v_pk_mul_f32 v[144:145], v[144:145], v[8:9]
    v_cvt_pk_bf16_f32 v40, v144, v145
    v_pk_add_f32 v[146:147], v[146:147], v[4:5] neg_lo:[0,1] neg_hi:[0,1]
    v_cvt_pk_bf16_f32 v41, v146, v147
    v_lshlrev_b32 v146, 16, v41
    v_and_b32 v147, 0xffff0000, v41
    v_pk_mul_f32 v[146:147], v[146:147], v[8:9]
    v_cvt_pk_bf16_f32 v41, v146, v147
    v_pk_add_f32 v[148:149], v[148:149], v[4:5] neg_lo:[0,1] neg_hi:[0,1]
    v_cvt_pk_bf16_f32 v42, v148, v149
    v_lshlrev_b32 v148, 16, v42
    v_and_b32 v149, 0xffff0000, v42
    v_pk_mul_f32 v[148:149], v[148:149], v[8:9]
    v_cvt_pk_bf16_f32 v42, v148, v149
    v_pk_add_f32 v[150:151], v[150:151], v[4:5] neg_lo:[0,1] neg_hi:[0,1]
    v_cvt_pk_bf16_f32 v43, v150, v151
    v_lshlrev_b32 v150, 16, v43
    v_and_b32 v151, 0xffff0000, v43
    v_pk_mul_f32 v[150:151], v[150:151], v[8:9]
    v_cvt_pk_bf16_f32 v43, v150, v151
    s_add_u32 s31, s31, 4096
    buffer_store_dwordx4 v[40:43], v2, s[8:11], s31 offen offset:0 sc1
    v_pk_add_f32 v[152:153], v[152:153], v[4:5] neg_lo:[0,1] neg_hi:[0,1]
    v_cvt_pk_bf16_f32 v44, v152, v153
    v_lshlrev_b32 v152, 16, v44
    v_and_b32 v153, 0xffff0000, v44
    v_pk_mul_f32 v[152:153], v[152:153], v[8:9]
    v_cvt_pk_bf16_f32 v44, v152, v153
    v_pk_add_f32 v[154:155], v[154:155], v[4:5] neg_lo:[0,1] neg_hi:[0,1]
    v_cvt_pk_bf16_f32 v45, v154, v155
    v_lshlrev_b32 v154, 16, v45
    v_and_b32 v155, 0xffff0000, v45
    v_pk_mul_f32 v[154:155], v[154:155], v[8:9]
    v_cvt_pk_bf16_f32 v45, v154, v155
    v_pk_add_f32 v[156:157], v[156:157], v[4:5] neg_lo:[0,1] neg_hi:[0,1]
    v_cvt_pk_bf16_f32 v46, v156, v157
    v_lshlrev_b32 v156, 16, v46
    v_and_b32 v157, 0xffff0000, v46
    v_pk_mul_f32 v[156:157], v[156:157], v[8:9]
    v_cvt_pk_bf16_f32 v46, v156, v157
    v_pk_add_f32 v[158:159], v[158:159], v[4:5] neg_lo:[0,1] neg_hi:[0,1]
    v_cvt_pk_bf16_f32 v47, v158, v159
    v_lshlrev_b32 v158, 16, v47
    v_and_b32 v159, 0xffff0000, v47
    v_pk_mul_f32 v[158:159], v[158:159], v[8:9]
    v_cvt_pk_bf16_f32 v47, v158, v159
    buffer_store_dwordx4 v[44:47], v2, s[8:11], s31 offen offset:2048 sc1
    v_pk_add_f32 v[160:161], v[160:161], v[4:5] neg_lo:[0,1] neg_hi:[0,1]
    v_cvt_pk_bf16_f32 v48, v160, v161
    v_lshlrev_b32 v160, 16, v48
    v_and_b32 v161, 0xffff0000, v48
    v_pk_mul_f32 v[160:161], v[160:161], v[8:9]
    v_cvt_pk_bf16_f32 v48, v160, v161
    v_pk_add_f32 v[162:163], v[162:163], v[4:5] neg_lo:[0,1] neg_hi:[0,1]
    v_cvt_pk_bf16_f32 v49, v162, v163
    v_lshlrev_b32 v162, 16, v49
    v_and_b32 v163, 0xffff0000, v49
    v_pk_mul_f32 v[162:163], v[162:163], v[8:9]
    v_cvt_pk_bf16_f32 v49, v162, v163
    v_pk_add_f32 v[164:165], v[164:165], v[4:5] neg_lo:[0,1] neg_hi:[0,1]
    v_cvt_pk_bf16_f32 v50, v164, v165
    v_lshlrev_b32 v164, 16, v50
    v_and_b32 v165, 0xffff0000, v50
    v_pk_mul_f32 v[164:165], v[164:165], v[8:9]
    v_cvt_pk_bf16_f32 v50, v164, v165
    v_pk_add_f32 v[166:167], v[166:167], v[4:5] neg_lo:[0,1] neg_hi:[0,1]
    v_cvt_pk_bf16_f32 v51, v166, v167
    v_lshlrev_b32 v166, 16, v51
    v_and_b32 v167, 0xffff0000, v51
    v_pk_mul_f32 v[166:167], v[166:167], v[8:9]
    v_cvt_pk_bf16_f32 v51, v166, v167
    s_add_u32 s31, s31, 4096
    buffer_store_dwordx4 v[48:51], v2, s[8:11], s31 offen offset:0 sc1
    v_pk_add_f32 v[168:169], v[168:169], v[4:5] neg_lo:[0,1] neg_hi:[0,1]
    v_cvt_pk_bf16_f32 v52, v168, v169
    v_lshlrev_b32 v168, 16, v52
    v_and_b32 v169, 0xffff0000, v52
    v_pk_mul_f32 v[168:169], v[168:169], v[8:9]
    v_cvt_pk_bf16_f32 v52, v168, v169
    v_pk_add_f32 v[170:171], v[170:171], v[4:5] neg_lo:[0,1] neg_hi:[0,1]
    v_cvt_pk_bf16_f32 v53, v170, v171
    v_lshlrev_b32 v170, 16, v53
    v_and_b32 v171, 0xffff0000, v53
    v_pk_mul_f32 v[170:171], v[170:171], v[8:9]
    v_cvt_pk_bf16_f32 v53, v170, v171
    v_pk_add_f32 v[172:173], v[172:173], v[4:5] neg_lo:[0,1] neg_hi:[0,1]
    v_cvt_pk_bf16_f32 v54, v172, v173
    v_lshlrev_b32 v172, 16, v54
    v_and_b32 v173, 0xffff0000, v54
    v_pk_mul_f32 v[172:173], v[172:173], v[8:9]
    v_cvt_pk_bf16_f32 v54, v172, v173
    v_pk_add_f32 v[174:175], v[174:175], v[4:5] neg_lo:[0,1] neg_hi:[0,1]
    v_cvt_pk_bf16_f32 v55, v174, v175
    v_lshlrev_b32 v174, 16, v55
    v_and_b32 v175, 0xffff0000, v55
    v_pk_mul_f32 v[174:175], v[174:175], v[8:9]
    v_cvt_pk_bf16_f32 v55, v174, v175
    buffer_store_dwordx4 v[52:55], v2, s[8:11], s31 offen offset:2048 sc1
    v_pk_add_f32 v[176:177], v[176:177], v[4:5] neg_lo:[0,1] neg_hi:[0,1]
    v_cvt_pk_bf16_f32 v56, v176, v177
    v_lshlrev_b32 v176, 16, v56
    v_and_b32 v177, 0xffff0000, v56
    v_pk_mul_f32 v[176:177], v[176:177], v[8:9]
    v_cvt_pk_bf16_f32 v56, v176, v177
    v_pk_add_f32 v[178:179], v[178:179], v[4:5] neg_lo:[0,1] neg_hi:[0,1]
    v_cvt_pk_bf16_f32 v57, v178, v179
    v_lshlrev_b32 v178, 16, v57
    v_and_b32 v179, 0xffff0000, v57
    v_pk_mul_f32 v[178:179], v[178:179], v[8:9]
    v_cvt_pk_bf16_f32 v57, v178, v179
    v_pk_add_f32 v[180:181], v[180:181], v[4:5] neg_lo:[0,1] neg_hi:[0,1]
    v_cvt_pk_bf16_f32 v58, v180, v181
    v_lshlrev_b32 v180, 16, v58
    v_and_b32 v181, 0xffff0000, v58
    v_pk_mul_f32 v[180:181], v[180:181], v[8:9]
    v_cvt_pk_bf16_f32 v58, v180, v181
    v_pk_add_f32 v[182:183], v[182:183], v[4:5] neg_lo:[0,1] neg_hi:[0,1]
    v_cvt_pk_bf16_f32 v59, v182, v183
    v_lshlrev_b32 v182, 16, v59
    v_and_b32 v183, 0xffff0000, v59
    v_pk_mul_f32 v[182:183], v[182:183], v[8:9]
    v_cvt_pk_bf16_f32 v59, v182, v183
    s_add_u32 s31, s31, 4096
    buffer_store_dwordx4 v[56:59], v2, s[8:11], s31 offen offset:0 sc1
    v_pk_add_f32 v[184:185], v[184:185], v[4:5] neg_lo:[0,1] neg_hi:[0,1]
    v_cvt_pk_bf16_f32 v60, v184, v185
    v_lshlrev_b32 v184, 16, v60
    v_and_b32 v185, 0xffff0000, v60
    v_pk_mul_f32 v[184:185], v[184:185], v[8:9]
    v_cvt_pk_bf16_f32 v60, v184, v185
    v_pk_add_f32 v[186:187], v[186:187], v[4:5] neg_lo:[0,1] neg_hi:[0,1]
    v_cvt_pk_bf16_f32 v61, v186, v187
    v_lshlrev_b32 v186, 16, v61
    v_and_b32 v187, 0xffff0000, v61
    v_pk_mul_f32 v[186:187], v[186:187], v[8:9]
    v_cvt_pk_bf16_f32 v61, v186, v187
    v_pk_add_f32 v[188:189], v[188:189], v[4:5] neg_lo:[0,1] neg_hi:[0,1]
    v_cvt_pk_bf16_f32 v62, v188, v189
    v_lshlrev_b32 v188, 16, v62
    v_and_b32 v189, 0xffff0000, v62
    v_pk_mul_f32 v[188:189], v[188:189], v[8:9]
    v_cvt_pk_bf16_f32 v62, v188, v189
    v_pk_add_f32 v[190:191], v[190:191], v[4:5] neg_lo:[0,1] neg_hi:[0,1]
    v_cvt_pk_bf16_f32 v63, v190, v191
    v_lshlrev_b32 v190, 16, v63
    v_and_b32 v191, 0xffff0000, v63
    v_pk_mul_f32 v[190:191], v[190:191], v[8:9]
    v_cvt_pk_bf16_f32 v63, v190, v191
    buffer_store_dwordx4 v[60:63], v2, s[8:11], s31 offen offset:2048 sc1
    v_pk_add_f32 v[192:193], v[192:193], v[4:5] neg_lo:[0,1] neg_hi:[0,1]
    v_cvt_pk_bf16_f32 v64, v192, v193
    v_lshlrev_b32 v192, 16, v64
    v_and_b32 v193, 0xffff0000, v64
    v_pk_mul_f32 v[192:193], v[192:193], v[8:9]
    v_cvt_pk_bf16_f32 v64, v192, v193
    v_pk_add_f32 v[194:195], v[194:195], v[4:5] neg_lo:[0,1] neg_hi:[0,1]
    v_cvt_pk_bf16_f32 v65, v194, v195
    v_lshlrev_b32 v194, 16, v65
    v_and_b32 v195, 0xffff0000, v65
    v_pk_mul_f32 v[194:195], v[194:195], v[8:9]
    v_cvt_pk_bf16_f32 v65, v194, v195
    v_pk_add_f32 v[196:197], v[196:197], v[4:5] neg_lo:[0,1] neg_hi:[0,1]
    v_cvt_pk_bf16_f32 v66, v196, v197
    v_lshlrev_b32 v196, 16, v66
    v_and_b32 v197, 0xffff0000, v66
    v_pk_mul_f32 v[196:197], v[196:197], v[8:9]
    v_cvt_pk_bf16_f32 v66, v196, v197
    v_pk_add_f32 v[198:199], v[198:199], v[4:5] neg_lo:[0,1] neg_hi:[0,1]
    v_cvt_pk_bf16_f32 v67, v198, v199
    v_lshlrev_b32 v198, 16, v67
    v_and_b32 v199, 0xffff0000, v67
    v_pk_mul_f32 v[198:199], v[198:199], v[8:9]
    v_cvt_pk_bf16_f32 v67, v198, v199
    s_add_u32 s31, s31, 4096
    buffer_store_dwordx4 v[64:67], v2, s[8:11], s31 offen offset:0 sc1
    v_pk_add_f32 v[200:201], v[200:201], v[4:5] neg_lo:[0,1] neg_hi:[0,1]
    v_cvt_pk_bf16_f32 v68, v200, v201
    v_lshlrev_b32 v200, 16, v68
    v_and_b32 v201, 0xffff0000, v68
    v_pk_mul_f32 v[200:201], v[200:201], v[8:9]
    v_cvt_pk_bf16_f32 v68, v200, v201
    v_pk_add_f32 v[202:203], v[202:203], v[4:5] neg_lo:[0,1] neg_hi:[0,1]
    v_cvt_pk_bf16_f32 v69, v202, v203
    v_lshlrev_b32 v202, 16, v69
    v_and_b32 v203, 0xffff0000, v69
    v_pk_mul_f32 v[202:203], v[202:203], v[8:9]
    v_cvt_pk_bf16_f32 v69, v202, v203
    v_pk_add_f32 v[204:205], v[204:205], v[4:5] neg_lo:[0,1] neg_hi:[0,1]
    v_cvt_pk_bf16_f32 v70, v204, v205
    v_lshlrev_b32 v204, 16, v70
    v_and_b32 v205, 0xffff0000, v70
    v_pk_mul_f32 v[204:205], v[204:205], v[8:9]
    v_cvt_pk_bf16_f32 v70, v204, v205
    v_pk_add_f32 v[206:207], v[206:207], v[4:5] neg_lo:[0,1] neg_hi:[0,1]
    v_cvt_pk_bf16_f32 v71, v206, v207
    v_lshlrev_b32 v206, 16, v71
    v_and_b32 v207, 0xffff0000, v71
    v_pk_mul_f32 v[206:207], v[206:207], v[8:9]
    v_cvt_pk_bf16_f32 v71, v206, v207
    buffer_store_dwordx4 v[68:71], v2, s[8:11], s31 offen offset:2048 sc1
    v_pk_add_f32 v[208:209], v[208:209], v[4:5] neg_lo:[0,1] neg_hi:[0,1]
    v_cvt_pk_bf16_f32 v72, v208, v209
    v_lshlrev_b32 v208, 16, v72
    v_and_b32 v209, 0xffff0000, v72
    v_pk_mul_f32 v[208:209], v[208:209], v[8:9]
    v_cvt_pk_bf16_f32 v72, v208, v209
    v_pk_add_f32 v[210:211], v[210:211], v[4:5] neg_lo:[0,1] neg_hi:[0,1]
    v_cvt_pk_bf16_f32 v73, v210, v211
    v_lshlrev_b32 v210, 16, v73
    v_and_b32 v211, 0xffff0000, v73
    v_pk_mul_f32 v[210:211], v[210:211], v[8:9]
    v_cvt_pk_bf16_f32 v73, v210, v211
    v_pk_add_f32 v[212:213], v[212:213], v[4:5] neg_lo:[0,1] neg_hi:[0,1]
    v_cvt_pk_bf16_f32 v74, v212, v213
    v_lshlrev_b32 v212, 16, v74
    v_and_b32 v213, 0xffff0000, v74
    v_pk_mul_f32 v[212:213], v[212:213], v[8:9]
    v_cvt_pk_bf16_f32 v74, v212, v213
    v_pk_add_f32 v[214:215], v[214:215], v[4:5] neg_lo:[0,1] neg_hi:[0,1]
    v_cvt_pk_bf16_f32 v75, v214, v215
    v_lshlrev_b32 v214, 16, v75
    v_and_b32 v215, 0xffff0000, v75
    v_pk_mul_f32 v[214:215], v[214:215], v[8:9]
    v_cvt_pk_bf16_f32 v75, v214, v215
    s_add_u32 s31, s31, 4096
    buffer_store_dwordx4 v[72:75], v2, s[8:11], s31 offen offset:0 sc1
    v_pk_add_f32 v[216:217], v[216:217], v[4:5] neg_lo:[0,1] neg_hi:[0,1]
    v_cvt_pk_bf16_f32 v76, v216, v217
    v_lshlrev_b32 v216, 16, v76
    v_and_b32 v217, 0xffff0000, v76
    v_pk_mul_f32 v[216:217], v[216:217], v[8:9]
    v_cvt_pk_bf16_f32 v76, v216, v217
    v_pk_add_f32 v[218:219], v[218:219], v[4:5] neg_lo:[0,1] neg_hi:[0,1]
    v_cvt_pk_bf16_f32 v77, v218, v219
    v_lshlrev_b32 v218, 16, v77
    v_and_b32 v219, 0xffff0000, v77
    v_pk_mul_f32 v[218:219], v[218:219], v[8:9]
    v_cvt_pk_bf16_f32 v77, v218, v219
    v_pk_add_f32 v[220:221], v[220:221], v[4:5] neg_lo:[0,1] neg_hi:[0,1]
    v_cvt_pk_bf16_f32 v78, v220, v221
    v_lshlrev_b32 v220, 16, v78
    v_and_b32 v221, 0xffff0000, v78
    v_pk_mul_f32 v[220:221], v[220:221], v[8:9]
    v_cvt_pk_bf16_f32 v78, v220, v221
    v_pk_add_f32 v[222:223], v[222:223], v[4:5] neg_lo:[0,1] neg_hi:[0,1]
    v_cvt_pk_bf16_f32 v79, v222, v223
    v_lshlrev_b32 v222, 16, v79
    v_and_b32 v223, 0xffff0000, v79
    v_pk_mul_f32 v[222:223], v[222:223], v[8:9]
    v_cvt_pk_bf16_f32 v79, v222, v223
    buffer_store_dwordx4 v[76:79], v2, s[8:11], s31 offen offset:2048 sc1
    v_pk_add_f32 v[224:225], v[224:225], v[4:5] neg_lo:[0,1] neg_hi:[0,1]
    v_cvt_pk_bf16_f32 v80, v224, v225
    v_lshlrev_b32 v224, 16, v80
    v_and_b32 v225, 0xffff0000, v80
    v_pk_mul_f32 v[224:225], v[224:225], v[8:9]
    v_cvt_pk_bf16_f32 v80, v224, v225
    v_pk_add_f32 v[226:227], v[226:227], v[4:5] neg_lo:[0,1] neg_hi:[0,1]
    v_cvt_pk_bf16_f32 v81, v226, v227
    v_lshlrev_b32 v226, 16, v81
    v_and_b32 v227, 0xffff0000, v81
    v_pk_mul_f32 v[226:227], v[226:227], v[8:9]
    v_cvt_pk_bf16_f32 v81, v226, v227
    v_pk_add_f32 v[228:229], v[228:229], v[4:5] neg_lo:[0,1] neg_hi:[0,1]
    v_cvt_pk_bf16_f32 v82, v228, v229
    v_lshlrev_b32 v228, 16, v82
    v_and_b32 v229, 0xffff0000, v82
    v_pk_mul_f32 v[228:229], v[228:229], v[8:9]
    v_cvt_pk_bf16_f32 v82, v228, v229
    v_pk_add_f32 v[230:231], v[230:231], v[4:5] neg_lo:[0,1] neg_hi:[0,1]
    v_cvt_pk_bf16_f32 v83, v230, v231
    v_lshlrev_b32 v230, 16, v83
    v_and_b32 v231, 0xffff0000, v83
    v_pk_mul_f32 v[230:231], v[230:231], v[8:9]
    v_cvt_pk_bf16_f32 v83, v230, v231
    s_add_u32 s31, s31, 4096
    buffer_store_dwordx4 v[80:83], v2, s[8:11], s31 offen offset:0 sc1
    v_pk_add_f32 v[232:233], v[232:233], v[4:5] neg_lo:[0,1] neg_hi:[0,1]
    v_cvt_pk_bf16_f32 v84, v232, v233
    v_lshlrev_b32 v232, 16, v84
    v_and_b32 v233, 0xffff0000, v84
    v_pk_mul_f32 v[232:233], v[232:233], v[8:9]
    v_cvt_pk_bf16_f32 v84, v232, v233
    v_pk_add_f32 v[234:235], v[234:235], v[4:5] neg_lo:[0,1] neg_hi:[0,1]
    v_cvt_pk_bf16_f32 v85, v234, v235
    v_lshlrev_b32 v234, 16, v85
    v_and_b32 v235, 0xffff0000, v85
    v_pk_mul_f32 v[234:235], v[234:235], v[8:9]
    v_cvt_pk_bf16_f32 v85, v234, v235
    v_pk_add_f32 v[236:237], v[236:237], v[4:5] neg_lo:[0,1] neg_hi:[0,1]
    v_cvt_pk_bf16_f32 v86, v236, v237
    v_lshlrev_b32 v236, 16, v86
    v_and_b32 v237, 0xffff0000, v86
    v_pk_mul_f32 v[236:237], v[236:237], v[8:9]
    v_cvt_pk_bf16_f32 v86, v236, v237
    v_pk_add_f32 v[238:239], v[238:239], v[4:5] neg_lo:[0,1] neg_hi:[0,1]
    v_cvt_pk_bf16_f32 v87, v238, v239
    v_lshlrev_b32 v238, 16, v87
    v_and_b32 v239, 0xffff0000, v87
    v_pk_mul_f32 v[238:239], v[238:239], v[8:9]
    v_cvt_pk_bf16_f32 v87, v238, v239
    buffer_store_dwordx4 v[84:87], v2, s[8:11], s31 offen offset:2048 sc1
    v_pk_add_f32 v[240:241], v[240:241], v[4:5] neg_lo:[0,1] neg_hi:[0,1]
    v_cvt_pk_bf16_f32 v88, v240, v241
    v_lshlrev_b32 v240, 16, v88
    v_and_b32 v241, 0xffff0000, v88
    v_pk_mul_f32 v[240:241], v[240:241], v[8:9]
    v_cvt_pk_bf16_f32 v88, v240, v241
    v_pk_add_f32 v[242:243], v[242:243], v[4:5] neg_lo:[0,1] neg_hi:[0,1]
    v_cvt_pk_bf16_f32 v89, v242, v243
    v_lshlrev_b32 v242, 16, v89
    v_and_b32 v243, 0xffff0000, v89
    v_pk_mul_f32 v[242:243], v[242:243], v[8:9]
    v_cvt_pk_bf16_f32 v89, v242, v243
    v_pk_add_f32 v[244:245], v[244:245], v[4:5] neg_lo:[0,1] neg_hi:[0,1]
    v_cvt_pk_bf16_f32 v90, v244, v245
    v_lshlrev_b32 v244, 16, v90
    v_and_b32 v245, 0xffff0000, v90
    v_pk_mul_f32 v[244:245], v[244:245], v[8:9]
    v_cvt_pk_bf16_f32 v90, v244, v245
    v_pk_add_f32 v[246:247], v[246:247], v[4:5] neg_lo:[0,1] neg_hi:[0,1]
    v_cvt_pk_bf16_f32 v91, v246, v247
    v_lshlrev_b32 v246, 16, v91
    v_and_b32 v247, 0xffff0000, v91
    v_pk_mul_f32 v[246:247], v[246:247], v[8:9]
    v_cvt_pk_bf16_f32 v91, v246, v247
    s_add_u32 s31, s31, 4096
    buffer_store_dwordx4 v[88:91], v2, s[8:11], s31 offen offset:0 sc1
    v_pk_add_f32 v[248:249], v[248:249], v[4:5] neg_lo:[0,1] neg_hi:[0,1]
    v_cvt_pk_bf16_f32 v92, v248, v249
    v_lshlrev_b32 v248, 16, v92
    v_and_b32 v249, 0xffff0000, v92
    v_pk_mul_f32 v[248:249], v[248:249], v[8:9]
    v_cvt_pk_bf16_f32 v92, v248, v249
    v_pk_add_f32 v[250:251], v[250:251], v[4:5] neg_lo:[0,1] neg_hi:[0,1]
    v_cvt_pk_bf16_f32 v93, v250, v251
    v_lshlrev_b32 v250, 16, v93
    v_and_b32 v251, 0xffff0000, v93
    v_pk_mul_f32 v[250:251], v[250:251], v[8:9]
    v_cvt_pk_bf16_f32 v93, v250, v251
    v_pk_add_f32 v[252:253], v[252:253], v[4:5] neg_lo:[0,1] neg_hi:[0,1]
    v_cvt_pk_bf16_f32 v94, v252, v253
    v_lshlrev_b32 v252, 16, v94
    v_and_b32 v253, 0xffff0000, v94
    v_pk_mul_f32 v[252:253], v[252:253], v[8:9]
    v_cvt_pk_bf16_f32 v94, v252, v253
    v_pk_add_f32 v[254:255], v[254:255], v[4:5] neg_lo:[0,1] neg_hi:[0,1]
    v_cvt_pk_bf16_f32 v95, v254, v255
    v_lshlrev_b32 v254, 16, v95
    v_and_b32 v255, 0xffff0000, v95
    v_pk_mul_f32 v[254:255], v[254:255], v[8:9]
    v_cvt_pk_bf16_f32 v95, v254, v255
    buffer_store_dwordx4 v[92:95], v2, s[8:11], s31 offen offset:2048 sc1
    s_cmp_lg_u32 s3, 0
    s_cbranch_scc1 dwok_recurrent_scan__memory_aug_recurrent_mem_tr__dense_activation_mish__prompt_kernel_89
    s_mov_b32 s52, 0
    s_mov_b32 s56, s88
    s_and_b32 s57, s89, 0xffff
    s_mov_b32 s58, 256
    s_mov_b32 s59, 0x20000
dw_recurrent_scan__memory_aug_recurrent_mem_tr__dense_activation_mish__prompt_kernel_88:
    buffer_load_dword v6, off, s[56:59], 0 offset:64 sc1
    s_waitcnt vmcnt(0)
    v_readfirstlane_b32 s50, v6
    s_cmp_eq_u32 s50, 1
    s_cbranch_scc1 dwi_recurrent_scan__memory_aug_recurrent_mem_tr__dense_activation_mish__prompt_kernel_90
    s_add_u32 s52, s52, 1
    s_cmp_gt_u32 s52, 100000
    s_cbranch_scc1 dwok_recurrent_scan__memory_aug_recurrent_mem_tr__dense_activation_mish__prompt_kernel_89
    s_sleep 8
    s_branch dw_recurrent_scan__memory_aug_recurrent_mem_tr__dense_activation_mish__prompt_kernel_88
dwi_recurrent_scan__memory_aug_recurrent_mem_tr__dense_activation_mish__prompt_kernel_90:
dwok_recurrent_scan__memory_aug_recurrent_mem_tr__dense_activation_mish__prompt_kernel_89:
    s_waitcnt vmcnt(0)
    s_barrier
    s_cmp_lg_u32 s3, 0
    s_cbranch_scc1 noln_recurrent_scan__memory_aug_recurrent_mem_tr__dense_activation_mish__prompt_kernel_83
    s_lshl_b32 s7, s7, 2
    s_add_u32 s7, s7, 97925632
    v_lshlrev_b32 v8, 8, v0
    v_mov_b32 v9, 1
    s_mov_b64 exec, 63
    buffer_store_dword v9, v8, s[8:11], s7 offen sc1
    s_mov_b64 exec, -1
noln_recurrent_scan__memory_aug_recurrent_mem_tr__dense_activation_mish__prompt_kernel_83:
    s_cmp_ge_u32 s4, 4
    s_cbranch_scc1 nmi_recurrent_scan__memory_aug_recurrent_mem_tr__dense_activation_mish__prompt_kernel_91
    s_sub_u32 s6, s5, 8
    s_cmp_ge_u32 s6, 16
    s_cbranch_scc1 nmi_recurrent_scan__memory_aug_recurrent_mem_tr__dense_activation_mish__prompt_kernel_91
    s_lshl_b32 s6, s6, 2
    s_add_u32 s6, s6, s3
    s_lshl_b32 s7, s4, 20
    s_add_u32 s7, s7, 96468992
    s_cmp_eq_u32 s6, 0
    s_cselect_b32 s7, 268435456, s7
    s_lshl_b32 s6, s6, 14
    s_add_u32 s6, s6, s7
    v_mov_b32 v4, -1
    v_mov_b32 v5, -1
    v_mov_b32 v6, -1
    v_mov_b32 v7, -1
    v_lshlrev_b32 v8, 4, v0
    buffer_store_dwordx4 v[4:7], v8, s[8:11], s6 offen offset:0 sc1
    buffer_store_dwordx4 v[4:7], v8, s[8:11], s6 offen offset:1024 sc1
    buffer_store_dwordx4 v[4:7], v8, s[8:11], s6 offen offset:2048 sc1
    buffer_store_dwordx4 v[4:7], v8, s[8:11], s6 offen offset:3072 sc1
    s_add_u32 s6, s6, 4096
    buffer_store_dwordx4 v[4:7], v8, s[8:11], s6 offen sc1
    s_mov_b64 exec, 0xff
    buffer_store_dwordx4 v[4:7], v8, s[8:11], s6 offen offset:1024 sc1
    s_mov_b64 exec, -1
    s_add_u32 s6, s6, 4096
    buffer_store_dwordx4 v[4:7], v8, s[8:11], s6 offen offset:0 sc1
    buffer_store_dwordx4 v[4:7], v8, s[8:11], s6 offen offset:1024 sc1
    buffer_store_dwordx4 v[4:7], v8, s[8:11], s6 offen offset:2048 sc1
    buffer_store_dwordx4 v[4:7], v8, s[8:11], s6 offen offset:3072 sc1
    s_add_u32 s6, s6, 4096
    buffer_store_dwordx4 v[4:7], v8, s[8:11], s6 offen sc1
    s_mov_b64 exec, 0xff
    buffer_store_dwordx4 v[4:7], v8, s[8:11], s6 offen offset:1024 sc1
    s_mov_b64 exec, -1
    s_add_u32 s6, s6, 4096
    v_mov_b32 v9, 1
    s_waitcnt vmcnt(0)
    s_barrier
    s_cmp_lg_u32 s3, 0
    s_cbranch_scc1 nmi_recurrent_scan__memory_aug_recurrent_mem_tr__dense_activation_mish__prompt_kernel_91
    s_mov_b64 exec, 1
    buffer_atomic_add v9, off, s[24:27], 0 offset:80 sc1
    s_mov_b64 exec, -1
nmi_recurrent_scan__memory_aug_recurrent_mem_tr__dense_activation_mish__prompt_kernel_91:
    s_cmp_lg_u32 s5, 31
    s_cbranch_scc1 n31_recurrent_scan__memory_aug_recurrent_mem_tr__dense_activation_mish__prompt_kernel_92
    s_cmp_lg_u32 s3, 0
    s_cbranch_scc1 dwok_recurrent_scan__memory_aug_recurrent_mem_tr__dense_activation_mish__prompt_kernel_94
    s_mov_b32 s52, 0
    s_mov_b32 s56, s88
    s_and_b32 s57, s89, 0xffff
    s_mov_b32 s58, 256
    s_mov_b32 s59, 0x20000
dw_recurrent_scan__memory_aug_recurrent_mem_tr__dense_activation_mish__prompt_kernel_93:
    buffer_load_dword v6, off, s[56:59], 0 offset:64 sc1
    s_waitcnt vmcnt(0)
    v_readfirstlane_b32 s50, v6
    s_cmp_eq_u32 s50, 1
    s_cbranch_scc1 dwi_recurrent_scan__memory_aug_recurrent_mem_tr__dense_activation_mish__prompt_kernel_95
    s_add_u32 s52, s52, 1
    s_cmp_gt_u32 s52, 100000
    s_cbranch_scc1 dwok_recurrent_scan__memory_aug_recurrent_mem_tr__dense_activation_mish__prompt_kernel_94
    s_sleep 8
    s_branch dw_recurrent_scan__memory_aug_recurrent_mem_tr__dense_activation_mish__prompt_kernel_93
dwi_recurrent_scan__memory_aug_recurrent_mem_tr__dense_activation_mish__prompt_kernel_95:
dwok_recurrent_scan__memory_aug_recurrent_mem_tr__dense_activation_mish__prompt_kernel_94:
    s_barrier
    s_lshl_b32 s49, s4, 5
    s_add_u32 s49, s49, s3
    s_lshl_b32 s49, s49, 2
    s_add_u32 s49, s49, 97918832
    v_mov_b32 v6, 64
    buffer_store_dword v6, off, s[8:11], s49 sc1
n31_recurrent_scan__memory_aug_recurrent_mem_tr__dense_activation_mish__prompt_kernel_92:
    s_cmp_ge_u32 s5, 31
    s_cbranch_scc1 g1done_recurrent_scan__memory_aug_recurrent_mem_tr__dense_activation_mish__prompt_kernel_98
    s_sub_u32 s33, s4, 2
    s_cmp_ge_u32 s5, 24
    s_cbranch_scc1 g1ffn_recurrent_scan__memory_aug_recurrent_mem_tr__dense_activation_mish__prompt_kernel_96
    s_mul_i32 s34, s5, 43
    s_lshr_b32 s34, s34, 7
    s_mul_i32 s35, s34, 3
    s_sub_u32 s26, s5, s35
    s_mov_b32 s27, 3
    s_lshl_b32 s35, s33, 3
    s_add_u32 s34, s34, s35
    s_lshr_b32 s28, s34, 4
    s_and_b32 s34, s34, 15
    s_lshl_b32 s34, s34, 2
    s_add_u32 s34, s34, s3
    s_lshl_b32 s30, s34, 7
    s_mov_b32 s29, 8192
    s_lshr_b32 s31, s34, 1
    s_mul_i32 s31, s31, 2097152
    s_and_b32 s35, s34, 1
    s_lshl_b32 s35, s35, 12
    s_add_u32 s31, s31, s35
    s_lshl_b32 s35, s28, 13
    s_add_u32 s31, s31, s35
    s_add_u32 s31, s31, 4194304
    s_mov_b32 s32, 32768
    s_add_u32 s35, s28, 2
    s_cmp_ge_u32 s35, 3
    s_cselect_b32 s49, 3, 0
    s_sub_u32 s35, s35, s49
    s_mul_i32 s35, s35, 3
    s_add_u32 s35, s35, s26
    s_lshl_b32 s35, s35, 3
    s_and_b32 s49, s34, 1
    s_lshl_b32 s49, s49, 2
    s_add_u32 s35, s35, s49
    s_lshr_b32 s49, s34, 1
    s_lshl_b32 s49, s49, 8
    s_add_u32 s49, s49, s35
    s_add_u32 s49, s49, 97910784
    s_cmp_eq_u32 s28, 0
    s_cselect_b32 s12, s68, s70
    s_cselect_b32 s13, s69, s71
    s_cmp_eq_u32 s28, 2
    s_cselect_b32 s12, s72, s12
    s_cselect_b32 s13, s73, s13
    s_and_b32 s13, s13, 0xffff
    s_mov_b32 s14, 5242880
    s_mov_b32 s15, 0x20000
    s_branch g1common_recurrent_scan__memory_aug_recurrent_mem_tr__dense_activation_mish__prompt_kernel_97
g1ffn_recurrent_scan__memory_aug_recurrent_mem_tr__dense_activation_mish__prompt_kernel_96:
    s_mov_b32 s26, s33
    s_mov_b32 s27, 6
    s_mov_b32 s28, 3
    s_sub_u32 s34, s5, 24
    s_lshl_b32 s34, s34, 2
    s_add_u32 s34, s34, s3
    s_lshl_b32 s49, s33, 5
    s_add_u32 s49, s49, s34
    s_lshl_b32 s49, s49, 2
    s_add_u32 s49, s49, 97918976
    s_min_u32 s34, s34, 26
    s_lshl_b32 s30, s34, 7
    s_mov_b32 s29, 3456
    s_lshl_b32 s31, s34, 11
    s_add_u32 s31, s31, 71303168
    s_mov_b32 s32, 110592
    s_mov_b32 s12, s80
    s_and_b32 s13, s81, 0xffff
    s_mov_b32 s14, 2211840
    s_mov_b32 s15, 0x20000
g1common_recurrent_scan__memory_aug_recurrent_mem_tr__dense_activation_mish__prompt_kernel_97:
    s_mov_b32 s16, s82
    s_and_b32 s17, s83, 0xffff
    s_mov_b32 s18, 3456
    s_mov_b32 s19, 0x20000
    v_lshrrev_b32 v1, 4, v0
    v_bfe_u32 v2, v0, 2, 2
    v_lshl_add_u32 v2, v1, 3, v2
    v_mul_lo_u32 v2, v2, s29
    v_and_b32 v3, 3, v0
    v_lshl_add_u32 v2, v3, 4, v2
    s_mul_i32 s36, s3, 40960
    v_lshlrev_b32 v3, 4, v0
    v_add_u32 v4, s36, v3
    v_lshlrev_b32 v5, 4, v1
    buffer_load_dwordx4 v[8:11], v5, s[16:19], s30 offen
    buffer_load_dwordx4 v[12:15], v5, s[16:19], s30 offen offset:64
    s_waitcnt vmcnt(0)
    v_lshlrev_b32 v96, 16, v8
    v_and_b32 v97, 0xffff0000, v8
    v_lshlrev_b32 v98, 16, v9
    v_and_b32 v99, 0xffff0000, v9
    v_lshlrev_b32 v100, 16, v10
    v_and_b32 v101, 0xffff0000, v10
    v_lshlrev_b32 v102, 16, v11
    v_and_b32 v103, 0xffff0000, v11
    v_lshlrev_b32 v104, 16, v12
    v_and_b32 v105, 0xffff0000, v12
    v_lshlrev_b32 v106, 16, v13
    v_and_b32 v107, 0xffff0000, v13
    v_lshlrev_b32 v108, 16, v14
    v_and_b32 v109, 0xffff0000, v14
    v_lshlrev_b32 v110, 16, v15
    v_and_b32 v111, 0xffff0000, v15
    s_lshl_b32 s38, s29, 2
    s_mul_i32 s39, s29, 28
    s_mov_b32 s37, s30
    s_add_u32 m0, s36, 0
    s_nop 0
    buffer_load_dwordx4 v2, s[12:15], s37 offen offset:0 lds
    s_add_u32 m0, s36, 960
    s_nop 0
    buffer_load_dwordx4 v2, s[12:15], s37 offen offset:64 lds
    s_add_u32 s37, s37, s38
    s_add_u32 m0, s36, 2048
    s_nop 0
    buffer_load_dwordx4 v2, s[12:15], s37 offen offset:0 lds
    s_add_u32 m0, s36, 3008
    s_nop 0
    buffer_load_dwordx4 v2, s[12:15], s37 offen offset:64 lds
    s_add_u32 s37, s37, s39
    s_add_u32 m0, s36, 4096
    s_nop 0
    buffer_load_dwordx4 v2, s[12:15], s37 offen offset:0 lds
    s_add_u32 m0, s36, 5056
    s_nop 0
    buffer_load_dwordx4 v2, s[12:15], s37 offen offset:64 lds
    s_add_u32 s37, s37, s38
    s_add_u32 m0, s36, 6144
    s_nop 0
    buffer_load_dwordx4 v2, s[12:15], s37 offen offset:0 lds
    s_add_u32 m0, s36, 7104
    s_nop 0
    buffer_load_dwordx4 v2, s[12:15], s37 offen offset:64 lds
    s_add_u32 s37, s37, s39
    s_add_u32 m0, s36, 8192
    s_nop 0
    buffer_load_dwordx4 v2, s[12:15], s37 offen offset:0 lds
    s_add_u32 m0, s36, 9152
    s_nop 0
    buffer_load_dwordx4 v2, s[12:15], s37 offen offset:64 lds
    s_add_u32 s37, s37, s38
    s_add_u32 m0, s36, 10240
    s_nop 0
    buffer_load_dwordx4 v2, s[12:15], s37 offen offset:0 lds
    s_add_u32 m0, s36, 11200
    s_nop 0
    buffer_load_dwordx4 v2, s[12:15], s37 offen offset:64 lds
    s_add_u32 s37, s37, s39
    s_add_u32 m0, s36, 12288
    s_nop 0
    buffer_load_dwordx4 v2, s[12:15], s37 offen offset:0 lds
    s_add_u32 m0, s36, 13248
    s_nop 0
    buffer_load_dwordx4 v2, s[12:15], s37 offen offset:64 lds
    s_add_u32 s37, s37, s38
    s_add_u32 m0, s36, 14336
    s_nop 0
    buffer_load_dwordx4 v2, s[12:15], s37 offen offset:0 lds
    s_add_u32 m0, s36, 15296
    s_nop 0
    buffer_load_dwordx4 v2, s[12:15], s37 offen offset:64 lds
    s_add_u32 s37, s37, s39
    s_add_u32 m0, s36, 16384
    s_nop 0
    buffer_load_dwordx4 v2, s[12:15], s37 offen offset:0 lds
    s_add_u32 m0, s36, 17344
    s_nop 0
    buffer_load_dwordx4 v2, s[12:15], s37 offen offset:64 lds
    s_add_u32 s37, s37, s38
    s_add_u32 m0, s36, 18432
    s_nop 0
    buffer_load_dwordx4 v2, s[12:15], s37 offen offset:0 lds
    s_add_u32 m0, s36, 19392
    s_nop 0
    buffer_load_dwordx4 v2, s[12:15], s37 offen offset:64 lds
    s_add_u32 s37, s37, s39
    s_add_u32 m0, s36, 20480
    s_nop 0
    buffer_load_dwordx4 v2, s[12:15], s37 offen offset:0 lds
    s_add_u32 m0, s36, 21440
    s_nop 0
    buffer_load_dwordx4 v2, s[12:15], s37 offen offset:64 lds
    s_add_u32 s37, s37, s38
    s_add_u32 m0, s36, 22528
    s_nop 0
    buffer_load_dwordx4 v2, s[12:15], s37 offen offset:0 lds
    s_add_u32 m0, s36, 23488
    s_nop 0
    buffer_load_dwordx4 v2, s[12:15], s37 offen offset:64 lds
    s_add_u32 s37, s37, s39
    s_add_u32 m0, s36, 24576
    s_nop 0
    buffer_load_dwordx4 v2, s[12:15], s37 offen offset:0 lds
    s_add_u32 m0, s36, 25536
    s_nop 0
    buffer_load_dwordx4 v2, s[12:15], s37 offen offset:64 lds
    s_add_u32 s37, s37, s38
    s_add_u32 m0, s36, 26624
    s_nop 0
    buffer_load_dwordx4 v2, s[12:15], s37 offen offset:0 lds
    s_add_u32 m0, s36, 27584
    s_nop 0
    buffer_load_dwordx4 v2, s[12:15], s37 offen offset:64 lds
    s_add_u32 s37, s37, s39
    s_add_u32 m0, s36, 28672
    s_nop 0
    buffer_load_dwordx4 v2, s[12:15], s37 offen offset:0 lds
    s_add_u32 m0, s36, 29632
    s_nop 0
    buffer_load_dwordx4 v2, s[12:15], s37 offen offset:64 lds
    s_add_u32 s37, s37, s38
    s_add_u32 m0, s36, 30720
    s_nop 0
    buffer_load_dwordx4 v2, s[12:15], s37 offen offset:0 lds
    s_add_u32 m0, s36, 31680
    s_nop 0
    buffer_load_dwordx4 v2, s[12:15], s37 offen offset:64 lds
    s_add_u32 s37, s37, s39
    s_add_u32 m0, s36, 32768
    s_nop 0
    buffer_load_dwordx4 v2, s[12:15], s37 offen offset:0 lds
    s_add_u32 m0, s36, 33728
    s_nop 0
    buffer_load_dwordx4 v2, s[12:15], s37 offen offset:64 lds
    s_add_u32 s37, s37, s38
    s_add_u32 m0, s36, 34816
    s_nop 0
    buffer_load_dwordx4 v2, s[12:15], s37 offen offset:0 lds
    s_add_u32 m0, s36, 35776
    s_nop 0
    buffer_load_dwordx4 v2, s[12:15], s37 offen offset:64 lds
    s_add_u32 s37, s37, s39
    s_add_u32 m0, s36, 36864
    s_nop 0
    buffer_load_dwordx4 v2, s[12:15], s37 offen offset:0 lds
    s_add_u32 m0, s36, 37824
    s_nop 0
    buffer_load_dwordx4 v2, s[12:15], s37 offen offset:64 lds
    s_add_u32 s37, s37, s38
    s_add_u32 m0, s36, 38912
    s_nop 0
    buffer_load_dwordx4 v2, s[12:15], s37 offen offset:0 lds
    s_add_u32 m0, s36, 39872
    s_nop 0
    buffer_load_dwordx4 v2, s[12:15], s37 offen offset:64 lds
    s_waitcnt vmcnt(32)
    ds_read_b64_tr_b16 a[0:1], v4 offset:0
    ds_read_b64_tr_b16 a[4:5], v4 offset:8
    ds_read_b64_tr_b16 a[8:9], v4 offset:1024
    ds_read_b64_tr_b16 a[12:13], v4 offset:1032
    ds_read_b64_tr_b16 a[2:3], v4 offset:2048
    ds_read_b64_tr_b16 a[6:7], v4 offset:2056
    ds_read_b64_tr_b16 a[10:11], v4 offset:3072
    ds_read_b64_tr_b16 a[14:15], v4 offset:3080
    ds_read_b64_tr_b16 a[16:17], v4 offset:4096
    ds_read_b64_tr_b16 a[20:21], v4 offset:4104
    ds_read_b64_tr_b16 a[24:25], v4 offset:5120
    ds_read_b64_tr_b16 a[28:29], v4 offset:5128
    ds_read_b64_tr_b16 a[18:19], v4 offset:6144
    ds_read_b64_tr_b16 a[22:23], v4 offset:6152
    ds_read_b64_tr_b16 a[26:27], v4 offset:7168
    ds_read_b64_tr_b16 a[30:31], v4 offset:7176
    s_waitcnt lgkmcnt(0)
    s_add_u32 s37, s37, s39
    s_add_u32 m0, s36, 0
    s_nop 0
    buffer_load_dwordx4 v2, s[12:15], s37 offen offset:0 lds
    s_add_u32 m0, s36, 960
    s_nop 0
    buffer_load_dwordx4 v2, s[12:15], s37 offen offset:64 lds
    s_add_u32 s37, s37, s38
    s_add_u32 m0, s36, 2048
    s_nop 0
    buffer_load_dwordx4 v2, s[12:15], s37 offen offset:0 lds
    s_add_u32 m0, s36, 3008
    s_nop 0
    buffer_load_dwordx4 v2, s[12:15], s37 offen offset:64 lds
    s_add_u32 s37, s37, s39
    s_add_u32 m0, s36, 4096
    s_nop 0
    buffer_load_dwordx4 v2, s[12:15], s37 offen offset:0 lds
    s_add_u32 m0, s36, 5056
    s_nop 0
    buffer_load_dwordx4 v2, s[12:15], s37 offen offset:64 lds
    s_add_u32 s37, s37, s38
    s_add_u32 m0, s36, 6144
    s_nop 0
    buffer_load_dwordx4 v2, s[12:15], s37 offen offset:0 lds
    s_add_u32 m0, s36, 7104
    s_nop 0
    buffer_load_dwordx4 v2, s[12:15], s37 offen offset:64 lds
    s_waitcnt vmcnt(32)
    ds_read_b64_tr_b16 a[32:33], v4 offset:8192
    ds_read_b64_tr_b16 a[36:37], v4 offset:8200
    ds_read_b64_tr_b16 a[40:41], v4 offset:9216
    ds_read_b64_tr_b16 a[44:45], v4 offset:9224
    ds_read_b64_tr_b16 a[34:35], v4 offset:10240
    ds_read_b64_tr_b16 a[38:39], v4 offset:10248
    ds_read_b64_tr_b16 a[42:43], v4 offset:11264
    ds_read_b64_tr_b16 a[46:47], v4 offset:11272
    ds_read_b64_tr_b16 a[48:49], v4 offset:12288
    ds_read_b64_tr_b16 a[52:53], v4 offset:12296
    ds_read_b64_tr_b16 a[56:57], v4 offset:13312
    ds_read_b64_tr_b16 a[60:61], v4 offset:13320
    ds_read_b64_tr_b16 a[50:51], v4 offset:14336
    ds_read_b64_tr_b16 a[54:55], v4 offset:14344
    ds_read_b64_tr_b16 a[58:59], v4 offset:15360
    ds_read_b64_tr_b16 a[62:63], v4 offset:15368
    s_waitcnt lgkmcnt(0)
    s_add_u32 s37, s37, s39
    s_add_u32 m0, s36, 8192
    s_nop 0
    buffer_load_dwordx4 v2, s[12:15], s37 offen offset:0 lds
    s_add_u32 m0, s36, 9152
    s_nop 0
    buffer_load_dwordx4 v2, s[12:15], s37 offen offset:64 lds
    s_add_u32 s37, s37, s38
    s_add_u32 m0, s36, 10240
    s_nop 0
    buffer_load_dwordx4 v2, s[12:15], s37 offen offset:0 lds
    s_add_u32 m0, s36, 11200
    s_nop 0
    buffer_load_dwordx4 v2, s[12:15], s37 offen offset:64 lds
    s_add_u32 s37, s37, s39
    s_add_u32 m0, s36, 12288
    s_nop 0
    buffer_load_dwordx4 v2, s[12:15], s37 offen offset:0 lds
    s_add_u32 m0, s36, 13248
    s_nop 0
    buffer_load_dwordx4 v2, s[12:15], s37 offen offset:64 lds
    s_add_u32 s37, s37, s38
    s_add_u32 m0, s36, 14336
    s_nop 0
    buffer_load_dwordx4 v2, s[12:15], s37 offen offset:0 lds
    s_add_u32 m0, s36, 15296
    s_nop 0
    buffer_load_dwordx4 v2, s[12:15], s37 offen offset:64 lds
    s_waitcnt vmcnt(32)
    ds_read_b64_tr_b16 a[64:65], v4 offset:16384
    ds_read_b64_tr_b16 a[68:69], v4 offset:16392
    ds_read_b64_tr_b16 a[72:73], v4 offset:17408
    ds_read_b64_tr_b16 a[76:77], v4 offset:17416
    ds_read_b64_tr_b16 a[66:67], v4 offset:18432
    ds_read_b64_tr_b16 a[70:71], v4 offset:18440
    ds_read_b64_tr_b16 a[74:75], v4 offset:19456
    ds_read_b64_tr_b16 a[78:79], v4 offset:19464
    ds_read_b64_tr_b16 a[80:81], v4 offset:20480
    ds_read_b64_tr_b16 a[84:85], v4 offset:20488
    ds_read_b64_tr_b16 a[88:89], v4 offset:21504
    ds_read_b64_tr_b16 a[92:93], v4 offset:21512
    ds_read_b64_tr_b16 a[82:83], v4 offset:22528
    ds_read_b64_tr_b16 a[86:87], v4 offset:22536
    ds_read_b64_tr_b16 a[90:91], v4 offset:23552
    ds_read_b64_tr_b16 a[94:95], v4 offset:23560
    s_waitcnt lgkmcnt(0)
    s_add_u32 s37, s37, s39
    s_add_u32 m0, s36, 16384
    s_nop 0
    buffer_load_dwordx4 v2, s[12:15], s37 offen offset:0 lds
    s_add_u32 m0, s36, 17344
    s_nop 0
    buffer_load_dwordx4 v2, s[12:15], s37 offen offset:64 lds
    s_add_u32 s37, s37, s38
    s_add_u32 m0, s36, 18432
    s_nop 0
    buffer_load_dwordx4 v2, s[12:15], s37 offen offset:0 lds
    s_add_u32 m0, s36, 19392
    s_nop 0
    buffer_load_dwordx4 v2, s[12:15], s37 offen offset:64 lds
    s_add_u32 s37, s37, s39
    s_add_u32 m0, s36, 20480
    s_nop 0
    buffer_load_dwordx4 v2, s[12:15], s37 offen offset:0 lds
    s_add_u32 m0, s36, 21440
    s_nop 0
    buffer_load_dwordx4 v2, s[12:15], s37 offen offset:64 lds
    s_add_u32 s37, s37, s38
    s_add_u32 m0, s36, 22528
    s_nop 0
    buffer_load_dwordx4 v2, s[12:15], s37 offen offset:0 lds
    s_add_u32 m0, s36, 23488
    s_nop 0
    buffer_load_dwordx4 v2, s[12:15], s37 offen offset:64 lds
    s_waitcnt vmcnt(32)
    ds_read_b64_tr_b16 a[96:97], v4 offset:24576
    ds_read_b64_tr_b16 a[100:101], v4 offset:24584
    ds_read_b64_tr_b16 a[104:105], v4 offset:25600
    ds_read_b64_tr_b16 a[108:109], v4 offset:25608
    ds_read_b64_tr_b16 a[98:99], v4 offset:26624
    ds_read_b64_tr_b16 a[102:103], v4 offset:26632
    ds_read_b64_tr_b16 a[106:107], v4 offset:27648
    ds_read_b64_tr_b16 a[110:111], v4 offset:27656
    ds_read_b64_tr_b16 a[112:113], v4 offset:28672
    ds_read_b64_tr_b16 a[116:117], v4 offset:28680
    ds_read_b64_tr_b16 a[120:121], v4 offset:29696
    ds_read_b64_tr_b16 a[124:125], v4 offset:29704
    ds_read_b64_tr_b16 a[114:115], v4 offset:30720
    ds_read_b64_tr_b16 a[118:119], v4 offset:30728
    ds_read_b64_tr_b16 a[122:123], v4 offset:31744
    ds_read_b64_tr_b16 a[126:127], v4 offset:31752
    s_waitcnt lgkmcnt(0)
    s_add_u32 s37, s37, s39
    s_add_u32 m0, s36, 24576
    s_nop 0
    buffer_load_dwordx4 v2, s[12:15], s37 offen offset:0 lds
    s_add_u32 m0, s36, 25536
    s_nop 0
    buffer_load_dwordx4 v2, s[12:15], s37 offen offset:64 lds
    s_add_u32 s37, s37, s38
    s_add_u32 m0, s36, 26624
    s_nop 0
    buffer_load_dwordx4 v2, s[12:15], s37 offen offset:0 lds
    s_add_u32 m0, s36, 27584
    s_nop 0
    buffer_load_dwordx4 v2, s[12:15], s37 offen offset:64 lds
    s_add_u32 s37, s37, s39
    s_add_u32 m0, s36, 28672
    s_nop 0
    buffer_load_dwordx4 v2, s[12:15], s37 offen offset:0 lds
    s_add_u32 m0, s36, 29632
    s_nop 0
    buffer_load_dwordx4 v2, s[12:15], s37 offen offset:64 lds
    s_add_u32 s37, s37, s38
    s_add_u32 m0, s36, 30720
    s_nop 0
    buffer_load_dwordx4 v2, s[12:15], s37 offen offset:0 lds
    s_add_u32 m0, s36, 31680
    s_nop 0
    buffer_load_dwordx4 v2, s[12:15], s37 offen offset:64 lds
    s_waitcnt vmcnt(32)
    ds_read_b64_tr_b16 a[128:129], v4 offset:32768
    ds_read_b64_tr_b16 a[132:133], v4 offset:32776
    ds_read_b64_tr_b16 a[136:137], v4 offset:33792
    ds_read_b64_tr_b16 a[140:141], v4 offset:33800
    ds_read_b64_tr_b16 a[130:131], v4 offset:34816
    ds_read_b64_tr_b16 a[134:135], v4 offset:34824
    ds_read_b64_tr_b16 a[138:139], v4 offset:35840
    ds_read_b64_tr_b16 a[142:143], v4 offset:35848
    ds_read_b64_tr_b16 a[144:145], v4 offset:36864
    ds_read_b64_tr_b16 a[148:149], v4 offset:36872
    ds_read_b64_tr_b16 a[152:153], v4 offset:37888
    ds_read_b64_tr_b16 a[156:157], v4 offset:37896
    ds_read_b64_tr_b16 a[146:147], v4 offset:38912
    ds_read_b64_tr_b16 a[150:151], v4 offset:38920
    ds_read_b64_tr_b16 a[154:155], v4 offset:39936
    ds_read_b64_tr_b16 a[158:159], v4 offset:39944
    s_waitcnt lgkmcnt(0)
    s_add_u32 s37, s37, s39
    s_add_u32 m0, s36, 32768
    s_nop 0
    buffer_load_dwordx4 v2, s[12:15], s37 offen offset:0 lds
    s_add_u32 m0, s36, 33728
    s_nop 0
    buffer_load_dwordx4 v2, s[12:15], s37 offen offset:64 lds
    s_add_u32 s37, s37, s38
    s_add_u32 m0, s36, 34816
    s_nop 0
    buffer_load_dwordx4 v2, s[12:15], s37 offen offset:0 lds
    s_add_u32 m0, s36, 35776
    s_nop 0
    buffer_load_dwordx4 v2, s[12:15], s37 offen offset:64 lds
    s_add_u32 s37, s37, s39
    s_add_u32 m0, s36, 36864
    s_nop 0
    buffer_load_dwordx4 v2, s[12:15], s37 offen offset:0 lds
    s_add_u32 m0, s36, 37824
    s_nop 0
    buffer_load_dwordx4 v2, s[12:15], s37 offen offset:64 lds
    s_add_u32 s37, s37, s38
    s_add_u32 m0, s36, 38912
    s_nop 0
    buffer_load_dwordx4 v2, s[12:15], s37 offen offset:0 lds
    s_add_u32 m0, s36, 39872
    s_nop 0
    buffer_load_dwordx4 v2, s[12:15], s37 offen offset:64 lds
    s_waitcnt vmcnt(32)
    ds_read_b64_tr_b16 a[160:161], v4 offset:0
    ds_read_b64_tr_b16 a[164:165], v4 offset:8
    ds_read_b64_tr_b16 a[168:169], v4 offset:1024
    ds_read_b64_tr_b16 a[172:173], v4 offset:1032
    ds_read_b64_tr_b16 a[162:163], v4 offset:2048
    ds_read_b64_tr_b16 a[166:167], v4 offset:2056
    ds_read_b64_tr_b16 a[170:171], v4 offset:3072
    ds_read_b64_tr_b16 a[174:175], v4 offset:3080
    ds_read_b64_tr_b16 a[176:177], v4 offset:4096
    ds_read_b64_tr_b16 a[180:181], v4 offset:4104
    ds_read_b64_tr_b16 a[184:185], v4 offset:5120
    ds_read_b64_tr_b16 a[188:189], v4 offset:5128
    ds_read_b64_tr_b16 a[178:179], v4 offset:6144
    ds_read_b64_tr_b16 a[182:183], v4 offset:6152
    ds_read_b64_tr_b16 a[186:187], v4 offset:7168
    ds_read_b64_tr_b16 a[190:191], v4 offset:7176
    s_waitcnt vmcnt(24)
    ds_read_b64_tr_b16 a[192:193], v4 offset:8192
    ds_read_b64_tr_b16 a[196:197], v4 offset:8200
    ds_read_b64_tr_b16 a[200:201], v4 offset:9216
    ds_read_b64_tr_b16 a[204:205], v4 offset:9224
    ds_read_b64_tr_b16 a[194:195], v4 offset:10240
    ds_read_b64_tr_b16 a[198:199], v4 offset:10248
    ds_read_b64_tr_b16 a[202:203], v4 offset:11264
    ds_read_b64_tr_b16 a[206:207], v4 offset:11272
    ds_read_b64_tr_b16 a[208:209], v4 offset:12288
    ds_read_b64_tr_b16 a[212:213], v4 offset:12296
    ds_read_b64_tr_b16 a[216:217], v4 offset:13312
    ds_read_b64_tr_b16 a[220:221], v4 offset:13320
    ds_read_b64_tr_b16 a[210:211], v4 offset:14336
    ds_read_b64_tr_b16 a[214:215], v4 offset:14344
    ds_read_b64_tr_b16 a[218:219], v4 offset:15360
    ds_read_b64_tr_b16 a[222:223], v4 offset:15368
    s_waitcnt vmcnt(16)
    ds_read_b64_tr_b16 a[224:225], v4 offset:16384
    ds_read_b64_tr_b16 a[228:229], v4 offset:16392
    ds_read_b64_tr_b16 a[232:233], v4 offset:17408
    ds_read_b64_tr_b16 a[236:237], v4 offset:17416
    ds_read_b64_tr_b16 a[226:227], v4 offset:18432
    ds_read_b64_tr_b16 a[230:231], v4 offset:18440
    ds_read_b64_tr_b16 a[234:235], v4 offset:19456
    ds_read_b64_tr_b16 a[238:239], v4 offset:19464
    ds_read_b64_tr_b16 a[240:241], v4 offset:20480
    ds_read_b64_tr_b16 a[244:245], v4 offset:20488
    ds_read_b64_tr_b16 a[248:249], v4 offset:21504
    ds_read_b64_tr_b16 a[252:253], v4 offset:21512
    ds_read_b64_tr_b16 a[242:243], v4 offset:22528
    ds_read_b64_tr_b16 a[246:247], v4 offset:22536
    ds_read_b64_tr_b16 a[250:251], v4 offset:23552
    ds_read_b64_tr_b16 a[254:255], v4 offset:23560
    s_load_dword s50, s[88:89], 64
    s_waitcnt vmcnt(8)
    ds_read_b64_tr_b16 v[192:193], v4 offset:24576
    ds_read_b64_tr_b16 v[196:197], v4 offset:24584
    ds_read_b64_tr_b16 v[200:201], v4 offset:25600
    ds_read_b64_tr_b16 v[204:205], v4 offset:25608
    ds_read_b64_tr_b16 v[194:195], v4 offset:26624
    ds_read_b64_tr_b16 v[198:199], v4 offset:26632
    ds_read_b64_tr_b16 v[202:203], v4 offset:27648
    ds_read_b64_tr_b16 v[206:207], v4 offset:27656
    ds_read_b64_tr_b16 v[208:209], v4 offset:28672
    ds_read_b64_tr_b16 v[212:213], v4 offset:28680
    ds_read_b64_tr_b16 v[216:217], v4 offset:29696
    ds_read_b64_tr_b16 v[220:221], v4 offset:29704
    ds_read_b64_tr_b16 v[210:211], v4 offset:30720
    ds_read_b64_tr_b16 v[214:215], v4 offset:30728
    ds_read_b64_tr_b16 v[218:219], v4 offset:31744
    ds_read_b64_tr_b16 v[222:223], v4 offset:31752
    s_waitcnt vmcnt(0)
    ds_read_b64_tr_b16 v[224:225], v4 offset:32768
    ds_read_b64_tr_b16 v[228:229], v4 offset:32776
    ds_read_b64_tr_b16 v[232:233], v4 offset:33792
    ds_read_b64_tr_b16 v[236:237], v4 offset:33800
    ds_read_b64_tr_b16 v[226:227], v4 offset:34816
    ds_read_b64_tr_b16 v[230:231], v4 offset:34824
    ds_read_b64_tr_b16 v[234:235], v4 offset:35840
    ds_read_b64_tr_b16 v[238:239], v4 offset:35848
    ds_read_b64_tr_b16 v[240:241], v4 offset:36864
    ds_read_b64_tr_b16 v[244:245], v4 offset:36872
    ds_read_b64_tr_b16 v[248:249], v4 offset:37888
    ds_read_b64_tr_b16 v[252:253], v4 offset:37896
    ds_read_b64_tr_b16 v[242:243], v4 offset:38912
    ds_read_b64_tr_b16 v[246:247], v4 offset:38920
    ds_read_b64_tr_b16 v[250:251], v4 offset:39936
    ds_read_b64_tr_b16 v[254:255], v4 offset:39944
    s_waitcnt lgkmcnt(0)
    s_cmp_lg_u32 s3, 0
    s_cbranch_scc1 dwok_recurrent_scan__memory_aug_recurrent_mem_tr__dense_activation_mish__prompt_kernel_101
    s_mov_b32 s52, 0
    s_cmp_eq_u32 s50, 1
    s_cbranch_scc1 dwi_recurrent_scan__memory_aug_recurrent_mem_tr__dense_activation_mish__prompt_kernel_102
    s_mov_b32 s56, s88
    s_and_b32 s57, s89, 0xffff
    s_mov_b32 s58, 256
    s_mov_b32 s59, 0x20000
dw_recurrent_scan__memory_aug_recurrent_mem_tr__dense_activation_mish__prompt_kernel_100:
    buffer_load_dword v6, off, s[56:59], 0 offset:64 sc1
    s_waitcnt vmcnt(0)
    v_readfirstlane_b32 s50, v6
    s_cmp_eq_u32 s50, 1
    s_cbranch_scc1 dwi_recurrent_scan__memory_aug_recurrent_mem_tr__dense_activation_mish__prompt_kernel_102
    s_add_u32 s52, s52, 1
    s_cmp_gt_u32 s52, 100000
    s_cbranch_scc1 dwok_recurrent_scan__memory_aug_recurrent_mem_tr__dense_activation_mish__prompt_kernel_101
    s_sleep 8
    s_branch dw_recurrent_scan__memory_aug_recurrent_mem_tr__dense_activation_mish__prompt_kernel_100
dwi_recurrent_scan__memory_aug_recurrent_mem_tr__dense_activation_mish__prompt_kernel_102:
    v_mbcnt_lo_u32_b32 v7, -1, 0
    v_min_u32 v7, 31, v7
    v_lshlrev_b32 v7, 2, v7
    s_lshl_b32 s51, s4, 8
    s_add_u32 s51, s51, 97925120
dl_recurrent_scan__memory_aug_recurrent_mem_tr__dense_activation_mish__prompt_kernel_103:
    buffer_load_dword v6, v7, s[8:11], s51 offen sc1
    s_waitcnt vmcnt(0)
    v_cmp_eq_u32 vcc, 0, v6
    s_cbranch_vccz dwok_recurrent_scan__memory_aug_recurrent_mem_tr__dense_activation_mish__prompt_kernel_101
    s_add_u32 s52, s52, 1
    s_cmp_gt_u32 s52, 100000
    s_cbranch_scc1 dwok_recurrent_scan__memory_aug_recurrent_mem_tr__dense_activation_mish__prompt_kernel_101
    s_sleep 4
    s_branch dl_recurrent_scan__memory_aug_recurrent_mem_tr__dense_activation_mish__prompt_kernel_103
dwok_recurrent_scan__memory_aug_recurrent_mem_tr__dense_activation_mish__prompt_kernel_101:
    s_barrier
    s_mul_i32 s46, s3, 10240
    s_add_u32 s45, s46, 0
    s_mov_b32 s40, s26
    s_mov_b32 s41, 0
    s_mov_b32 s43, 40960
    s_add_u32 s42, s26, s27
    s_min_u32 s44, s40, 63
    s_mul_i32 s44, s44, 40960
    s_add_u32 s44, s44, s45
    s_add_u32 m0, s41, s46
    s_nop 0
    buffer_load_dwordx4 v3, s[8:11], s44 offen offset:0 sc1 lds
    buffer_load_dwordx4 v3, s[8:11], s44 offen offset:1024 sc1 lds
    buffer_load_dwordx4 v3, s[8:11], s44 offen offset:2048 sc1 lds
    buffer_load_dwordx4 v3, s[8:11], s44 offen offset:3072 sc1 lds
    s_add_u32 s44, s44, 4096
    s_add_u32 m0, m0, 4096
    s_nop 0
    buffer_load_dwordx4 v3, s[8:11], s44 offen offset:0 sc1 lds
    buffer_load_dwordx4 v3, s[8:11], s44 offen offset:1024 sc1 lds
    buffer_load_dwordx4 v3, s[8:11], s44 offen offset:2048 sc1 lds
    buffer_load_dwordx4 v3, s[8:11], s44 offen offset:3072 sc1 lds
    s_add_u32 s44, s44, 4096
    s_add_u32 m0, m0, 4096
    s_nop 0
    buffer_load_dwordx4 v3, s[8:11], s44 offen offset:0 sc1 lds
    buffer_load_dwordx4 v3, s[8:11], s44 offen offset:1024 sc1 lds
    s_min_u32 s44, s42, 63
    s_mul_i32 s44, s44, 40960
    s_add_u32 s44, s44, s45
    s_add_u32 m0, s43, s46
    s_nop 0
    buffer_load_dwordx4 v3, s[8:11], s44 offen offset:0 sc1 lds
    buffer_load_dwordx4 v3, s[8:11], s44 offen offset:1024 sc1 lds
    buffer_load_dwordx4 v3, s[8:11], s44 offen offset:2048 sc1 lds
    buffer_load_dwordx4 v3, s[8:11], s44 offen offset:3072 sc1 lds
    s_add_u32 s44, s44, 4096
    s_add_u32 m0, m0, 4096
    s_nop 0
    buffer_load_dwordx4 v3, s[8:11], s44 offen offset:0 sc1 lds
    buffer_load_dwordx4 v3, s[8:11], s44 offen offset:1024 sc1 lds
    buffer_load_dwordx4 v3, s[8:11], s44 offen offset:2048 sc1 lds
    buffer_load_dwordx4 v3, s[8:11], s44 offen offset:3072 sc1 lds
    s_add_u32 s44, s44, 4096
    s_add_u32 m0, m0, 4096
    s_nop 0
    buffer_load_dwordx4 v3, s[8:11], s44 offen offset:0 sc1 lds
    buffer_load_dwordx4 v3, s[8:11], s44 offen offset:1024 sc1 lds
    s_add_u32 s42, s42, s27
    s_mov_b32 s43, 81920
    s_waitcnt vmcnt(10)
    s_cmp_eq_u32 s28, 2
    s_cbranch_scc1 g1loop_v_recurrent_scan__memory_aug_recurrent_mem_tr__dense_activation_mish__prompt_kernel_105
    s_cmp_eq_u32 s28, 3
    s_cbranch_scc1 g1loop_ffn_recurrent_scan__memory_aug_recurrent_mem_tr__dense_activation_mish__prompt_kernel_106
g1loop_qk_recurrent_scan__memory_aug_recurrent_mem_tr__dense_activation_mish__prompt_kernel_104:
    s_barrier
    s_min_u32 s44, s42, 63
    s_mul_i32 s44, s44, 40960
    s_add_u32 s44, s44, s45
    s_add_u32 m0, s43, s46
    s_nop 0
    buffer_load_dwordx4 v3, s[8:11], s44 offen offset:0 sc1 lds
    buffer_load_dwordx4 v3, s[8:11], s44 offen offset:1024 sc1 lds
    buffer_load_dwordx4 v3, s[8:11], s44 offen offset:2048 sc1 lds
    buffer_load_dwordx4 v3, s[8:11], s44 offen offset:3072 sc1 lds
    s_add_u32 s44, s44, 4096
    s_add_u32 m0, m0, 4096
    s_nop 0
    buffer_load_dwordx4 v3, s[8:11], s44 offen offset:0 sc1 lds
    buffer_load_dwordx4 v3, s[8:11], s44 offen offset:1024 sc1 lds
    buffer_load_dwordx4 v3, s[8:11], s44 offen offset:2048 sc1 lds
    buffer_load_dwordx4 v3, s[8:11], s44 offen offset:3072 sc1 lds
    s_add_u32 s44, s44, 4096
    s_add_u32 m0, m0, 4096
    s_nop 0
    buffer_load_dwordx4 v3, s[8:11], s44 offen offset:0 sc1 lds
    buffer_load_dwordx4 v3, s[8:11], s44 offen offset:1024 sc1 lds
    v_add_u32 v5, s41, v3
    ds_read_b128 v[48:51], v5 offset:0
    ds_read_b128 v[52:55], v5 offset:1024
    ds_read_b128 v[56:59], v5 offset:2048
    ds_read_b128 v[60:63], v5 offset:3072
    ds_read_b128 v[64:67], v5 offset:4096
    ds_read_b128 v[68:71], v5 offset:5120
    ds_read_b128 v[72:75], v5 offset:6144
    ds_read_b128 v[76:79], v5 offset:7168
    s_waitcnt lgkmcnt(6)
    v_mfma_f32_16x16x32_bf16 v[16:19], a[0:3], v[48:51], 0
    v_mfma_f32_16x16x32_bf16 v[20:23], a[0:3], v[52:55], 0
    v_mfma_f32_16x16x32_bf16 v[24:27], a[4:7], v[48:51], 0
    v_mfma_f32_16x16x32_bf16 v[28:31], a[4:7], v[52:55], 0
    v_mfma_f32_16x16x32_bf16 v[32:35], a[8:11], v[48:51], 0
    v_mfma_f32_16x16x32_bf16 v[36:39], a[8:11], v[52:55], 0
    v_mfma_f32_16x16x32_bf16 v[40:43], a[12:15], v[48:51], 0
    v_mfma_f32_16x16x32_bf16 v[44:47], a[12:15], v[52:55], 0
    ds_read_b128 v[48:51], v5 offset:8192
    ds_read_b128 v[52:55], v5 offset:9216
    s_waitcnt lgkmcnt(6)
    v_mfma_f32_16x16x32_bf16 v[16:19], a[16:19], v[56:59], v[16:19]
    v_mfma_f32_16x16x32_bf16 v[20:23], a[16:19], v[60:63], v[20:23]
    v_mfma_f32_16x16x32_bf16 v[24:27], a[20:23], v[56:59], v[24:27]
    v_mfma_f32_16x16x32_bf16 v[28:31], a[20:23], v[60:63], v[28:31]
    v_mfma_f32_16x16x32_bf16 v[32:35], a[24:27], v[56:59], v[32:35]
    v_mfma_f32_16x16x32_bf16 v[36:39], a[24:27], v[60:63], v[36:39]
    v_mfma_f32_16x16x32_bf16 v[40:43], a[28:31], v[56:59], v[40:43]
    v_mfma_f32_16x16x32_bf16 v[44:47], a[28:31], v[60:63], v[44:47]
    ds_read_b128 v[56:59], v5 offset:10240
    ds_read_b128 v[60:63], v5 offset:11264
    s_waitcnt lgkmcnt(6)
    v_mfma_f32_16x16x32_bf16 v[16:19], a[32:35], v[64:67], v[16:19]
    v_mfma_f32_16x16x32_bf16 v[20:23], a[32:35], v[68:71], v[20:23]
    v_mfma_f32_16x16x32_bf16 v[24:27], a[36:39], v[64:67], v[24:27]
    v_mfma_f32_16x16x32_bf16 v[28:31], a[36:39], v[68:71], v[28:31]
    v_mfma_f32_16x16x32_bf16 v[32:35], a[40:43], v[64:67], v[32:35]
    v_mfma_f32_16x16x32_bf16 v[36:39], a[40:43], v[68:71], v[36:39]
    v_mfma_f32_16x16x32_bf16 v[40:43], a[44:47], v[64:67], v[40:43]
    v_mfma_f32_16x16x32_bf16 v[44:47], a[44:47], v[68:71], v[44:47]
    ds_read_b128 v[64:67], v5 offset:12288
    ds_read_b128 v[68:71], v5 offset:13312
    s_waitcnt lgkmcnt(6)
    v_mfma_f32_16x16x32_bf16 v[16:19], a[48:51], v[72:75], v[16:19]
    v_mfma_f32_16x16x32_bf16 v[20:23], a[48:51], v[76:79], v[20:23]
    v_mfma_f32_16x16x32_bf16 v[24:27], a[52:55], v[72:75], v[24:27]
    v_mfma_f32_16x16x32_bf16 v[28:31], a[52:55], v[76:79], v[28:31]
    v_mfma_f32_16x16x32_bf16 v[32:35], a[56:59], v[72:75], v[32:35]
    v_mfma_f32_16x16x32_bf16 v[36:39], a[56:59], v[76:79], v[36:39]
    v_mfma_f32_16x16x32_bf16 v[40:43], a[60:63], v[72:75], v[40:43]
    v_mfma_f32_16x16x32_bf16 v[44:47], a[60:63], v[76:79], v[44:47]
    ds_read_b128 v[72:75], v5 offset:14336
    ds_read_b128 v[76:79], v5 offset:15360
    s_waitcnt lgkmcnt(6)
    v_mfma_f32_16x16x32_bf16 v[16:19], a[64:67], v[48:51], v[16:19]
    v_mfma_f32_16x16x32_bf16 v[20:23], a[64:67], v[52:55], v[20:23]
    v_mfma_f32_16x16x32_bf16 v[24:27], a[68:71], v[48:51], v[24:27]
    v_mfma_f32_16x16x32_bf16 v[28:31], a[68:71], v[52:55], v[28:31]
    v_mfma_f32_16x16x32_bf16 v[32:35], a[72:75], v[48:51], v[32:35]
    v_mfma_f32_16x16x32_bf16 v[36:39], a[72:75], v[52:55], v[36:39]
    v_mfma_f32_16x16x32_bf16 v[40:43], a[76:79], v[48:51], v[40:43]
    v_mfma_f32_16x16x32_bf16 v[44:47], a[76:79], v[52:55], v[44:47]
    ds_read_b128 v[48:51], v5 offset:16384
    ds_read_b128 v[52:55], v5 offset:17408
    s_waitcnt lgkmcnt(6)
    v_mfma_f32_16x16x32_bf16 v[16:19], a[80:83], v[56:59], v[16:19]
    v_mfma_f32_16x16x32_bf16 v[20:23], a[80:83], v[60:63], v[20:23]
    v_mfma_f32_16x16x32_bf16 v[24:27], a[84:87], v[56:59], v[24:27]
    v_mfma_f32_16x16x32_bf16 v[28:31], a[84:87], v[60:63], v[28:31]
    v_mfma_f32_16x16x32_bf16 v[32:35], a[88:91], v[56:59], v[32:35]
    v_mfma_f32_16x16x32_bf16 v[36:39], a[88:91], v[60:63], v[36:39]
    v_mfma_f32_16x16x32_bf16 v[40:43], a[92:95], v[56:59], v[40:43]
    v_mfma_f32_16x16x32_bf16 v[44:47], a[92:95], v[60:63], v[44:47]
    ds_read_b128 v[56:59], v5 offset:18432
    ds_read_b128 v[60:63], v5 offset:19456
    s_waitcnt lgkmcnt(6)
    v_mfma_f32_16x16x32_bf16 v[16:19], a[96:99], v[64:67], v[16:19]
    v_mfma_f32_16x16x32_bf16 v[20:23], a[96:99], v[68:71], v[20:23]
    v_mfma_f32_16x16x32_bf16 v[24:27], a[100:103], v[64:67], v[24:27]
    v_mfma_f32_16x16x32_bf16 v[28:31], a[100:103], v[68:71], v[28:31]
    v_mfma_f32_16x16x32_bf16 v[32:35], a[104:107], v[64:67], v[32:35]
    v_mfma_f32_16x16x32_bf16 v[36:39], a[104:107], v[68:71], v[36:39]
    v_mfma_f32_16x16x32_bf16 v[40:43], a[108:111], v[64:67], v[40:43]
    v_mfma_f32_16x16x32_bf16 v[44:47], a[108:111], v[68:71], v[44:47]
    ds_read_b128 v[64:67], v5 offset:20480
    ds_read_b128 v[68:71], v5 offset:21504
    s_waitcnt lgkmcnt(6)
    v_mfma_f32_16x16x32_bf16 v[16:19], a[112:115], v[72:75], v[16:19]
    v_mfma_f32_16x16x32_bf16 v[20:23], a[112:115], v[76:79], v[20:23]
    v_mfma_f32_16x16x32_bf16 v[24:27], a[116:119], v[72:75], v[24:27]
    v_mfma_f32_16x16x32_bf16 v[28:31], a[116:119], v[76:79], v[28:31]
    v_mfma_f32_16x16x32_bf16 v[32:35], a[120:123], v[72:75], v[32:35]
    v_mfma_f32_16x16x32_bf16 v[36:39], a[120:123], v[76:79], v[36:39]
    v_mfma_f32_16x16x32_bf16 v[40:43], a[124:127], v[72:75], v[40:43]
    v_mfma_f32_16x16x32_bf16 v[44:47], a[124:127], v[76:79], v[44:47]
    ds_read_b128 v[72:75], v5 offset:22528
    ds_read_b128 v[76:79], v5 offset:23552
    s_waitcnt lgkmcnt(6)
    v_mfma_f32_16x16x32_bf16 v[16:19], a[128:131], v[48:51], v[16:19]
    v_mfma_f32_16x16x32_bf16 v[20:23], a[128:131], v[52:55], v[20:23]
    v_mfma_f32_16x16x32_bf16 v[24:27], a[132:135], v[48:51], v[24:27]
    v_mfma_f32_16x16x32_bf16 v[28:31], a[132:135], v[52:55], v[28:31]
    v_mfma_f32_16x16x32_bf16 v[32:35], a[136:139], v[48:51], v[32:35]
    v_mfma_f32_16x16x32_bf16 v[36:39], a[136:139], v[52:55], v[36:39]
    v_mfma_f32_16x16x32_bf16 v[40:43], a[140:143], v[48:51], v[40:43]
    v_mfma_f32_16x16x32_bf16 v[44:47], a[140:143], v[52:55], v[44:47]
    ds_read_b128 v[48:51], v5 offset:24576
    ds_read_b128 v[52:55], v5 offset:25600
    s_waitcnt lgkmcnt(6)
    v_mfma_f32_16x16x32_bf16 v[16:19], a[144:147], v[56:59], v[16:19]
    v_mfma_f32_16x16x32_bf16 v[20:23], a[144:147], v[60:63], v[20:23]
    v_mfma_f32_16x16x32_bf16 v[24:27], a[148:151], v[56:59], v[24:27]
    v_mfma_f32_16x16x32_bf16 v[28:31], a[148:151], v[60:63], v[28:31]
    v_mfma_f32_16x16x32_bf16 v[32:35], a[152:155], v[56:59], v[32:35]
    v_mfma_f32_16x16x32_bf16 v[36:39], a[152:155], v[60:63], v[36:39]
    v_mfma_f32_16x16x32_bf16 v[40:43], a[156:159], v[56:59], v[40:43]
    v_mfma_f32_16x16x32_bf16 v[44:47], a[156:159], v[60:63], v[44:47]
    ds_read_b128 v[56:59], v5 offset:26624
    ds_read_b128 v[60:63], v5 offset:27648
    s_waitcnt lgkmcnt(6)
    v_mfma_f32_16x16x32_bf16 v[16:19], a[160:163], v[64:67], v[16:19]
    v_mfma_f32_16x16x32_bf16 v[20:23], a[160:163], v[68:71], v[20:23]
    v_mfma_f32_16x16x32_bf16 v[24:27], a[164:167], v[64:67], v[24:27]
    v_mfma_f32_16x16x32_bf16 v[28:31], a[164:167], v[68:71], v[28:31]
    v_mfma_f32_16x16x32_bf16 v[32:35], a[168:171], v[64:67], v[32:35]
    v_mfma_f32_16x16x32_bf16 v[36:39], a[168:171], v[68:71], v[36:39]
    v_mfma_f32_16x16x32_bf16 v[40:43], a[172:175], v[64:67], v[40:43]
    v_mfma_f32_16x16x32_bf16 v[44:47], a[172:175], v[68:71], v[44:47]
    ds_read_b128 v[64:67], v5 offset:28672
    ds_read_b128 v[68:71], v5 offset:29696
    s_waitcnt lgkmcnt(6)
    v_mfma_f32_16x16x32_bf16 v[16:19], a[176:179], v[72:75], v[16:19]
    v_mfma_f32_16x16x32_bf16 v[20:23], a[176:179], v[76:79], v[20:23]
    v_mfma_f32_16x16x32_bf16 v[24:27], a[180:183], v[72:75], v[24:27]
    v_mfma_f32_16x16x32_bf16 v[28:31], a[180:183], v[76:79], v[28:31]
    v_mfma_f32_16x16x32_bf16 v[32:35], a[184:187], v[72:75], v[32:35]
    v_mfma_f32_16x16x32_bf16 v[36:39], a[184:187], v[76:79], v[36:39]
    v_mfma_f32_16x16x32_bf16 v[40:43], a[188:191], v[72:75], v[40:43]
    v_mfma_f32_16x16x32_bf16 v[44:47], a[188:191], v[76:79], v[44:47]
    ds_read_b128 v[72:75], v5 offset:30720
    ds_read_b128 v[76:79], v5 offset:31744
    s_waitcnt lgkmcnt(6)
    v_mfma_f32_16x16x32_bf16 v[16:19], a[192:195], v[48:51], v[16:19]
    v_mfma_f32_16x16x32_bf16 v[20:23], a[192:195], v[52:55], v[20:23]
    v_mfma_f32_16x16x32_bf16 v[24:27], a[196:199], v[48:51], v[24:27]
    v_mfma_f32_16x16x32_bf16 v[28:31], a[196:199], v[52:55], v[28:31]
    v_mfma_f32_16x16x32_bf16 v[32:35], a[200:203], v[48:51], v[32:35]
    v_mfma_f32_16x16x32_bf16 v[36:39], a[200:203], v[52:55], v[36:39]
    v_mfma_f32_16x16x32_bf16 v[40:43], a[204:207], v[48:51], v[40:43]
    v_mfma_f32_16x16x32_bf16 v[44:47], a[204:207], v[52:55], v[44:47]
    ds_read_b128 v[48:51], v5 offset:32768
    ds_read_b128 v[52:55], v5 offset:33792
    s_waitcnt lgkmcnt(6)
    v_mfma_f32_16x16x32_bf16 v[16:19], a[208:211], v[56:59], v[16:19]
    v_mfma_f32_16x16x32_bf16 v[20:23], a[208:211], v[60:63], v[20:23]
    v_mfma_f32_16x16x32_bf16 v[24:27], a[212:215], v[56:59], v[24:27]
    v_mfma_f32_16x16x32_bf16 v[28:31], a[212:215], v[60:63], v[28:31]
    v_mfma_f32_16x16x32_bf16 v[32:35], a[216:219], v[56:59], v[32:35]
    v_mfma_f32_16x16x32_bf16 v[36:39], a[216:219], v[60:63], v[36:39]
    v_mfma_f32_16x16x32_bf16 v[40:43], a[220:223], v[56:59], v[40:43]
    v_mfma_f32_16x16x32_bf16 v[44:47], a[220:223], v[60:63], v[44:47]
    ds_read_b128 v[56:59], v5 offset:34816
    ds_read_b128 v[60:63], v5 offset:35840
    s_waitcnt lgkmcnt(6)
    v_mfma_f32_16x16x32_bf16 v[16:19], a[224:227], v[64:67], v[16:19]
    v_mfma_f32_16x16x32_bf16 v[20:23], a[224:227], v[68:71], v[20:23]
    v_mfma_f32_16x16x32_bf16 v[24:27], a[228:231], v[64:67], v[24:27]
    v_mfma_f32_16x16x32_bf16 v[28:31], a[228:231], v[68:71], v[28:31]
    v_mfma_f32_16x16x32_bf16 v[32:35], a[232:235], v[64:67], v[32:35]
    v_mfma_f32_16x16x32_bf16 v[36:39], a[232:235], v[68:71], v[36:39]
    v_mfma_f32_16x16x32_bf16 v[40:43], a[236:239], v[64:67], v[40:43]
    v_mfma_f32_16x16x32_bf16 v[44:47], a[236:239], v[68:71], v[44:47]
    ds_read_b128 v[64:67], v5 offset:36864
    ds_read_b128 v[68:71], v5 offset:37888
    s_waitcnt lgkmcnt(6)
    v_mfma_f32_16x16x32_bf16 v[16:19], a[240:243], v[72:75], v[16:19]
    v_mfma_f32_16x16x32_bf16 v[20:23], a[240:243], v[76:79], v[20:23]
    v_mfma_f32_16x16x32_bf16 v[24:27], a[244:247], v[72:75], v[24:27]
    v_mfma_f32_16x16x32_bf16 v[28:31], a[244:247], v[76:79], v[28:31]
    v_mfma_f32_16x16x32_bf16 v[32:35], a[248:251], v[72:75], v[32:35]
    v_mfma_f32_16x16x32_bf16 v[36:39], a[248:251], v[76:79], v[36:39]
    v_mfma_f32_16x16x32_bf16 v[40:43], a[252:255], v[72:75], v[40:43]
    v_mfma_f32_16x16x32_bf16 v[44:47], a[252:255], v[76:79], v[44:47]
    ds_read_b128 v[72:75], v5 offset:38912
    ds_read_b128 v[76:79], v5 offset:39936
    s_waitcnt lgkmcnt(6)
    v_mfma_f32_16x16x32_bf16 v[16:19], v[192:195], v[48:51], v[16:19]
    v_mfma_f32_16x16x32_bf16 v[20:23], v[192:195], v[52:55], v[20:23]
    v_mfma_f32_16x16x32_bf16 v[24:27], v[196:199], v[48:51], v[24:27]
    v_mfma_f32_16x16x32_bf16 v[28:31], v[196:199], v[52:55], v[28:31]
    v_mfma_f32_16x16x32_bf16 v[32:35], v[200:203], v[48:51], v[32:35]
    v_mfma_f32_16x16x32_bf16 v[36:39], v[200:203], v[52:55], v[36:39]
    v_mfma_f32_16x16x32_bf16 v[40:43], v[204:207], v[48:51], v[40:43]
    v_mfma_f32_16x16x32_bf16 v[44:47], v[204:207], v[52:55], v[44:47]
    s_waitcnt lgkmcnt(4)
    v_mfma_f32_16x16x32_bf16 v[16:19], v[208:211], v[56:59], v[16:19]
    v_mfma_f32_16x16x32_bf16 v[20:23], v[208:211], v[60:63], v[20:23]
    v_mfma_f32_16x16x32_bf16 v[24:27], v[212:215], v[56:59], v[24:27]
    v_mfma_f32_16x16x32_bf16 v[28:31], v[212:215], v[60:63], v[28:31]
    v_mfma_f32_16x16x32_bf16 v[32:35], v[216:219], v[56:59], v[32:35]
    v_mfma_f32_16x16x32_bf16 v[36:39], v[216:219], v[60:63], v[36:39]
    v_mfma_f32_16x16x32_bf16 v[40:43], v[220:223], v[56:59], v[40:43]
    v_mfma_f32_16x16x32_bf16 v[44:47], v[220:223], v[60:63], v[44:47]
    s_waitcnt lgkmcnt(2)
    v_mfma_f32_16x16x32_bf16 v[16:19], v[224:227], v[64:67], v[16:19]
    v_mfma_f32_16x16x32_bf16 v[20:23], v[224:227], v[68:71], v[20:23]
    v_mfma_f32_16x16x32_bf16 v[24:27], v[228:231], v[64:67], v[24:27]
    v_mfma_f32_16x16x32_bf16 v[28:31], v[228:231], v[68:71], v[28:31]
    v_mfma_f32_16x16x32_bf16 v[32:35], v[232:235], v[64:67], v[32:35]
    v_mfma_f32_16x16x32_bf16 v[36:39], v[232:235], v[68:71], v[36:39]
    v_mfma_f32_16x16x32_bf16 v[40:43], v[236:239], v[64:67], v[40:43]
    v_mfma_f32_16x16x32_bf16 v[44:47], v[236:239], v[68:71], v[44:47]
    s_waitcnt lgkmcnt(0)
    v_mfma_f32_16x16x32_bf16 v[16:19], v[240:243], v[72:75], v[16:19]
    v_mfma_f32_16x16x32_bf16 v[20:23], v[240:243], v[76:79], v[20:23]
    v_mfma_f32_16x16x32_bf16 v[24:27], v[244:247], v[72:75], v[24:27]
    v_mfma_f32_16x16x32_bf16 v[28:31], v[244:247], v[76:79], v[28:31]
    v_mfma_f32_16x16x32_bf16 v[32:35], v[248:251], v[72:75], v[32:35]
    v_mfma_f32_16x16x32_bf16 v[36:39], v[248:251], v[76:79], v[36:39]
    v_mfma_f32_16x16x32_bf16 v[40:43], v[252:255], v[72:75], v[40:43]
    v_mfma_f32_16x16x32_bf16 v[44:47], v[252:255], v[76:79], v[44:47]
    s_mul_i32 s47, s40, s32
    s_add_u32 s47, s47, s31
    v_cvt_pk_bf16_f32 v80, v16, v17
    v_cvt_pk_bf16_f32 v81, v18, v19
    v_cvt_pk_bf16_f32 v82, v24, v25
    v_cvt_pk_bf16_f32 v83, v26, v27
    buffer_store_dwordx4 v[80:83], v3, s[8:11], s47 offen offset:0 sc1
    v_cvt_pk_bf16_f32 v84, v20, v21
    v_cvt_pk_bf16_f32 v85, v22, v23
    v_cvt_pk_bf16_f32 v86, v28, v29
    v_cvt_pk_bf16_f32 v87, v30, v31
    buffer_store_dwordx4 v[84:87], v3, s[8:11], s47 offen offset:1024 sc1
    v_cvt_pk_bf16_f32 v88, v32, v33
    v_cvt_pk_bf16_f32 v89, v34, v35
    v_cvt_pk_bf16_f32 v90, v40, v41
    v_cvt_pk_bf16_f32 v91, v42, v43
    buffer_store_dwordx4 v[88:91], v3, s[8:11], s47 offen offset:2048 sc1
    v_cvt_pk_bf16_f32 v92, v36, v37
    v_cvt_pk_bf16_f32 v93, v38, v39
    v_cvt_pk_bf16_f32 v94, v44, v45
    v_cvt_pk_bf16_f32 v95, v46, v47
    buffer_store_dwordx4 v[92:95], v3, s[8:11], s47 offen offset:3072 sc1
    v_mov_b32 v6, s40
    s_add_u32 s40, s40, s27
    s_add_u32 s42, s42, s27
    s_mov_b32 s43, s41
    s_add_u32 s41, s41, 40960
    s_cmp_eq_u32 s41, 122880
    s_cselect_b32 s41, 0, s41
    s_cmp_ge_u32 s40, 9
    s_cbranch_scc1 g1ne_recurrent_scan__memory_aug_recurrent_mem_tr__dense_activation_mish__prompt_kernel_107
    v_mov_b32 v6, s40
    s_waitcnt vmcnt(0)
g1ne_recurrent_scan__memory_aug_recurrent_mem_tr__dense_activation_mish__prompt_kernel_107:
    s_cmp_lt_u32 s40, 64
    s_waitcnt vmcnt(14)
    buffer_store_dword v6, off, s[8:11], s49 sc1
    s_cbranch_scc1 g1loop_qk_recurrent_scan__memory_aug_recurrent_mem_tr__dense_activation_mish__prompt_kernel_104
    s_branch g1fin_recurrent_scan__memory_aug_recurrent_mem_tr__dense_activation_mish__prompt_kernel_99
g1loop_v_recurrent_scan__memory_aug_recurrent_mem_tr__dense_activation_mish__prompt_kernel_105:
    s_barrier
    s_min_u32 s44, s42, 63
    s_mul_i32 s44, s44, 40960
    s_add_u32 s44, s44, s45
    s_add_u32 m0, s43, s46
    s_nop 0
    buffer_load_dwordx4 v3, s[8:11], s44 offen offset:0 sc1 lds
    buffer_load_dwordx4 v3, s[8:11], s44 offen offset:1024 sc1 lds
    buffer_load_dwordx4 v3, s[8:11], s44 offen offset:2048 sc1 lds
    buffer_load_dwordx4 v3, s[8:11], s44 offen offset:3072 sc1 lds
    s_add_u32 s44, s44, 4096
    s_add_u32 m0, m0, 4096
    s_nop 0
    buffer_load_dwordx4 v3, s[8:11], s44 offen offset:0 sc1 lds
    buffer_load_dwordx4 v3, s[8:11], s44 offen offset:1024 sc1 lds
    buffer_load_dwordx4 v3, s[8:11], s44 offen offset:2048 sc1 lds
    buffer_load_dwordx4 v3, s[8:11], s44 offen offset:3072 sc1 lds
    s_add_u32 s44, s44, 4096
    s_add_u32 m0, m0, 4096
    s_nop 0
    buffer_load_dwordx4 v3, s[8:11], s44 offen offset:0 sc1 lds
    buffer_load_dwordx4 v3, s[8:11], s44 offen offset:1024 sc1 lds
    v_add_u32 v5, s41, v3
    ds_read_b128 v[48:51], v5 offset:0
    ds_read_b128 v[52:55], v5 offset:1024
    ds_read_b128 v[56:59], v5 offset:2048
    ds_read_b128 v[60:63], v5 offset:3072
    ds_read_b128 v[64:67], v5 offset:4096
    ds_read_b128 v[68:71], v5 offset:5120
    ds_read_b128 v[72:75], v5 offset:6144
    ds_read_b128 v[76:79], v5 offset:7168
    s_waitcnt lgkmcnt(6)
    v_mfma_f32_16x16x32_bf16 v[16:19], v[48:51], a[0:3], 0
    v_mfma_f32_16x16x32_bf16 v[20:23], v[52:55], a[0:3], 0
    v_mfma_f32_16x16x32_bf16 v[24:27], v[48:51], a[4:7], 0
    v_mfma_f32_16x16x32_bf16 v[28:31], v[52:55], a[4:7], 0
    v_mfma_f32_16x16x32_bf16 v[32:35], v[48:51], a[8:11], 0
    v_mfma_f32_16x16x32_bf16 v[36:39], v[52:55], a[8:11], 0
    v_mfma_f32_16x16x32_bf16 v[40:43], v[48:51], a[12:15], 0
    v_mfma_f32_16x16x32_bf16 v[44:47], v[52:55], a[12:15], 0
    ds_read_b128 v[48:51], v5 offset:8192
    ds_read_b128 v[52:55], v5 offset:9216
    s_waitcnt lgkmcnt(6)
    v_mfma_f32_16x16x32_bf16 v[16:19], v[56:59], a[16:19], v[16:19]
    v_mfma_f32_16x16x32_bf16 v[20:23], v[60:63], a[16:19], v[20:23]
    v_mfma_f32_16x16x32_bf16 v[24:27], v[56:59], a[20:23], v[24:27]
    v_mfma_f32_16x16x32_bf16 v[28:31], v[60:63], a[20:23], v[28:31]
    v_mfma_f32_16x16x32_bf16 v[32:35], v[56:59], a[24:27], v[32:35]
    v_mfma_f32_16x16x32_bf16 v[36:39], v[60:63], a[24:27], v[36:39]
    v_mfma_f32_16x16x32_bf16 v[40:43], v[56:59], a[28:31], v[40:43]
    v_mfma_f32_16x16x32_bf16 v[44:47], v[60:63], a[28:31], v[44:47]
    ds_read_b128 v[56:59], v5 offset:10240
    ds_read_b128 v[60:63], v5 offset:11264
    s_waitcnt lgkmcnt(6)
    v_mfma_f32_16x16x32_bf16 v[16:19], v[64:67], a[32:35], v[16:19]
    v_mfma_f32_16x16x32_bf16 v[20:23], v[68:71], a[32:35], v[20:23]
    v_mfma_f32_16x16x32_bf16 v[24:27], v[64:67], a[36:39], v[24:27]
    v_mfma_f32_16x16x32_bf16 v[28:31], v[68:71], a[36:39], v[28:31]
    v_mfma_f32_16x16x32_bf16 v[32:35], v[64:67], a[40:43], v[32:35]
    v_mfma_f32_16x16x32_bf16 v[36:39], v[68:71], a[40:43], v[36:39]
    v_mfma_f32_16x16x32_bf16 v[40:43], v[64:67], a[44:47], v[40:43]
    v_mfma_f32_16x16x32_bf16 v[44:47], v[68:71], a[44:47], v[44:47]
    ds_read_b128 v[64:67], v5 offset:12288
    ds_read_b128 v[68:71], v5 offset:13312
    s_waitcnt lgkmcnt(6)
    v_mfma_f32_16x16x32_bf16 v[16:19], v[72:75], a[48:51], v[16:19]
    v_mfma_f32_16x16x32_bf16 v[20:23], v[76:79], a[48:51], v[20:23]
    v_mfma_f32_16x16x32_bf16 v[24:27], v[72:75], a[52:55], v[24:27]
    v_mfma_f32_16x16x32_bf16 v[28:31], v[76:79], a[52:55], v[28:31]
    v_mfma_f32_16x16x32_bf16 v[32:35], v[72:75], a[56:59], v[32:35]
    v_mfma_f32_16x16x32_bf16 v[36:39], v[76:79], a[56:59], v[36:39]
    v_mfma_f32_16x16x32_bf16 v[40:43], v[72:75], a[60:63], v[40:43]
    v_mfma_f32_16x16x32_bf16 v[44:47], v[76:79], a[60:63], v[44:47]
    ds_read_b128 v[72:75], v5 offset:14336
    ds_read_b128 v[76:79], v5 offset:15360
    s_waitcnt lgkmcnt(6)
    v_mfma_f32_16x16x32_bf16 v[16:19], v[48:51], a[64:67], v[16:19]
    v_mfma_f32_16x16x32_bf16 v[20:23], v[52:55], a[64:67], v[20:23]
    v_mfma_f32_16x16x32_bf16 v[24:27], v[48:51], a[68:71], v[24:27]
    v_mfma_f32_16x16x32_bf16 v[28:31], v[52:55], a[68:71], v[28:31]
    v_mfma_f32_16x16x32_bf16 v[32:35], v[48:51], a[72:75], v[32:35]
    v_mfma_f32_16x16x32_bf16 v[36:39], v[52:55], a[72:75], v[36:39]
    v_mfma_f32_16x16x32_bf16 v[40:43], v[48:51], a[76:79], v[40:43]
    v_mfma_f32_16x16x32_bf16 v[44:47], v[52:55], a[76:79], v[44:47]
    ds_read_b128 v[48:51], v5 offset:16384
    ds_read_b128 v[52:55], v5 offset:17408
    s_waitcnt lgkmcnt(6)
    v_mfma_f32_16x16x32_bf16 v[16:19], v[56:59], a[80:83], v[16:19]
    v_mfma_f32_16x16x32_bf16 v[20:23], v[60:63], a[80:83], v[20:23]
    v_mfma_f32_16x16x32_bf16 v[24:27], v[56:59], a[84:87], v[24:27]
    v_mfma_f32_16x16x32_bf16 v[28:31], v[60:63], a[84:87], v[28:31]
    v_mfma_f32_16x16x32_bf16 v[32:35], v[56:59], a[88:91], v[32:35]
    v_mfma_f32_16x16x32_bf16 v[36:39], v[60:63], a[88:91], v[36:39]
    v_mfma_f32_16x16x32_bf16 v[40:43], v[56:59], a[92:95], v[40:43]
    v_mfma_f32_16x16x32_bf16 v[44:47], v[60:63], a[92:95], v[44:47]
    ds_read_b128 v[56:59], v5 offset:18432
    ds_read_b128 v[60:63], v5 offset:19456
    s_waitcnt lgkmcnt(6)
    v_mfma_f32_16x16x32_bf16 v[16:19], v[64:67], a[96:99], v[16:19]
    v_mfma_f32_16x16x32_bf16 v[20:23], v[68:71], a[96:99], v[20:23]
    v_mfma_f32_16x16x32_bf16 v[24:27], v[64:67], a[100:103], v[24:27]
    v_mfma_f32_16x16x32_bf16 v[28:31], v[68:71], a[100:103], v[28:31]
    v_mfma_f32_16x16x32_bf16 v[32:35], v[64:67], a[104:107], v[32:35]
    v_mfma_f32_16x16x32_bf16 v[36:39], v[68:71], a[104:107], v[36:39]
    v_mfma_f32_16x16x32_bf16 v[40:43], v[64:67], a[108:111], v[40:43]
    v_mfma_f32_16x16x32_bf16 v[44:47], v[68:71], a[108:111], v[44:47]
    ds_read_b128 v[64:67], v5 offset:20480
    ds_read_b128 v[68:71], v5 offset:21504
    s_waitcnt lgkmcnt(6)
    v_mfma_f32_16x16x32_bf16 v[16:19], v[72:75], a[112:115], v[16:19]
    v_mfma_f32_16x16x32_bf16 v[20:23], v[76:79], a[112:115], v[20:23]
    v_mfma_f32_16x16x32_bf16 v[24:27], v[72:75], a[116:119], v[24:27]
    v_mfma_f32_16x16x32_bf16 v[28:31], v[76:79], a[116:119], v[28:31]
    v_mfma_f32_16x16x32_bf16 v[32:35], v[72:75], a[120:123], v[32:35]
    v_mfma_f32_16x16x32_bf16 v[36:39], v[76:79], a[120:123], v[36:39]
    v_mfma_f32_16x16x32_bf16 v[40:43], v[72:75], a[124:127], v[40:43]
    v_mfma_f32_16x16x32_bf16 v[44:47], v[76:79], a[124:127], v[44:47]
    ds_read_b128 v[72:75], v5 offset:22528
    ds_read_b128 v[76:79], v5 offset:23552
    s_waitcnt lgkmcnt(6)
    v_mfma_f32_16x16x32_bf16 v[16:19], v[48:51], a[128:131], v[16:19]
    v_mfma_f32_16x16x32_bf16 v[20:23], v[52:55], a[128:131], v[20:23]
    v_mfma_f32_16x16x32_bf16 v[24:27], v[48:51], a[132:135], v[24:27]
    v_mfma_f32_16x16x32_bf16 v[28:31], v[52:55], a[132:135], v[28:31]
    v_mfma_f32_16x16x32_bf16 v[32:35], v[48:51], a[136:139], v[32:35]
    v_mfma_f32_16x16x32_bf16 v[36:39], v[52:55], a[136:139], v[36:39]
    v_mfma_f32_16x16x32_bf16 v[40:43], v[48:51], a[140:143], v[40:43]
    v_mfma_f32_16x16x32_bf16 v[44:47], v[52:55], a[140:143], v[44:47]
    ds_read_b128 v[48:51], v5 offset:24576
    ds_read_b128 v[52:55], v5 offset:25600
    s_waitcnt lgkmcnt(6)
    v_mfma_f32_16x16x32_bf16 v[16:19], v[56:59], a[144:147], v[16:19]
    v_mfma_f32_16x16x32_bf16 v[20:23], v[60:63], a[144:147], v[20:23]
    v_mfma_f32_16x16x32_bf16 v[24:27], v[56:59], a[148:151], v[24:27]
    v_mfma_f32_16x16x32_bf16 v[28:31], v[60:63], a[148:151], v[28:31]
    v_mfma_f32_16x16x32_bf16 v[32:35], v[56:59], a[152:155], v[32:35]
    v_mfma_f32_16x16x32_bf16 v[36:39], v[60:63], a[152:155], v[36:39]
    v_mfma_f32_16x16x32_bf16 v[40:43], v[56:59], a[156:159], v[40:43]
    v_mfma_f32_16x16x32_bf16 v[44:47], v[60:63], a[156:159], v[44:47]
    ds_read_b128 v[56:59], v5 offset:26624
    ds_read_b128 v[60:63], v5 offset:27648
    s_waitcnt lgkmcnt(6)
    v_mfma_f32_16x16x32_bf16 v[16:19], v[64:67], a[160:163], v[16:19]
    v_mfma_f32_16x16x32_bf16 v[20:23], v[68:71], a[160:163], v[20:23]
    v_mfma_f32_16x16x32_bf16 v[24:27], v[64:67], a[164:167], v[24:27]
    v_mfma_f32_16x16x32_bf16 v[28:31], v[68:71], a[164:167], v[28:31]
    v_mfma_f32_16x16x32_bf16 v[32:35], v[64:67], a[168:171], v[32:35]
    v_mfma_f32_16x16x32_bf16 v[36:39], v[68:71], a[168:171], v[36:39]
    v_mfma_f32_16x16x32_bf16 v[40:43], v[64:67], a[172:175], v[40:43]
    v_mfma_f32_16x16x32_bf16 v[44:47], v[68:71], a[172:175], v[44:47]
    ds_read_b128 v[64:67], v5 offset:28672
    ds_read_b128 v[68:71], v5 offset:29696
    s_waitcnt lgkmcnt(6)
    v_mfma_f32_16x16x32_bf16 v[16:19], v[72:75], a[176:179], v[16:19]
    v_mfma_f32_16x16x32_bf16 v[20:23], v[76:79], a[176:179], v[20:23]
    v_mfma_f32_16x16x32_bf16 v[24:27], v[72:75], a[180:183], v[24:27]
    v_mfma_f32_16x16x32_bf16 v[28:31], v[76:79], a[180:183], v[28:31]
    v_mfma_f32_16x16x32_bf16 v[32:35], v[72:75], a[184:187], v[32:35]
    v_mfma_f32_16x16x32_bf16 v[36:39], v[76:79], a[184:187], v[36:39]
    v_mfma_f32_16x16x32_bf16 v[40:43], v[72:75], a[188:191], v[40:43]
    v_mfma_f32_16x16x32_bf16 v[44:47], v[76:79], a[188:191], v[44:47]
    ds_read_b128 v[72:75], v5 offset:30720
    ds_read_b128 v[76:79], v5 offset:31744
    s_waitcnt lgkmcnt(6)
    v_mfma_f32_16x16x32_bf16 v[16:19], v[48:51], a[192:195], v[16:19]
    v_mfma_f32_16x16x32_bf16 v[20:23], v[52:55], a[192:195], v[20:23]
    v_mfma_f32_16x16x32_bf16 v[24:27], v[48:51], a[196:199], v[24:27]
    v_mfma_f32_16x16x32_bf16 v[28:31], v[52:55], a[196:199], v[28:31]
    v_mfma_f32_16x16x32_bf16 v[32:35], v[48:51], a[200:203], v[32:35]
    v_mfma_f32_16x16x32_bf16 v[36:39], v[52:55], a[200:203], v[36:39]
    v_mfma_f32_16x16x32_bf16 v[40:43], v[48:51], a[204:207], v[40:43]
    v_mfma_f32_16x16x32_bf16 v[44:47], v[52:55], a[204:207], v[44:47]
    ds_read_b128 v[48:51], v5 offset:32768
    ds_read_b128 v[52:55], v5 offset:33792
    s_waitcnt lgkmcnt(6)
    v_mfma_f32_16x16x32_bf16 v[16:19], v[56:59], a[208:211], v[16:19]
    v_mfma_f32_16x16x32_bf16 v[20:23], v[60:63], a[208:211], v[20:23]
    v_mfma_f32_16x16x32_bf16 v[24:27], v[56:59], a[212:215], v[24:27]
    v_mfma_f32_16x16x32_bf16 v[28:31], v[60:63], a[212:215], v[28:31]
    v_mfma_f32_16x16x32_bf16 v[32:35], v[56:59], a[216:219], v[32:35]
    v_mfma_f32_16x16x32_bf16 v[36:39], v[60:63], a[216:219], v[36:39]
    v_mfma_f32_16x16x32_bf16 v[40:43], v[56:59], a[220:223], v[40:43]
    v_mfma_f32_16x16x32_bf16 v[44:47], v[60:63], a[220:223], v[44:47]
    ds_read_b128 v[56:59], v5 offset:34816
    ds_read_b128 v[60:63], v5 offset:35840
    s_waitcnt lgkmcnt(6)
    v_mfma_f32_16x16x32_bf16 v[16:19], v[64:67], a[224:227], v[16:19]
    v_mfma_f32_16x16x32_bf16 v[20:23], v[68:71], a[224:227], v[20:23]
    v_mfma_f32_16x16x32_bf16 v[24:27], v[64:67], a[228:231], v[24:27]
    v_mfma_f32_16x16x32_bf16 v[28:31], v[68:71], a[228:231], v[28:31]
    v_mfma_f32_16x16x32_bf16 v[32:35], v[64:67], a[232:235], v[32:35]
    v_mfma_f32_16x16x32_bf16 v[36:39], v[68:71], a[232:235], v[36:39]
    v_mfma_f32_16x16x32_bf16 v[40:43], v[64:67], a[236:239], v[40:43]
    v_mfma_f32_16x16x32_bf16 v[44:47], v[68:71], a[236:239], v[44:47]
    ds_read_b128 v[64:67], v5 offset:36864
    ds_read_b128 v[68:71], v5 offset:37888
    s_waitcnt lgkmcnt(6)
    v_mfma_f32_16x16x32_bf16 v[16:19], v[72:75], a[240:243], v[16:19]
    v_mfma_f32_16x16x32_bf16 v[20:23], v[76:79], a[240:243], v[20:23]
    v_mfma_f32_16x16x32_bf16 v[24:27], v[72:75], a[244:247], v[24:27]
    v_mfma_f32_16x16x32_bf16 v[28:31], v[76:79], a[244:247], v[28:31]
    v_mfma_f32_16x16x32_bf16 v[32:35], v[72:75], a[248:251], v[32:35]
    v_mfma_f32_16x16x32_bf16 v[36:39], v[76:79], a[248:251], v[36:39]
    v_mfma_f32_16x16x32_bf16 v[40:43], v[72:75], a[252:255], v[40:43]
    v_mfma_f32_16x16x32_bf16 v[44:47], v[76:79], a[252:255], v[44:47]
    ds_read_b128 v[72:75], v5 offset:38912
    ds_read_b128 v[76:79], v5 offset:39936
    s_waitcnt lgkmcnt(6)
    v_mfma_f32_16x16x32_bf16 v[16:19], v[48:51], v[192:195], v[16:19]
    v_mfma_f32_16x16x32_bf16 v[20:23], v[52:55], v[192:195], v[20:23]
    v_mfma_f32_16x16x32_bf16 v[24:27], v[48:51], v[196:199], v[24:27]
    v_mfma_f32_16x16x32_bf16 v[28:31], v[52:55], v[196:199], v[28:31]
    v_mfma_f32_16x16x32_bf16 v[32:35], v[48:51], v[200:203], v[32:35]
    v_mfma_f32_16x16x32_bf16 v[36:39], v[52:55], v[200:203], v[36:39]
    v_mfma_f32_16x16x32_bf16 v[40:43], v[48:51], v[204:207], v[40:43]
    v_mfma_f32_16x16x32_bf16 v[44:47], v[52:55], v[204:207], v[44:47]
    s_waitcnt lgkmcnt(4)
    v_mfma_f32_16x16x32_bf16 v[16:19], v[56:59], v[208:211], v[16:19]
    v_mfma_f32_16x16x32_bf16 v[20:23], v[60:63], v[208:211], v[20:23]
    v_mfma_f32_16x16x32_bf16 v[24:27], v[56:59], v[212:215], v[24:27]
    v_mfma_f32_16x16x32_bf16 v[28:31], v[60:63], v[212:215], v[28:31]
    v_mfma_f32_16x16x32_bf16 v[32:35], v[56:59], v[216:219], v[32:35]
    v_mfma_f32_16x16x32_bf16 v[36:39], v[60:63], v[216:219], v[36:39]
    v_mfma_f32_16x16x32_bf16 v[40:43], v[56:59], v[220:223], v[40:43]
    v_mfma_f32_16x16x32_bf16 v[44:47], v[60:63], v[220:223], v[44:47]
    s_waitcnt lgkmcnt(2)
    v_mfma_f32_16x16x32_bf16 v[16:19], v[64:67], v[224:227], v[16:19]
    v_mfma_f32_16x16x32_bf16 v[20:23], v[68:71], v[224:227], v[20:23]
    v_mfma_f32_16x16x32_bf16 v[24:27], v[64:67], v[228:231], v[24:27]
    v_mfma_f32_16x16x32_bf16 v[28:31], v[68:71], v[228:231], v[28:31]
    v_mfma_f32_16x16x32_bf16 v[32:35], v[64:67], v[232:235], v[32:35]
    v_mfma_f32_16x16x32_bf16 v[36:39], v[68:71], v[232:235], v[36:39]
    v_mfma_f32_16x16x32_bf16 v[40:43], v[64:67], v[236:239], v[40:43]
    v_mfma_f32_16x16x32_bf16 v[44:47], v[68:71], v[236:239], v[44:47]
    s_waitcnt lgkmcnt(0)
    v_mfma_f32_16x16x32_bf16 v[16:19], v[72:75], v[240:243], v[16:19]
    v_mfma_f32_16x16x32_bf16 v[20:23], v[76:79], v[240:243], v[20:23]
    v_mfma_f32_16x16x32_bf16 v[24:27], v[72:75], v[244:247], v[24:27]
    v_mfma_f32_16x16x32_bf16 v[28:31], v[76:79], v[244:247], v[28:31]
    v_mfma_f32_16x16x32_bf16 v[32:35], v[72:75], v[248:251], v[32:35]
    v_mfma_f32_16x16x32_bf16 v[36:39], v[76:79], v[248:251], v[36:39]
    v_mfma_f32_16x16x32_bf16 v[40:43], v[72:75], v[252:255], v[40:43]
    v_mfma_f32_16x16x32_bf16 v[44:47], v[76:79], v[252:255], v[44:47]
    s_mul_i32 s47, s40, s32
    s_add_u32 s47, s47, s31
    v_cvt_pk_bf16_f32 v80, v16, v17
    v_cvt_pk_bf16_f32 v81, v18, v19
    v_cvt_pk_bf16_f32 v82, v20, v21
    v_cvt_pk_bf16_f32 v83, v22, v23
    buffer_store_dwordx4 v[80:83], v3, s[8:11], s47 offen offset:0 sc1
    v_cvt_pk_bf16_f32 v84, v24, v25
    v_cvt_pk_bf16_f32 v85, v26, v27
    v_cvt_pk_bf16_f32 v86, v28, v29
    v_cvt_pk_bf16_f32 v87, v30, v31
    buffer_store_dwordx4 v[84:87], v3, s[8:11], s47 offen offset:1024 sc1
    v_cvt_pk_bf16_f32 v88, v32, v33
    v_cvt_pk_bf16_f32 v89, v34, v35
    v_cvt_pk_bf16_f32 v90, v36, v37
    v_cvt_pk_bf16_f32 v91, v38, v39
    buffer_store_dwordx4 v[88:91], v3, s[8:11], s47 offen offset:2048 sc1
    v_cvt_pk_bf16_f32 v92, v40, v41
    v_cvt_pk_bf16_f32 v93, v42, v43
    v_cvt_pk_bf16_f32 v94, v44, v45
    v_cvt_pk_bf16_f32 v95, v46, v47
    buffer_store_dwordx4 v[92:95], v3, s[8:11], s47 offen offset:3072 sc1
    v_mov_b32 v6, s40
    s_add_u32 s40, s40, s27
    s_add_u32 s42, s42, s27
    s_mov_b32 s43, s41
    s_add_u32 s41, s41, 40960
    s_cmp_eq_u32 s41, 122880
    s_cselect_b32 s41, 0, s41
    s_cmp_ge_u32 s40, 9
    s_cbranch_scc1 g1ne_recurrent_scan__memory_aug_recurrent_mem_tr__dense_activation_mish__prompt_kernel_108
    v_mov_b32 v6, s40
    s_waitcnt vmcnt(0)
g1ne_recurrent_scan__memory_aug_recurrent_mem_tr__dense_activation_mish__prompt_kernel_108:
    s_cmp_lt_u32 s40, 64
    s_waitcnt vmcnt(14)
    buffer_store_dword v6, off, s[8:11], s49 sc1
    s_cbranch_scc1 g1loop_v_recurrent_scan__memory_aug_recurrent_mem_tr__dense_activation_mish__prompt_kernel_105
    s_branch g1fin_recurrent_scan__memory_aug_recurrent_mem_tr__dense_activation_mish__prompt_kernel_99
g1loop_ffn_recurrent_scan__memory_aug_recurrent_mem_tr__dense_activation_mish__prompt_kernel_106:
    s_barrier
    s_min_u32 s44, s42, 63
    s_mul_i32 s44, s44, 40960
    s_add_u32 s44, s44, s45
    s_add_u32 m0, s43, s46
    s_nop 0
    buffer_load_dwordx4 v3, s[8:11], s44 offen offset:0 sc1 lds
    buffer_load_dwordx4 v3, s[8:11], s44 offen offset:1024 sc1 lds
    buffer_load_dwordx4 v3, s[8:11], s44 offen offset:2048 sc1 lds
    buffer_load_dwordx4 v3, s[8:11], s44 offen offset:3072 sc1 lds
    s_add_u32 s44, s44, 4096
    s_add_u32 m0, m0, 4096
    s_nop 0
    buffer_load_dwordx4 v3, s[8:11], s44 offen offset:0 sc1 lds
    buffer_load_dwordx4 v3, s[8:11], s44 offen offset:1024 sc1 lds
    buffer_load_dwordx4 v3, s[8:11], s44 offen offset:2048 sc1 lds
    buffer_load_dwordx4 v3, s[8:11], s44 offen offset:3072 sc1 lds
    s_add_u32 s44, s44, 4096
    s_add_u32 m0, m0, 4096
    s_nop 0
    buffer_load_dwordx4 v3, s[8:11], s44 offen offset:0 sc1 lds
    buffer_load_dwordx4 v3, s[8:11], s44 offen offset:1024 sc1 lds
    v_add_u32 v5, s41, v3
    ds_read_b128 v[48:51], v5 offset:0
    ds_read_b128 v[52:55], v5 offset:1024
    ds_read_b128 v[56:59], v5 offset:2048
    ds_read_b128 v[60:63], v5 offset:3072
    ds_read_b128 v[64:67], v5 offset:4096
    ds_read_b128 v[68:71], v5 offset:5120
    ds_read_b128 v[72:75], v5 offset:6144
    ds_read_b128 v[76:79], v5 offset:7168
    s_waitcnt lgkmcnt(6)
    v_mfma_f32_16x16x32_bf16 v[16:19], a[0:3], v[48:51], v[96:99]
    v_mfma_f32_16x16x32_bf16 v[20:23], a[0:3], v[52:55], v[96:99]
    v_mfma_f32_16x16x32_bf16 v[24:27], a[4:7], v[48:51], v[100:103]
    v_mfma_f32_16x16x32_bf16 v[28:31], a[4:7], v[52:55], v[100:103]
    v_mfma_f32_16x16x32_bf16 v[32:35], a[8:11], v[48:51], v[104:107]
    v_mfma_f32_16x16x32_bf16 v[36:39], a[8:11], v[52:55], v[104:107]
    v_mfma_f32_16x16x32_bf16 v[40:43], a[12:15], v[48:51], v[108:111]
    v_mfma_f32_16x16x32_bf16 v[44:47], a[12:15], v[52:55], v[108:111]
    ds_read_b128 v[48:51], v5 offset:8192
    ds_read_b128 v[52:55], v5 offset:9216
    s_waitcnt lgkmcnt(6)
    v_mfma_f32_16x16x32_bf16 v[16:19], a[16:19], v[56:59], v[16:19]
    v_mfma_f32_16x16x32_bf16 v[20:23], a[16:19], v[60:63], v[20:23]
    v_mfma_f32_16x16x32_bf16 v[24:27], a[20:23], v[56:59], v[24:27]
    v_mfma_f32_16x16x32_bf16 v[28:31], a[20:23], v[60:63], v[28:31]
    v_mfma_f32_16x16x32_bf16 v[32:35], a[24:27], v[56:59], v[32:35]
    v_mfma_f32_16x16x32_bf16 v[36:39], a[24:27], v[60:63], v[36:39]
    v_mfma_f32_16x16x32_bf16 v[40:43], a[28:31], v[56:59], v[40:43]
    v_mfma_f32_16x16x32_bf16 v[44:47], a[28:31], v[60:63], v[44:47]
    ds_read_b128 v[56:59], v5 offset:10240
    ds_read_b128 v[60:63], v5 offset:11264
    s_waitcnt lgkmcnt(6)
    v_mfma_f32_16x16x32_bf16 v[16:19], a[32:35], v[64:67], v[16:19]
    v_mfma_f32_16x16x32_bf16 v[20:23], a[32:35], v[68:71], v[20:23]
    v_mfma_f32_16x16x32_bf16 v[24:27], a[36:39], v[64:67], v[24:27]
    v_mfma_f32_16x16x32_bf16 v[28:31], a[36:39], v[68:71], v[28:31]
    v_mfma_f32_16x16x32_bf16 v[32:35], a[40:43], v[64:67], v[32:35]
    v_mfma_f32_16x16x32_bf16 v[36:39], a[40:43], v[68:71], v[36:39]
    v_mfma_f32_16x16x32_bf16 v[40:43], a[44:47], v[64:67], v[40:43]
    v_mfma_f32_16x16x32_bf16 v[44:47], a[44:47], v[68:71], v[44:47]
    ds_read_b128 v[64:67], v5 offset:12288
    ds_read_b128 v[68:71], v5 offset:13312
    s_waitcnt lgkmcnt(6)
    v_mfma_f32_16x16x32_bf16 v[16:19], a[48:51], v[72:75], v[16:19]
    v_mfma_f32_16x16x32_bf16 v[20:23], a[48:51], v[76:79], v[20:23]
    v_mfma_f32_16x16x32_bf16 v[24:27], a[52:55], v[72:75], v[24:27]
    v_mfma_f32_16x16x32_bf16 v[28:31], a[52:55], v[76:79], v[28:31]
    v_mfma_f32_16x16x32_bf16 v[32:35], a[56:59], v[72:75], v[32:35]
    v_mfma_f32_16x16x32_bf16 v[36:39], a[56:59], v[76:79], v[36:39]
    v_mfma_f32_16x16x32_bf16 v[40:43], a[60:63], v[72:75], v[40:43]
    v_mfma_f32_16x16x32_bf16 v[44:47], a[60:63], v[76:79], v[44:47]
    ds_read_b128 v[72:75], v5 offset:14336
    ds_read_b128 v[76:79], v5 offset:15360
    s_waitcnt lgkmcnt(6)
    v_mfma_f32_16x16x32_bf16 v[16:19], a[64:67], v[48:51], v[16:19]
    v_mfma_f32_16x16x32_bf16 v[20:23], a[64:67], v[52:55], v[20:23]
    v_mfma_f32_16x16x32_bf16 v[24:27], a[68:71], v[48:51], v[24:27]
    v_mfma_f32_16x16x32_bf16 v[28:31], a[68:71], v[52:55], v[28:31]
    v_mfma_f32_16x16x32_bf16 v[32:35], a[72:75], v[48:51], v[32:35]
    v_mfma_f32_16x16x32_bf16 v[36:39], a[72:75], v[52:55], v[36:39]
    v_mfma_f32_16x16x32_bf16 v[40:43], a[76:79], v[48:51], v[40:43]
    v_mfma_f32_16x16x32_bf16 v[44:47], a[76:79], v[52:55], v[44:47]
    ds_read_b128 v[48:51], v5 offset:16384
    ds_read_b128 v[52:55], v5 offset:17408
    s_waitcnt lgkmcnt(6)
    v_mfma_f32_16x16x32_bf16 v[16:19], a[80:83], v[56:59], v[16:19]
    v_mfma_f32_16x16x32_bf16 v[20:23], a[80:83], v[60:63], v[20:23]
    v_mfma_f32_16x16x32_bf16 v[24:27], a[84:87], v[56:59], v[24:27]
    v_mfma_f32_16x16x32_bf16 v[28:31], a[84:87], v[60:63], v[28:31]
    v_mfma_f32_16x16x32_bf16 v[32:35], a[88:91], v[56:59], v[32:35]
    v_mfma_f32_16x16x32_bf16 v[36:39], a[88:91], v[60:63], v[36:39]
    v_mfma_f32_16x16x32_bf16 v[40:43], a[92:95], v[56:59], v[40:43]
    v_mfma_f32_16x16x32_bf16 v[44:47], a[92:95], v[60:63], v[44:47]
    ds_read_b128 v[56:59], v5 offset:18432
    ds_read_b128 v[60:63], v5 offset:19456
    s_waitcnt lgkmcnt(6)
    v_mfma_f32_16x16x32_bf16 v[16:19], a[96:99], v[64:67], v[16:19]
    v_mfma_f32_16x16x32_bf16 v[20:23], a[96:99], v[68:71], v[20:23]
    v_mfma_f32_16x16x32_bf16 v[24:27], a[100:103], v[64:67], v[24:27]
    v_mfma_f32_16x16x32_bf16 v[28:31], a[100:103], v[68:71], v[28:31]
    v_mfma_f32_16x16x32_bf16 v[32:35], a[104:107], v[64:67], v[32:35]
    v_mfma_f32_16x16x32_bf16 v[36:39], a[104:107], v[68:71], v[36:39]
    v_mfma_f32_16x16x32_bf16 v[40:43], a[108:111], v[64:67], v[40:43]
    v_mfma_f32_16x16x32_bf16 v[44:47], a[108:111], v[68:71], v[44:47]
    ds_read_b128 v[64:67], v5 offset:20480
    ds_read_b128 v[68:71], v5 offset:21504
    s_waitcnt lgkmcnt(6)
    v_mfma_f32_16x16x32_bf16 v[16:19], a[112:115], v[72:75], v[16:19]
    v_mfma_f32_16x16x32_bf16 v[20:23], a[112:115], v[76:79], v[20:23]
    v_mfma_f32_16x16x32_bf16 v[24:27], a[116:119], v[72:75], v[24:27]
    v_mfma_f32_16x16x32_bf16 v[28:31], a[116:119], v[76:79], v[28:31]
    v_mfma_f32_16x16x32_bf16 v[32:35], a[120:123], v[72:75], v[32:35]
    v_mfma_f32_16x16x32_bf16 v[36:39], a[120:123], v[76:79], v[36:39]
    v_mfma_f32_16x16x32_bf16 v[40:43], a[124:127], v[72:75], v[40:43]
    v_mfma_f32_16x16x32_bf16 v[44:47], a[124:127], v[76:79], v[44:47]
    ds_read_b128 v[72:75], v5 offset:22528
    ds_read_b128 v[76:79], v5 offset:23552
    s_waitcnt lgkmcnt(6)
    v_mfma_f32_16x16x32_bf16 v[16:19], a[128:131], v[48:51], v[16:19]
    v_mfma_f32_16x16x32_bf16 v[20:23], a[128:131], v[52:55], v[20:23]
    v_mfma_f32_16x16x32_bf16 v[24:27], a[132:135], v[48:51], v[24:27]
    v_mfma_f32_16x16x32_bf16 v[28:31], a[132:135], v[52:55], v[28:31]
    v_mfma_f32_16x16x32_bf16 v[32:35], a[136:139], v[48:51], v[32:35]
    v_mfma_f32_16x16x32_bf16 v[36:39], a[136:139], v[52:55], v[36:39]
    v_mfma_f32_16x16x32_bf16 v[40:43], a[140:143], v[48:51], v[40:43]
    v_mfma_f32_16x16x32_bf16 v[44:47], a[140:143], v[52:55], v[44:47]
    ds_read_b128 v[48:51], v5 offset:24576
    ds_read_b128 v[52:55], v5 offset:25600
    s_waitcnt lgkmcnt(6)
    v_mfma_f32_16x16x32_bf16 v[16:19], a[144:147], v[56:59], v[16:19]
    v_mfma_f32_16x16x32_bf16 v[20:23], a[144:147], v[60:63], v[20:23]
    v_mfma_f32_16x16x32_bf16 v[24:27], a[148:151], v[56:59], v[24:27]
    v_mfma_f32_16x16x32_bf16 v[28:31], a[148:151], v[60:63], v[28:31]
    v_mfma_f32_16x16x32_bf16 v[32:35], a[152:155], v[56:59], v[32:35]
    v_mfma_f32_16x16x32_bf16 v[36:39], a[152:155], v[60:63], v[36:39]
    v_mfma_f32_16x16x32_bf16 v[40:43], a[156:159], v[56:59], v[40:43]
    v_mfma_f32_16x16x32_bf16 v[44:47], a[156:159], v[60:63], v[44:47]
    ds_read_b128 v[56:59], v5 offset:26624
    ds_read_b128 v[60:63], v5 offset:27648
    s_waitcnt lgkmcnt(6)
    v_mfma_f32_16x16x32_bf16 v[16:19], a[160:163], v[64:67], v[16:19]
    v_mfma_f32_16x16x32_bf16 v[20:23], a[160:163], v[68:71], v[20:23]
    v_mfma_f32_16x16x32_bf16 v[24:27], a[164:167], v[64:67], v[24:27]
    v_mfma_f32_16x16x32_bf16 v[28:31], a[164:167], v[68:71], v[28:31]
    v_mfma_f32_16x16x32_bf16 v[32:35], a[168:171], v[64:67], v[32:35]
    v_mfma_f32_16x16x32_bf16 v[36:39], a[168:171], v[68:71], v[36:39]
    v_mfma_f32_16x16x32_bf16 v[40:43], a[172:175], v[64:67], v[40:43]
    v_mfma_f32_16x16x32_bf16 v[44:47], a[172:175], v[68:71], v[44:47]
    ds_read_b128 v[64:67], v5 offset:28672
    ds_read_b128 v[68:71], v5 offset:29696
    s_waitcnt lgkmcnt(6)
    v_mfma_f32_16x16x32_bf16 v[16:19], a[176:179], v[72:75], v[16:19]
    v_mfma_f32_16x16x32_bf16 v[20:23], a[176:179], v[76:79], v[20:23]
    v_mfma_f32_16x16x32_bf16 v[24:27], a[180:183], v[72:75], v[24:27]
    v_mfma_f32_16x16x32_bf16 v[28:31], a[180:183], v[76:79], v[28:31]
    v_mfma_f32_16x16x32_bf16 v[32:35], a[184:187], v[72:75], v[32:35]
    v_mfma_f32_16x16x32_bf16 v[36:39], a[184:187], v[76:79], v[36:39]
    v_mfma_f32_16x16x32_bf16 v[40:43], a[188:191], v[72:75], v[40:43]
    v_mfma_f32_16x16x32_bf16 v[44:47], a[188:191], v[76:79], v[44:47]
    ds_read_b128 v[72:75], v5 offset:30720
    ds_read_b128 v[76:79], v5 offset:31744
    s_waitcnt lgkmcnt(6)
    v_mfma_f32_16x16x32_bf16 v[16:19], a[192:195], v[48:51], v[16:19]
    v_mfma_f32_16x16x32_bf16 v[20:23], a[192:195], v[52:55], v[20:23]
    v_mfma_f32_16x16x32_bf16 v[24:27], a[196:199], v[48:51], v[24:27]
    v_mfma_f32_16x16x32_bf16 v[28:31], a[196:199], v[52:55], v[28:31]
    v_mfma_f32_16x16x32_bf16 v[32:35], a[200:203], v[48:51], v[32:35]
    v_mfma_f32_16x16x32_bf16 v[36:39], a[200:203], v[52:55], v[36:39]
    v_mfma_f32_16x16x32_bf16 v[40:43], a[204:207], v[48:51], v[40:43]
    v_mfma_f32_16x16x32_bf16 v[44:47], a[204:207], v[52:55], v[44:47]
    ds_read_b128 v[48:51], v5 offset:32768
    ds_read_b128 v[52:55], v5 offset:33792
    s_waitcnt lgkmcnt(6)
    v_mfma_f32_16x16x32_bf16 v[16:19], a[208:211], v[56:59], v[16:19]
    v_mfma_f32_16x16x32_bf16 v[20:23], a[208:211], v[60:63], v[20:23]
    v_mfma_f32_16x16x32_bf16 v[24:27], a[212:215], v[56:59], v[24:27]
    v_mfma_f32_16x16x32_bf16 v[28:31], a[212:215], v[60:63], v[28:31]
    v_mfma_f32_16x16x32_bf16 v[32:35], a[216:219], v[56:59], v[32:35]
    v_mfma_f32_16x16x32_bf16 v[36:39], a[216:219], v[60:63], v[36:39]
    v_mfma_f32_16x16x32_bf16 v[40:43], a[220:223], v[56:59], v[40:43]
    v_mfma_f32_16x16x32_bf16 v[44:47], a[220:223], v[60:63], v[44:47]
    ds_read_b128 v[56:59], v5 offset:34816
    ds_read_b128 v[60:63], v5 offset:35840
    s_waitcnt lgkmcnt(6)
    v_mfma_f32_16x16x32_bf16 v[16:19], a[224:227], v[64:67], v[16:19]
    v_mfma_f32_16x16x32_bf16 v[20:23], a[224:227], v[68:71], v[20:23]
    v_mfma_f32_16x16x32_bf16 v[24:27], a[228:231], v[64:67], v[24:27]
    v_mfma_f32_16x16x32_bf16 v[28:31], a[228:231], v[68:71], v[28:31]
    v_mfma_f32_16x16x32_bf16 v[32:35], a[232:235], v[64:67], v[32:35]
    v_mfma_f32_16x16x32_bf16 v[36:39], a[232:235], v[68:71], v[36:39]
    v_mfma_f32_16x16x32_bf16 v[40:43], a[236:239], v[64:67], v[40:43]
    v_mfma_f32_16x16x32_bf16 v[44:47], a[236:239], v[68:71], v[44:47]
    ds_read_b128 v[64:67], v5 offset:36864
    ds_read_b128 v[68:71], v5 offset:37888
    s_waitcnt lgkmcnt(6)
    v_mfma_f32_16x16x32_bf16 v[16:19], a[240:243], v[72:75], v[16:19]
    v_mfma_f32_16x16x32_bf16 v[20:23], a[240:243], v[76:79], v[20:23]
    v_mfma_f32_16x16x32_bf16 v[24:27], a[244:247], v[72:75], v[24:27]
    v_mfma_f32_16x16x32_bf16 v[28:31], a[244:247], v[76:79], v[28:31]
    v_mfma_f32_16x16x32_bf16 v[32:35], a[248:251], v[72:75], v[32:35]
    v_mfma_f32_16x16x32_bf16 v[36:39], a[248:251], v[76:79], v[36:39]
    v_mfma_f32_16x16x32_bf16 v[40:43], a[252:255], v[72:75], v[40:43]
    v_mfma_f32_16x16x32_bf16 v[44:47], a[252:255], v[76:79], v[44:47]
    ds_read_b128 v[72:75], v5 offset:38912
    ds_read_b128 v[76:79], v5 offset:39936
    s_waitcnt lgkmcnt(6)
    v_mfma_f32_16x16x32_bf16 v[16:19], v[192:195], v[48:51], v[16:19]
    v_mfma_f32_16x16x32_bf16 v[20:23], v[192:195], v[52:55], v[20:23]
    v_mfma_f32_16x16x32_bf16 v[24:27], v[196:199], v[48:51], v[24:27]
    v_mfma_f32_16x16x32_bf16 v[28:31], v[196:199], v[52:55], v[28:31]
    v_mfma_f32_16x16x32_bf16 v[32:35], v[200:203], v[48:51], v[32:35]
    v_mfma_f32_16x16x32_bf16 v[36:39], v[200:203], v[52:55], v[36:39]
    v_mfma_f32_16x16x32_bf16 v[40:43], v[204:207], v[48:51], v[40:43]
    v_mfma_f32_16x16x32_bf16 v[44:47], v[204:207], v[52:55], v[44:47]
    s_waitcnt lgkmcnt(4)
    v_mfma_f32_16x16x32_bf16 v[16:19], v[208:211], v[56:59], v[16:19]
    v_mfma_f32_16x16x32_bf16 v[20:23], v[208:211], v[60:63], v[20:23]
    v_mfma_f32_16x16x32_bf16 v[24:27], v[212:215], v[56:59], v[24:27]
    v_mfma_f32_16x16x32_bf16 v[28:31], v[212:215], v[60:63], v[28:31]
    v_mfma_f32_16x16x32_bf16 v[32:35], v[216:219], v[56:59], v[32:35]
    v_mfma_f32_16x16x32_bf16 v[36:39], v[216:219], v[60:63], v[36:39]
    v_mfma_f32_16x16x32_bf16 v[40:43], v[220:223], v[56:59], v[40:43]
    v_mfma_f32_16x16x32_bf16 v[44:47], v[220:223], v[60:63], v[44:47]
    s_waitcnt lgkmcnt(2)
    v_mfma_f32_16x16x32_bf16 v[16:19], v[224:227], v[64:67], v[16:19]
    v_mfma_f32_16x16x32_bf16 v[20:23], v[224:227], v[68:71], v[20:23]
    v_mfma_f32_16x16x32_bf16 v[24:27], v[228:231], v[64:67], v[24:27]
    v_mfma_f32_16x16x32_bf16 v[28:31], v[228:231], v[68:71], v[28:31]
    v_mfma_f32_16x16x32_bf16 v[32:35], v[232:235], v[64:67], v[32:35]
    v_mfma_f32_16x16x32_bf16 v[36:39], v[232:235], v[68:71], v[36:39]
    v_mfma_f32_16x16x32_bf16 v[40:43], v[236:239], v[64:67], v[40:43]
    v_mfma_f32_16x16x32_bf16 v[44:47], v[236:239], v[68:71], v[44:47]
    s_waitcnt lgkmcnt(0)
    v_mfma_f32_16x16x32_bf16 v[16:19], v[240:243], v[72:75], v[16:19]
    v_mfma_f32_16x16x32_bf16 v[20:23], v[240:243], v[76:79], v[20:23]
    v_mfma_f32_16x16x32_bf16 v[24:27], v[244:247], v[72:75], v[24:27]
    v_mfma_f32_16x16x32_bf16 v[28:31], v[244:247], v[76:79], v[28:31]
    v_mfma_f32_16x16x32_bf16 v[32:35], v[248:251], v[72:75], v[32:35]
    v_mfma_f32_16x16x32_bf16 v[36:39], v[248:251], v[76:79], v[36:39]
    v_mfma_f32_16x16x32_bf16 v[40:43], v[252:255], v[72:75], v[40:43]
    v_mfma_f32_16x16x32_bf16 v[44:47], v[252:255], v[76:79], v[44:47]
    s_mul_i32 s47, s40, s32
    s_add_u32 s47, s47, s31
    s_add_u32 s48, s47, 55296
    v_mul_f32 v112, 0x3fb8aa3b, v16
    v_min_f32 v112, 0x41f00000, v112
    v_exp_f32 v112, v112
    v_mul_f32 v114, 0x3fb8aa3b, v17
    v_min_f32 v114, 0x41f00000, v114
    v_exp_f32 v114, v114
    v_mul_f32 v116, 0x3fb8aa3b, v18
    v_min_f32 v116, 0x41f00000, v116
    v_exp_f32 v116, v116
    v_mul_f32 v118, 0x3fb8aa3b, v19
    v_min_f32 v118, 0x41f00000, v118
    v_exp_f32 v118, v118
    v_mul_f32 v120, 0x3fb8aa3b, v20
    v_min_f32 v120, 0x41f00000, v120
    v_exp_f32 v120, v120
    v_mul_f32 v122, 0x3fb8aa3b, v21
    v_min_f32 v122, 0x41f00000, v122
    v_exp_f32 v122, v122
    v_mul_f32 v124, 0x3fb8aa3b, v22
    v_min_f32 v124, 0x41f00000, v124
    v_exp_f32 v124, v124
    v_mul_f32 v126, 0x3fb8aa3b, v23
    v_min_f32 v126, 0x41f00000, v126
    v_exp_f32 v126, v126
    v_mul_f32 v128, 0x3fb8aa3b, v24
    v_min_f32 v128, 0x41f00000, v128
    v_exp_f32 v128, v128
    v_mul_f32 v130, 0x3fb8aa3b, v25
    v_min_f32 v130, 0x41f00000, v130
    v_exp_f32 v130, v130
    v_mul_f32 v132, 0x3fb8aa3b, v26
    v_min_f32 v132, 0x41f00000, v132
    v_exp_f32 v132, v132
    v_mul_f32 v134, 0x3fb8aa3b, v27
    v_min_f32 v134, 0x41f00000, v134
    v_exp_f32 v134, v134
    v_mul_f32 v136, 0x3fb8aa3b, v28
    v_min_f32 v136, 0x41f00000, v136
    v_exp_f32 v136, v136
    v_mul_f32 v138, 0x3fb8aa3b, v29
    v_min_f32 v138, 0x41f00000, v138
    v_exp_f32 v138, v138
    v_mul_f32 v140, 0x3fb8aa3b, v30
    v_min_f32 v140, 0x41f00000, v140
    v_exp_f32 v140, v140
    v_mul_f32 v142, 0x3fb8aa3b, v31
    v_min_f32 v142, 0x41f00000, v142
    v_exp_f32 v142, v142
    v_mul_f32 v144, 0x3fb8aa3b, v32
    v_min_f32 v144, 0x41f00000, v144
    v_exp_f32 v144, v144
    v_mul_f32 v146, 0x3fb8aa3b, v33
    v_min_f32 v146, 0x41f00000, v146
    v_exp_f32 v146, v146
    v_mul_f32 v148, 0x3fb8aa3b, v34
    v_min_f32 v148, 0x41f00000, v148
    v_exp_f32 v148, v148
    v_mul_f32 v150, 0x3fb8aa3b, v35
    v_min_f32 v150, 0x41f00000, v150
    v_exp_f32 v150, v150
    v_mul_f32 v152, 0x3fb8aa3b, v36
    v_min_f32 v152, 0x41f00000, v152
    v_exp_f32 v152, v152
    v_mul_f32 v154, 0x3fb8aa3b, v37
    v_min_f32 v154, 0x41f00000, v154
    v_exp_f32 v154, v154
    v_mul_f32 v156, 0x3fb8aa3b, v38
    v_min_f32 v156, 0x41f00000, v156
    v_exp_f32 v156, v156
    v_mul_f32 v158, 0x3fb8aa3b, v39
    v_min_f32 v158, 0x41f00000, v158
    v_exp_f32 v158, v158
    v_mul_f32 v160, 0x3fb8aa3b, v40
    v_min_f32 v160, 0x41f00000, v160
    v_exp_f32 v160, v160
    v_mul_f32 v162, 0x3fb8aa3b, v41
    v_min_f32 v162, 0x41f00000, v162
    v_exp_f32 v162, v162
    v_mul_f32 v164, 0x3fb8aa3b, v42
    v_min_f32 v164, 0x41f00000, v164
    v_exp_f32 v164, v164
    v_mul_f32 v166, 0x3fb8aa3b, v43
    v_min_f32 v166, 0x41f00000, v166
    v_exp_f32 v166, v166
    v_mul_f32 v168, 0x3fb8aa3b, v44
    v_min_f32 v168, 0x41f00000, v168
    v_exp_f32 v168, v168
    v_mul_f32 v170, 0x3fb8aa3b, v45
    v_min_f32 v170, 0x41f00000, v170
    v_exp_f32 v170, v170
    v_mul_f32 v172, 0x3fb8aa3b, v46
    v_min_f32 v172, 0x41f00000, v172
    v_exp_f32 v172, v172
    v_mul_f32 v174, 0x3fb8aa3b, v47
    v_min_f32 v174, 0x41f00000, v174
    v_exp_f32 v174, v174
    v_add_f32 v113, 2.0, v112
    v_mul_f32 v112, v112, v113
    v_add_f32 v113, 2.0, v112
    v_rcp_f32 v113, v113
    v_mul_f32 v16, v16, v112
    v_add_f32 v115, 2.0, v114
    v_mul_f32 v114, v114, v115
    v_add_f32 v115, 2.0, v114
    v_rcp_f32 v115, v115
    v_mul_f32 v17, v17, v114
    v_add_f32 v117, 2.0, v116
    v_mul_f32 v116, v116, v117
    v_add_f32 v117, 2.0, v116
    v_rcp_f32 v117, v117
    v_mul_f32 v18, v18, v116
    v_add_f32 v119, 2.0, v118
    v_mul_f32 v118, v118, v119
    v_add_f32 v119, 2.0, v118
    v_rcp_f32 v119, v119
    v_mul_f32 v19, v19, v118
    v_add_f32 v121, 2.0, v120
    v_mul_f32 v120, v120, v121
    v_add_f32 v121, 2.0, v120
    v_rcp_f32 v121, v121
    v_mul_f32 v20, v20, v120
    v_add_f32 v123, 2.0, v122
    v_mul_f32 v122, v122, v123
    v_add_f32 v123, 2.0, v122
    v_rcp_f32 v123, v123
    v_mul_f32 v21, v21, v122
    v_add_f32 v125, 2.0, v124
    v_mul_f32 v124, v124, v125
    v_add_f32 v125, 2.0, v124
    v_rcp_f32 v125, v125
    v_mul_f32 v22, v22, v124
    v_add_f32 v127, 2.0, v126
    v_mul_f32 v126, v126, v127
    v_add_f32 v127, 2.0, v126
    v_rcp_f32 v127, v127
    v_mul_f32 v23, v23, v126
    v_add_f32 v129, 2.0, v128
    v_mul_f32 v128, v128, v129
    v_add_f32 v129, 2.0, v128
    v_rcp_f32 v129, v129
    v_mul_f32 v24, v24, v128
    v_add_f32 v131, 2.0, v130
    v_mul_f32 v130, v130, v131
    v_add_f32 v131, 2.0, v130
    v_rcp_f32 v131, v131
    v_mul_f32 v25, v25, v130
    v_add_f32 v133, 2.0, v132
    v_mul_f32 v132, v132, v133
    v_add_f32 v133, 2.0, v132
    v_rcp_f32 v133, v133
    v_mul_f32 v26, v26, v132
    v_add_f32 v135, 2.0, v134
    v_mul_f32 v134, v134, v135
    v_add_f32 v135, 2.0, v134
    v_rcp_f32 v135, v135
    v_mul_f32 v27, v27, v134
    v_add_f32 v137, 2.0, v136
    v_mul_f32 v136, v136, v137
    v_add_f32 v137, 2.0, v136
    v_rcp_f32 v137, v137
    v_mul_f32 v28, v28, v136
    v_add_f32 v139, 2.0, v138
    v_mul_f32 v138, v138, v139
    v_add_f32 v139, 2.0, v138
    v_rcp_f32 v139, v139
    v_mul_f32 v29, v29, v138
    v_add_f32 v141, 2.0, v140
    v_mul_f32 v140, v140, v141
    v_add_f32 v141, 2.0, v140
    v_rcp_f32 v141, v141
    v_mul_f32 v30, v30, v140
    v_add_f32 v143, 2.0, v142
    v_mul_f32 v142, v142, v143
    v_add_f32 v143, 2.0, v142
    v_rcp_f32 v143, v143
    v_mul_f32 v31, v31, v142
    v_add_f32 v145, 2.0, v144
    v_mul_f32 v144, v144, v145
    v_add_f32 v145, 2.0, v144
    v_rcp_f32 v145, v145
    v_mul_f32 v32, v32, v144
    v_add_f32 v147, 2.0, v146
    v_mul_f32 v146, v146, v147
    v_add_f32 v147, 2.0, v146
    v_rcp_f32 v147, v147
    v_mul_f32 v33, v33, v146
    v_add_f32 v149, 2.0, v148
    v_mul_f32 v148, v148, v149
    v_add_f32 v149, 2.0, v148
    v_rcp_f32 v149, v149
    v_mul_f32 v34, v34, v148
    v_add_f32 v151, 2.0, v150
    v_mul_f32 v150, v150, v151
    v_add_f32 v151, 2.0, v150
    v_rcp_f32 v151, v151
    v_mul_f32 v35, v35, v150
    v_add_f32 v153, 2.0, v152
    v_mul_f32 v152, v152, v153
    v_add_f32 v153, 2.0, v152
    v_rcp_f32 v153, v153
    v_mul_f32 v36, v36, v152
    v_add_f32 v155, 2.0, v154
    v_mul_f32 v154, v154, v155
    v_add_f32 v155, 2.0, v154
    v_rcp_f32 v155, v155
    v_mul_f32 v37, v37, v154
    v_add_f32 v157, 2.0, v156
    v_mul_f32 v156, v156, v157
    v_add_f32 v157, 2.0, v156
    v_rcp_f32 v157, v157
    v_mul_f32 v38, v38, v156
    v_add_f32 v159, 2.0, v158
    v_mul_f32 v158, v158, v159
    v_add_f32 v159, 2.0, v158
    v_rcp_f32 v159, v159
    v_mul_f32 v39, v39, v158
    v_add_f32 v161, 2.0, v160
    v_mul_f32 v160, v160, v161
    v_add_f32 v161, 2.0, v160
    v_rcp_f32 v161, v161
    v_mul_f32 v40, v40, v160
    v_add_f32 v163, 2.0, v162
    v_mul_f32 v162, v162, v163
    v_add_f32 v163, 2.0, v162
    v_rcp_f32 v163, v163
    v_mul_f32 v41, v41, v162
    v_add_f32 v165, 2.0, v164
    v_mul_f32 v164, v164, v165
    v_add_f32 v165, 2.0, v164
    v_rcp_f32 v165, v165
    v_mul_f32 v42, v42, v164
    v_add_f32 v167, 2.0, v166
    v_mul_f32 v166, v166, v167
    v_add_f32 v167, 2.0, v166
    v_rcp_f32 v167, v167
    v_mul_f32 v43, v43, v166
    v_add_f32 v169, 2.0, v168
    v_mul_f32 v168, v168, v169
    v_add_f32 v169, 2.0, v168
    v_rcp_f32 v169, v169
    v_mul_f32 v44, v44, v168
    v_add_f32 v171, 2.0, v170
    v_mul_f32 v170, v170, v171
    v_add_f32 v171, 2.0, v170
    v_rcp_f32 v171, v171
    v_mul_f32 v45, v45, v170
    v_add_f32 v173, 2.0, v172
    v_mul_f32 v172, v172, v173
    v_add_f32 v173, 2.0, v172
    v_rcp_f32 v173, v173
    v_mul_f32 v46, v46, v172
    v_add_f32 v175, 2.0, v174
    v_mul_f32 v174, v174, v175
    v_add_f32 v175, 2.0, v174
    v_rcp_f32 v175, v175
    v_mul_f32 v47, v47, v174
    v_mul_f32 v16, v16, v113
    v_mul_f32 v17, v17, v115
    v_mul_f32 v18, v18, v117
    v_mul_f32 v19, v19, v119
    v_mul_f32 v20, v20, v121
    v_mul_f32 v21, v21, v123
    v_mul_f32 v22, v22, v125
    v_mul_f32 v23, v23, v127
    v_mul_f32 v24, v24, v129
    v_mul_f32 v25, v25, v131
    v_mul_f32 v26, v26, v133
    v_mul_f32 v27, v27, v135
    v_mul_f32 v28, v28, v137
    v_mul_f32 v29, v29, v139
    v_mul_f32 v30, v30, v141
    v_mul_f32 v31, v31, v143
    v_mul_f32 v32, v32, v145
    v_mul_f32 v33, v33, v147
    v_mul_f32 v34, v34, v149
    v_mul_f32 v35, v35, v151
    v_mul_f32 v36, v36, v153
    v_mul_f32 v37, v37, v155
    v_mul_f32 v38, v38, v157
    v_mul_f32 v39, v39, v159
    v_mul_f32 v40, v40, v161
    v_mul_f32 v41, v41, v163
    v_mul_f32 v42, v42, v165
    v_mul_f32 v43, v43, v167
    v_mul_f32 v44, v44, v169
    v_mul_f32 v45, v45, v171
    v_mul_f32 v46, v46, v173
    v_mul_f32 v47, v47, v175
    v_cvt_pk_bf16_f32 v80, v16, v17
    v_cvt_pk_bf16_f32 v81, v18, v19
    v_cvt_pk_bf16_f32 v82, v24, v25
    v_cvt_pk_bf16_f32 v83, v26, v27
    buffer_store_dwordx4 v[80:83], v3, s[8:11], s47 offen offset:0 sc1
    v_cvt_pk_bf16_f32 v84, v20, v21
    v_cvt_pk_bf16_f32 v85, v22, v23
    v_cvt_pk_bf16_f32 v86, v28, v29
    v_cvt_pk_bf16_f32 v87, v30, v31
    buffer_store_dwordx4 v[84:87], v3, s[8:11], s48 offen offset:0 sc1
    v_cvt_pk_bf16_f32 v88, v32, v33
    v_cvt_pk_bf16_f32 v89, v34, v35
    v_cvt_pk_bf16_f32 v90, v40, v41
    v_cvt_pk_bf16_f32 v91, v42, v43
    buffer_store_dwordx4 v[88:91], v3, s[8:11], s47 offen offset:1024 sc1
    v_cvt_pk_bf16_f32 v92, v36, v37
    v_cvt_pk_bf16_f32 v93, v38, v39
    v_cvt_pk_bf16_f32 v94, v44, v45
    v_cvt_pk_bf16_f32 v95, v46, v47
    buffer_store_dwordx4 v[92:95], v3, s[8:11], s48 offen offset:1024 sc1
    v_mov_b32 v6, s40
    s_add_u32 s40, s40, s27
    s_add_u32 s42, s42, s27
    s_mov_b32 s43, s41
    s_add_u32 s41, s41, 40960
    s_cmp_eq_u32 s41, 122880
    s_cselect_b32 s41, 0, s41
    s_cmp_lt_u32 s40, 64
    s_waitcnt vmcnt(14)
    s_cbranch_scc1 g1loop_ffn_recurrent_scan__memory_aug_recurrent_mem_tr__dense_activation_mish__prompt_kernel_106
    s_branch g1fin_recurrent_scan__memory_aug_recurrent_mem_tr__dense_activation_mish__prompt_kernel_99
g1fin_recurrent_scan__memory_aug_recurrent_mem_tr__dense_activation_mish__prompt_kernel_99:
    v_mov_b32 v6, 64
    s_waitcnt vmcnt(0)
    buffer_store_dword v6, off, s[8:11], s49 sc1
g1done_recurrent_scan__memory_aug_recurrent_mem_tr__dense_activation_mish__prompt_kernel_98:
    s_sub_u32 s6, s4, 2
    s_cmp_ge_u32 s5, 20
    s_cbranch_scc1 att_recurrent_scan__memory_aug_recurrent_mem_tr__dense_activation_mish__prompt_kernel_109
    s_mov_b32 s12, s74
    s_and_b32 s13, s75, 0xffff
    s_mov_b32 s14, 5242880
    s_mov_b32 s15, 0x20000
    s_mov_b32 s16, s84
    s_and_b32 s17, s85, 0xffff
    s_mov_b32 s18, 2211840
    s_mov_b32 s19, 0x20000
    s_mov_b32 s20, s64
    s_and_b32 s21, s65, 0xffff
    s_mov_b32 s22, 2621440
    s_mov_b32 s23, 0x20000
    s_mov_b32 s28, s86
    s_and_b32 s29, s87, 0xffff
    s_mov_b32 s30, 2621440
    s_mov_b32 s31, 0x20000
    v_mbcnt_lo_u32_b32 v0, -1, 0
    v_mbcnt_hi_u32_b32 v0, -1, v0
    v_lshrrev_b32 v1, 4, v0
    v_bfe_u32 v2, v0, 2, 2
    v_lshl_add_u32 v2, v1, 3, v2
    v_mul_u32_u24 v2, 1280, v2
    v_and_b32 v3, 3, v0
    v_lshl_add_u32 v2, v3, 4, v2
    v_and_b32 v3, 15, v0
    v_mul_u32_u24 v3, 1280, v3
    v_lshl_add_u32 v3, v1, 4, v3
    s_lshl_b32 s32, s5, 6
    s_lshl_b32 s33, s3, 2
    s_add_u32 s33, s33, s32
    v_add_u32 v3, s33, v3
    v_and_b32 v5, 7, v0
    v_lshlrev_b32 v5, 2, v5
    v_lshlrev_b32 v7, 2, v0
    v_lshlrev_b32 v0, 4, v0
    s_lshl_b32 s34, s3, 15
    s_add_u32 s34, s34, 32768
    v_add_u32 v4, s34, v0
    s_mul_i32 s35, s3, 1310720
    s_add_u32 s35, s35, s32
    s_mul_i32 s36, s3, 40960
    s_add_u32 s36, s36, s32
    s_lshl_b32 s37, s3, 12
    v_add_u32 v6, s37, v0
    s_lshr_b32 s37, s3, 1
    s_lshl_b32 s37, s37, 10
    s_and_b32 s38, s3, 1
    s_lshl_b32 s38, s38, 3
    s_add_u32 s37, s37, s38
    v_add_u32 v8, s37, v0
    s_barrier
    s_add_u32 s39, s36, 0
    s_add_u32 m0, s34, 0
    s_nop 0
    buffer_load_dwordx4 v2, s[16:19], s39 offen lds
    s_add_u32 s39, s36, 5120
    s_add_u32 m0, s34, 1024
    s_nop 0
    buffer_load_dwordx4 v2, s[16:19], s39 offen lds
    s_add_u32 s39, s36, 163840
    s_add_u32 m0, s34, 2048
    s_nop 0
    buffer_load_dwordx4 v2, s[16:19], s39 offen lds
    s_add_u32 s39, s36, 168960
    s_add_u32 m0, s34, 3072
    s_nop 0
    buffer_load_dwordx4 v2, s[16:19], s39 offen lds
    s_add_u32 s39, s36, 327680
    s_add_u32 m0, s34, 4096
    s_nop 0
    buffer_load_dwordx4 v2, s[16:19], s39 offen lds
    s_add_u32 s39, s36, 332800
    s_add_u32 m0, s34, 5120
    s_nop 0
    buffer_load_dwordx4 v2, s[16:19], s39 offen lds
    s_add_u32 s39, s36, 491520
    s_add_u32 m0, s34, 6144
    s_nop 0
    buffer_load_dwordx4 v2, s[16:19], s39 offen lds
    s_add_u32 s39, s36, 496640
    s_add_u32 m0, s34, 7168
    s_nop 0
    buffer_load_dwordx4 v2, s[16:19], s39 offen lds
    s_add_u32 s39, s36, 655360
    s_add_u32 m0, s34, 8192
    s_nop 0
    buffer_load_dwordx4 v2, s[16:19], s39 offen lds
    s_add_u32 s39, s36, 660480
    s_add_u32 m0, s34, 9216
    s_nop 0
    buffer_load_dwordx4 v2, s[16:19], s39 offen lds
    s_add_u32 s39, s36, 819200
    s_add_u32 m0, s34, 10240
    s_nop 0
    buffer_load_dwordx4 v2, s[16:19], s39 offen lds
    s_add_u32 s39, s36, 824320
    s_add_u32 m0, s34, 11264
    s_nop 0
    buffer_load_dwordx4 v2, s[16:19], s39 offen lds
    s_add_u32 s39, s36, 983040
    s_add_u32 m0, s34, 12288
    s_nop 0
    buffer_load_dwordx4 v2, s[16:19], s39 offen lds
    s_add_u32 s39, s36, 988160
    s_add_u32 m0, s34, 13312
    s_nop 0
    buffer_load_dwordx4 v2, s[16:19], s39 offen lds
    s_add_u32 s39, s36, 1146880
    s_add_u32 m0, s34, 14336
    s_nop 0
    buffer_load_dwordx4 v2, s[16:19], s39 offen lds
    s_add_u32 s39, s36, 1152000
    s_add_u32 m0, s34, 15360
    s_nop 0
    buffer_load_dwordx4 v2, s[16:19], s39 offen lds
    s_add_u32 s39, s36, 1310720
    s_add_u32 m0, s34, 16384
    s_nop 0
    buffer_load_dwordx4 v2, s[16:19], s39 offen lds
    s_add_u32 s39, s36, 1315840
    s_add_u32 m0, s34, 17408
    s_nop 0
    buffer_load_dwordx4 v2, s[16:19], s39 offen lds
    s_add_u32 s39, s36, 1474560
    s_add_u32 m0, s34, 18432
    s_nop 0
    buffer_load_dwordx4 v2, s[16:19], s39 offen lds
    s_add_u32 s39, s36, 1479680
    s_add_u32 m0, s34, 19456
    s_nop 0
    buffer_load_dwordx4 v2, s[16:19], s39 offen lds
    s_add_u32 s39, s36, 1638400
    s_add_u32 m0, s34, 20480
    s_nop 0
    buffer_load_dwordx4 v2, s[16:19], s39 offen lds
    s_add_u32 s39, s36, 1643520
    s_add_u32 m0, s34, 21504
    s_nop 0
    buffer_load_dwordx4 v2, s[16:19], s39 offen lds
    s_add_u32 s39, s36, 1802240
    s_add_u32 m0, s34, 22528
    s_nop 0
    buffer_load_dwordx4 v2, s[16:19], s39 offen lds
    s_add_u32 s39, s36, 1807360
    s_add_u32 m0, s34, 23552
    s_nop 0
    buffer_load_dwordx4 v2, s[16:19], s39 offen lds
    s_add_u32 s39, s36, 1966080
    s_add_u32 m0, s34, 24576
    s_nop 0
    buffer_load_dwordx4 v2, s[16:19], s39 offen lds
    s_add_u32 s39, s36, 1971200
    s_add_u32 m0, s34, 25600
    s_nop 0
    buffer_load_dwordx4 v2, s[16:19], s39 offen lds
    s_add_u32 s39, s36, 2129920
    s_add_u32 m0, s34, 26624
    s_nop 0
    buffer_load_dwordx4 v2, s[16:19], s39 offen lds
    s_add_u32 s39, s36, 2135040
    s_add_u32 m0, s34, 27648
    s_nop 0
    buffer_load_dwordx4 v2, s[16:19], s39 offen lds
    s_add_u32 s39, s35, 0
    s_add_u32 m0, s34, 28672
    s_nop 0
    buffer_load_dwordx4 v2, s[12:15], s39 offen lds
    s_add_u32 s39, s35, 5120
    s_add_u32 m0, s34, 29696
    s_nop 0
    buffer_load_dwordx4 v2, s[12:15], s39 offen lds
    s_add_u32 s39, s35, 40960
    s_add_u32 m0, s34, 30720
    s_nop 0
    buffer_load_dwordx4 v2, s[12:15], s39 offen lds
    s_add_u32 s39, s35, 46080
    s_add_u32 m0, s34, 31744
    s_nop 0
    buffer_load_dwordx4 v2, s[12:15], s39 offen lds
    s_waitcnt vmcnt(24)
    ds_read_b64_tr_b16 v[144:145], v4 offset:0
    ds_read_b64_tr_b16 v[148:149], v4 offset:8
    ds_read_b64_tr_b16 v[146:147], v4 offset:1024
    ds_read_b64_tr_b16 v[150:151], v4 offset:1032
    ds_read_b64_tr_b16 v[152:153], v4 offset:2048
    ds_read_b64_tr_b16 v[156:157], v4 offset:2056
    ds_read_b64_tr_b16 v[154:155], v4 offset:3072
    ds_read_b64_tr_b16 v[158:159], v4 offset:3080
    ds_read_b64_tr_b16 v[160:161], v4 offset:4096
    ds_read_b64_tr_b16 v[164:165], v4 offset:4104
    ds_read_b64_tr_b16 v[162:163], v4 offset:5120
    ds_read_b64_tr_b16 v[166:167], v4 offset:5128
    ds_read_b64_tr_b16 v[168:169], v4 offset:6144
    ds_read_b64_tr_b16 v[172:173], v4 offset:6152
    ds_read_b64_tr_b16 v[170:171], v4 offset:7168
    ds_read_b64_tr_b16 v[174:175], v4 offset:7176
    s_waitcnt lgkmcnt(0)
    s_add_u32 s39, s35, 81920
    s_add_u32 m0, s34, 0
    s_nop 0
    buffer_load_dwordx4 v2, s[12:15], s39 offen lds
    s_add_u32 s39, s35, 87040
    s_add_u32 m0, s34, 1024
    s_nop 0
    buffer_load_dwordx4 v2, s[12:15], s39 offen lds
    s_add_u32 s39, s35, 122880
    s_add_u32 m0, s34, 2048
    s_nop 0
    buffer_load_dwordx4 v2, s[12:15], s39 offen lds
    s_add_u32 s39, s35, 128000
    s_add_u32 m0, s34, 3072
    s_nop 0
    buffer_load_dwordx4 v2, s[12:15], s39 offen lds
    s_add_u32 s39, s35, 163840
    s_add_u32 m0, s34, 4096
    s_nop 0
    buffer_load_dwordx4 v2, s[12:15], s39 offen lds
    s_add_u32 s39, s35, 168960
    s_add_u32 m0, s34, 5120
    s_nop 0
    buffer_load_dwordx4 v2, s[12:15], s39 offen lds
    s_add_u32 s39, s35, 204800
    s_add_u32 m0, s34, 6144
    s_nop 0
    buffer_load_dwordx4 v2, s[12:15], s39 offen lds
    s_add_u32 s39, s35, 209920
    s_add_u32 m0, s34, 7168
    s_nop 0
    buffer_load_dwordx4 v2, s[12:15], s39 offen lds
    s_waitcnt vmcnt(24)
    ds_read_b64_tr_b16 v[176:177], v4 offset:8192
    ds_read_b64_tr_b16 v[180:181], v4 offset:8200
    ds_read_b64_tr_b16 v[178:179], v4 offset:9216
    ds_read_b64_tr_b16 v[182:183], v4 offset:9224
    ds_read_b64_tr_b16 v[184:185], v4 offset:10240
    ds_read_b64_tr_b16 v[188:189], v4 offset:10248
    ds_read_b64_tr_b16 v[186:187], v4 offset:11264
    ds_read_b64_tr_b16 v[190:191], v4 offset:11272
    ds_read_b64_tr_b16 v[192:193], v4 offset:12288
    ds_read_b64_tr_b16 v[196:197], v4 offset:12296
    ds_read_b64_tr_b16 v[194:195], v4 offset:13312
    ds_read_b64_tr_b16 v[198:199], v4 offset:13320
    ds_read_b64_tr_b16 v[200:201], v4 offset:14336
    ds_read_b64_tr_b16 v[204:205], v4 offset:14344
    ds_read_b64_tr_b16 v[202:203], v4 offset:15360
    ds_read_b64_tr_b16 v[206:207], v4 offset:15368
    s_waitcnt lgkmcnt(0)
    s_add_u32 s39, s35, 245760
    s_add_u32 m0, s34, 8192
    s_nop 0
    buffer_load_dwordx4 v2, s[12:15], s39 offen lds
    s_add_u32 s39, s35, 250880
    s_add_u32 m0, s34, 9216
    s_nop 0
    buffer_load_dwordx4 v2, s[12:15], s39 offen lds
    s_add_u32 s39, s35, 286720
    s_add_u32 m0, s34, 10240
    s_nop 0
    buffer_load_dwordx4 v2, s[12:15], s39 offen lds
    s_add_u32 s39, s35, 291840
    s_add_u32 m0, s34, 11264
    s_nop 0
    buffer_load_dwordx4 v2, s[12:15], s39 offen lds
    s_add_u32 s39, s35, 327680
    s_add_u32 m0, s34, 12288
    s_nop 0
    buffer_load_dwordx4 v2, s[12:15], s39 offen lds
    s_add_u32 s39, s35, 332800
    s_add_u32 m0, s34, 13312
    s_nop 0
    buffer_load_dwordx4 v2, s[12:15], s39 offen lds
    s_add_u32 s39, s35, 368640
    s_add_u32 m0, s34, 14336
    s_nop 0
    buffer_load_dwordx4 v2, s[12:15], s39 offen lds
    s_add_u32 s39, s35, 373760
    s_add_u32 m0, s34, 15360
    s_nop 0
    buffer_load_dwordx4 v2, s[12:15], s39 offen lds
    s_waitcnt vmcnt(24)
    ds_read_b64_tr_b16 v[208:209], v4 offset:16384
    ds_read_b64_tr_b16 v[212:213], v4 offset:16392
    ds_read_b64_tr_b16 v[210:211], v4 offset:17408
    ds_read_b64_tr_b16 v[214:215], v4 offset:17416
    ds_read_b64_tr_b16 v[216:217], v4 offset:18432
    ds_read_b64_tr_b16 v[220:221], v4 offset:18440
    ds_read_b64_tr_b16 v[218:219], v4 offset:19456
    ds_read_b64_tr_b16 v[222:223], v4 offset:19464
    ds_read_b64_tr_b16 v[224:225], v4 offset:20480
    ds_read_b64_tr_b16 v[228:229], v4 offset:20488
    ds_read_b64_tr_b16 v[226:227], v4 offset:21504
    ds_read_b64_tr_b16 v[230:231], v4 offset:21512
    ds_read_b64_tr_b16 v[232:233], v4 offset:22528
    ds_read_b64_tr_b16 v[236:237], v4 offset:22536
    ds_read_b64_tr_b16 v[234:235], v4 offset:23552
    ds_read_b64_tr_b16 v[238:239], v4 offset:23560
    s_waitcnt lgkmcnt(0)
    s_add_u32 s39, s35, 409600
    s_add_u32 m0, s34, 16384
    s_nop 0
    buffer_load_dwordx4 v2, s[12:15], s39 offen lds
    s_add_u32 s39, s35, 414720
    s_add_u32 m0, s34, 17408
    s_nop 0
    buffer_load_dwordx4 v2, s[12:15], s39 offen lds
    s_add_u32 s39, s35, 450560
    s_add_u32 m0, s34, 18432
    s_nop 0
    buffer_load_dwordx4 v2, s[12:15], s39 offen lds
    s_add_u32 s39, s35, 455680
    s_add_u32 m0, s34, 19456
    s_nop 0
    buffer_load_dwordx4 v2, s[12:15], s39 offen lds
    s_add_u32 s39, s35, 491520
    s_add_u32 m0, s34, 20480
    s_nop 0
    buffer_load_dwordx4 v2, s[12:15], s39 offen lds
    s_add_u32 s39, s35, 496640
    s_add_u32 m0, s34, 21504
    s_nop 0
    buffer_load_dwordx4 v2, s[12:15], s39 offen lds
    s_add_u32 s39, s35, 532480
    s_add_u32 m0, s34, 22528
    s_nop 0
    buffer_load_dwordx4 v2, s[12:15], s39 offen lds
    s_add_u32 s39, s35, 537600
    s_add_u32 m0, s34, 23552
    s_nop 0
    buffer_load_dwordx4 v2, s[12:15], s39 offen lds
    s_waitcnt vmcnt(24)
    ds_read_b64_tr_b16 v[240:241], v4 offset:24576
    ds_read_b64_tr_b16 v[244:245], v4 offset:24584
    ds_read_b64_tr_b16 v[242:243], v4 offset:25600
    ds_read_b64_tr_b16 v[246:247], v4 offset:25608
    ds_read_b64_tr_b16 v[248:249], v4 offset:26624
    ds_read_b64_tr_b16 v[252:253], v4 offset:26632
    ds_read_b64_tr_b16 v[250:251], v4 offset:27648
    ds_read_b64_tr_b16 v[254:255], v4 offset:27656
    ds_read_b64_tr_b16 a[0:1], v4 offset:28672
    ds_read_b64_tr_b16 a[4:5], v4 offset:28680
    ds_read_b64_tr_b16 a[2:3], v4 offset:29696
    ds_read_b64_tr_b16 a[6:7], v4 offset:29704
    ds_read_b64_tr_b16 a[8:9], v4 offset:30720
    ds_read_b64_tr_b16 a[12:13], v4 offset:30728
    ds_read_b64_tr_b16 a[10:11], v4 offset:31744
    ds_read_b64_tr_b16 a[14:15], v4 offset:31752
    s_waitcnt lgkmcnt(0)
    s_add_u32 s39, s35, 573440
    s_add_u32 m0, s34, 24576
    s_nop 0
    buffer_load_dwordx4 v2, s[12:15], s39 offen lds
    s_add_u32 s39, s35, 578560
    s_add_u32 m0, s34, 25600
    s_nop 0
    buffer_load_dwordx4 v2, s[12:15], s39 offen lds
    s_add_u32 s39, s35, 614400
    s_add_u32 m0, s34, 26624
    s_nop 0
    buffer_load_dwordx4 v2, s[12:15], s39 offen lds
    s_add_u32 s39, s35, 619520
    s_add_u32 m0, s34, 27648
    s_nop 0
    buffer_load_dwordx4 v2, s[12:15], s39 offen lds
    s_add_u32 s39, s35, 655360
    s_add_u32 m0, s34, 28672
    s_nop 0
    buffer_load_dwordx4 v2, s[12:15], s39 offen lds
    s_add_u32 s39, s35, 660480
    s_add_u32 m0, s34, 29696
    s_nop 0
    buffer_load_dwordx4 v2, s[12:15], s39 offen lds
    s_add_u32 s39, s35, 696320
    s_add_u32 m0, s34, 30720
    s_nop 0
    buffer_load_dwordx4 v2, s[12:15], s39 offen lds
    s_add_u32 s39, s35, 701440
    s_add_u32 m0, s34, 31744
    s_nop 0
    buffer_load_dwordx4 v2, s[12:15], s39 offen lds
    s_waitcnt vmcnt(24)
    ds_read_b64_tr_b16 a[16:17], v4 offset:0
    ds_read_b64_tr_b16 a[20:21], v4 offset:8
    ds_read_b64_tr_b16 a[18:19], v4 offset:1024
    ds_read_b64_tr_b16 a[22:23], v4 offset:1032
    ds_read_b64_tr_b16 a[24:25], v4 offset:2048
    ds_read_b64_tr_b16 a[28:29], v4 offset:2056
    ds_read_b64_tr_b16 a[26:27], v4 offset:3072
    ds_read_b64_tr_b16 a[30:31], v4 offset:3080
    ds_read_b64_tr_b16 a[32:33], v4 offset:4096
    ds_read_b64_tr_b16 a[36:37], v4 offset:4104
    ds_read_b64_tr_b16 a[34:35], v4 offset:5120
    ds_read_b64_tr_b16 a[38:39], v4 offset:5128
    ds_read_b64_tr_b16 a[40:41], v4 offset:6144
    ds_read_b64_tr_b16 a[44:45], v4 offset:6152
    ds_read_b64_tr_b16 a[42:43], v4 offset:7168
    ds_read_b64_tr_b16 a[46:47], v4 offset:7176
    s_waitcnt lgkmcnt(0)
    s_add_u32 s39, s35, 737280
    s_add_u32 m0, s34, 0
    s_nop 0
    buffer_load_dwordx4 v2, s[12:15], s39 offen lds
    s_add_u32 s39, s35, 742400
    s_add_u32 m0, s34, 1024
    s_nop 0
    buffer_load_dwordx4 v2, s[12:15], s39 offen lds
    s_add_u32 s39, s35, 778240
    s_add_u32 m0, s34, 2048
    s_nop 0
    buffer_load_dwordx4 v2, s[12:15], s39 offen lds
    s_add_u32 s39, s35, 783360
    s_add_u32 m0, s34, 3072
    s_nop 0
    buffer_load_dwordx4 v2, s[12:15], s39 offen lds
    s_add_u32 s39, s35, 819200
    s_add_u32 m0, s34, 4096
    s_nop 0
    buffer_load_dwordx4 v2, s[12:15], s39 offen lds
    s_add_u32 s39, s35, 824320
    s_add_u32 m0, s34, 5120
    s_nop 0
    buffer_load_dwordx4 v2, s[12:15], s39 offen lds
    s_add_u32 s39, s35, 860160
    s_add_u32 m0, s34, 6144
    s_nop 0
    buffer_load_dwordx4 v2, s[12:15], s39 offen lds
    s_add_u32 s39, s35, 865280
    s_add_u32 m0, s34, 7168
    s_nop 0
    buffer_load_dwordx4 v2, s[12:15], s39 offen lds
    s_waitcnt vmcnt(24)
    ds_read_b64_tr_b16 a[48:49], v4 offset:8192
    ds_read_b64_tr_b16 a[52:53], v4 offset:8200
    ds_read_b64_tr_b16 a[50:51], v4 offset:9216
    ds_read_b64_tr_b16 a[54:55], v4 offset:9224
    ds_read_b64_tr_b16 a[56:57], v4 offset:10240
    ds_read_b64_tr_b16 a[60:61], v4 offset:10248
    ds_read_b64_tr_b16 a[58:59], v4 offset:11264
    ds_read_b64_tr_b16 a[62:63], v4 offset:11272
    ds_read_b64_tr_b16 a[64:65], v4 offset:12288
    ds_read_b64_tr_b16 a[68:69], v4 offset:12296
    ds_read_b64_tr_b16 a[66:67], v4 offset:13312
    ds_read_b64_tr_b16 a[70:71], v4 offset:13320
    ds_read_b64_tr_b16 a[72:73], v4 offset:14336
    ds_read_b64_tr_b16 a[76:77], v4 offset:14344
    ds_read_b64_tr_b16 a[74:75], v4 offset:15360
    ds_read_b64_tr_b16 a[78:79], v4 offset:15368
    s_waitcnt lgkmcnt(0)
    s_add_u32 s39, s35, 901120
    s_add_u32 m0, s34, 8192
    s_nop 0
    buffer_load_dwordx4 v2, s[12:15], s39 offen lds
    s_add_u32 s39, s35, 906240
    s_add_u32 m0, s34, 9216
    s_nop 0
    buffer_load_dwordx4 v2, s[12:15], s39 offen lds
    s_add_u32 s39, s35, 942080
    s_add_u32 m0, s34, 10240
    s_nop 0
    buffer_load_dwordx4 v2, s[12:15], s39 offen lds
    s_add_u32 s39, s35, 947200
    s_add_u32 m0, s34, 11264
    s_nop 0
    buffer_load_dwordx4 v2, s[12:15], s39 offen lds
    s_add_u32 s39, s35, 983040
    s_add_u32 m0, s34, 12288
    s_nop 0
    buffer_load_dwordx4 v2, s[12:15], s39 offen lds
    s_add_u32 s39, s35, 988160
    s_add_u32 m0, s34, 13312
    s_nop 0
    buffer_load_dwordx4 v2, s[12:15], s39 offen lds
    s_add_u32 s39, s35, 1024000
    s_add_u32 m0, s34, 14336
    s_nop 0
    buffer_load_dwordx4 v2, s[12:15], s39 offen lds
    s_add_u32 s39, s35, 1029120
    s_add_u32 m0, s34, 15360
    s_nop 0
    buffer_load_dwordx4 v2, s[12:15], s39 offen lds
    s_waitcnt vmcnt(24)
    ds_read_b64_tr_b16 a[80:81], v4 offset:16384
    ds_read_b64_tr_b16 a[84:85], v4 offset:16392
    ds_read_b64_tr_b16 a[82:83], v4 offset:17408
    ds_read_b64_tr_b16 a[86:87], v4 offset:17416
    ds_read_b64_tr_b16 a[88:89], v4 offset:18432
    ds_read_b64_tr_b16 a[92:93], v4 offset:18440
    ds_read_b64_tr_b16 a[90:91], v4 offset:19456
    ds_read_b64_tr_b16 a[94:95], v4 offset:19464
    ds_read_b64_tr_b16 a[96:97], v4 offset:20480
    ds_read_b64_tr_b16 a[100:101], v4 offset:20488
    ds_read_b64_tr_b16 a[98:99], v4 offset:21504
    ds_read_b64_tr_b16 a[102:103], v4 offset:21512
    ds_read_b64_tr_b16 a[104:105], v4 offset:22528
    ds_read_b64_tr_b16 a[108:109], v4 offset:22536
    ds_read_b64_tr_b16 a[106:107], v4 offset:23552
    ds_read_b64_tr_b16 a[110:111], v4 offset:23560
    s_waitcnt lgkmcnt(0)
    s_add_u32 s39, s35, 1064960
    s_add_u32 m0, s34, 16384
    s_nop 0
    buffer_load_dwordx4 v2, s[12:15], s39 offen lds
    s_add_u32 s39, s35, 1070080
    s_add_u32 m0, s34, 17408
    s_nop 0
    buffer_load_dwordx4 v2, s[12:15], s39 offen lds
    s_add_u32 s39, s35, 1105920
    s_add_u32 m0, s34, 18432
    s_nop 0
    buffer_load_dwordx4 v2, s[12:15], s39 offen lds
    s_add_u32 s39, s35, 1111040
    s_add_u32 m0, s34, 19456
    s_nop 0
    buffer_load_dwordx4 v2, s[12:15], s39 offen lds
    s_add_u32 s39, s35, 1146880
    s_add_u32 m0, s34, 20480
    s_nop 0
    buffer_load_dwordx4 v2, s[12:15], s39 offen lds
    s_add_u32 s39, s35, 1152000
    s_add_u32 m0, s34, 21504
    s_nop 0
    buffer_load_dwordx4 v2, s[12:15], s39 offen lds
    s_add_u32 s39, s35, 1187840
    s_add_u32 m0, s34, 22528
    s_nop 0
    buffer_load_dwordx4 v2, s[12:15], s39 offen lds
    s_add_u32 s39, s35, 1192960
    s_add_u32 m0, s34, 23552
    s_nop 0
    buffer_load_dwordx4 v2, s[12:15], s39 offen lds
    s_waitcnt vmcnt(24)
    ds_read_b64_tr_b16 a[112:113], v4 offset:24576
    ds_read_b64_tr_b16 a[116:117], v4 offset:24584
    ds_read_b64_tr_b16 a[114:115], v4 offset:25600
    ds_read_b64_tr_b16 a[118:119], v4 offset:25608
    ds_read_b64_tr_b16 a[120:121], v4 offset:26624
    ds_read_b64_tr_b16 a[124:125], v4 offset:26632
    ds_read_b64_tr_b16 a[122:123], v4 offset:27648
    ds_read_b64_tr_b16 a[126:127], v4 offset:27656
    ds_read_b64_tr_b16 a[128:129], v4 offset:28672
    ds_read_b64_tr_b16 a[132:133], v4 offset:28680
    ds_read_b64_tr_b16 a[130:131], v4 offset:29696
    ds_read_b64_tr_b16 a[134:135], v4 offset:29704
    ds_read_b64_tr_b16 a[136:137], v4 offset:30720
    ds_read_b64_tr_b16 a[140:141], v4 offset:30728
    ds_read_b64_tr_b16 a[138:139], v4 offset:31744
    ds_read_b64_tr_b16 a[142:143], v4 offset:31752
    s_waitcnt lgkmcnt(0)
    s_add_u32 s39, s35, 1228800
    s_add_u32 m0, s34, 24576
    s_nop 0
    buffer_load_dwordx4 v2, s[12:15], s39 offen lds
    s_add_u32 s39, s35, 1233920
    s_add_u32 m0, s34, 25600
    s_nop 0
    buffer_load_dwordx4 v2, s[12:15], s39 offen lds
    s_add_u32 s39, s35, 1269760
    s_add_u32 m0, s34, 26624
    s_nop 0
    buffer_load_dwordx4 v2, s[12:15], s39 offen lds
    s_add_u32 s39, s35, 1274880
    s_add_u32 m0, s34, 27648
    s_nop 0
    buffer_load_dwordx4 v2, s[12:15], s39 offen lds
    s_waitcnt vmcnt(20)
    ds_read_b64_tr_b16 a[144:145], v4 offset:0
    ds_read_b64_tr_b16 a[148:149], v4 offset:8
    ds_read_b64_tr_b16 a[146:147], v4 offset:1024
    ds_read_b64_tr_b16 a[150:151], v4 offset:1032
    ds_read_b64_tr_b16 a[152:153], v4 offset:2048
    ds_read_b64_tr_b16 a[156:157], v4 offset:2056
    ds_read_b64_tr_b16 a[154:155], v4 offset:3072
    ds_read_b64_tr_b16 a[158:159], v4 offset:3080
    ds_read_b64_tr_b16 a[160:161], v4 offset:4096
    ds_read_b64_tr_b16 a[164:165], v4 offset:4104
    ds_read_b64_tr_b16 a[162:163], v4 offset:5120
    ds_read_b64_tr_b16 a[166:167], v4 offset:5128
    ds_read_b64_tr_b16 a[168:169], v4 offset:6144
    ds_read_b64_tr_b16 a[172:173], v4 offset:6152
    ds_read_b64_tr_b16 a[170:171], v4 offset:7168
    ds_read_b64_tr_b16 a[174:175], v4 offset:7176
    s_waitcnt vmcnt(12)
    ds_read_b64_tr_b16 a[176:177], v4 offset:8192
    ds_read_b64_tr_b16 a[180:181], v4 offset:8200
    ds_read_b64_tr_b16 a[178:179], v4 offset:9216
    ds_read_b64_tr_b16 a[182:183], v4 offset:9224
    ds_read_b64_tr_b16 a[184:185], v4 offset:10240
    ds_read_b64_tr_b16 a[188:189], v4 offset:10248
    ds_read_b64_tr_b16 a[186:187], v4 offset:11264
    ds_read_b64_tr_b16 a[190:191], v4 offset:11272
    ds_read_b64_tr_b16 a[192:193], v4 offset:12288
    ds_read_b64_tr_b16 a[196:197], v4 offset:12296
    ds_read_b64_tr_b16 a[194:195], v4 offset:13312
    ds_read_b64_tr_b16 a[198:199], v4 offset:13320
    ds_read_b64_tr_b16 a[200:201], v4 offset:14336
    ds_read_b64_tr_b16 a[204:205], v4 offset:14344
    ds_read_b64_tr_b16 a[202:203], v4 offset:15360
    ds_read_b64_tr_b16 a[206:207], v4 offset:15368
    s_waitcnt vmcnt(4)
    ds_read_b64_tr_b16 a[208:209], v4 offset:16384
    ds_read_b64_tr_b16 a[212:213], v4 offset:16392
    ds_read_b64_tr_b16 a[210:211], v4 offset:17408
    ds_read_b64_tr_b16 a[214:215], v4 offset:17416
    ds_read_b64_tr_b16 a[216:217], v4 offset:18432
    ds_read_b64_tr_b16 a[220:221], v4 offset:18440
    ds_read_b64_tr_b16 a[218:219], v4 offset:19456
    ds_read_b64_tr_b16 a[222:223], v4 offset:19464
    ds_read_b64_tr_b16 a[224:225], v4 offset:20480
    ds_read_b64_tr_b16 a[228:229], v4 offset:20488
    ds_read_b64_tr_b16 a[226:227], v4 offset:21504
    ds_read_b64_tr_b16 a[230:231], v4 offset:21512
    ds_read_b64_tr_b16 a[232:233], v4 offset:22528
    ds_read_b64_tr_b16 a[236:237], v4 offset:22536
    ds_read_b64_tr_b16 a[234:235], v4 offset:23552
    ds_read_b64_tr_b16 a[238:239], v4 offset:23560
    s_waitcnt vmcnt(0)
    ds_read_b64_tr_b16 a[240:241], v4 offset:24576
    ds_read_b64_tr_b16 a[244:245], v4 offset:24584
    ds_read_b64_tr_b16 a[242:243], v4 offset:25600
    ds_read_b64_tr_b16 a[246:247], v4 offset:25608
    ds_read_b64_tr_b16 a[248:249], v4 offset:26624
    ds_read_b64_tr_b16 a[252:253], v4 offset:26632
    ds_read_b64_tr_b16 a[250:251], v4 offset:27648
    ds_read_b64_tr_b16 a[254:255], v4 offset:27656
    s_waitcnt lgkmcnt(0)
    s_cmp_lt_u32 s3, 2
    s_cbranch_scc1 nz_recurrent_scan__memory_aug_recurrent_mem_tr__dense_activation_mish__prompt_kernel_111
    v_mov_b32 v248, 0
    v_mov_b32 v249, 0
    v_mov_b32 v250, 0
    v_mov_b32 v251, 0
    v_mov_b32 v252, 0
    v_mov_b32 v253, 0
    v_mov_b32 v254, 0
    v_mov_b32 v255, 0
nz_recurrent_scan__memory_aug_recurrent_mem_tr__dense_activation_mish__prompt_kernel_111:
    s_mov_b32 s40, s6
    s_mul_i32 s41, s40, 55296
    s_lshl_b32 s39, s3, 10
    s_add_u32 s41, s41, s39
    s_add_u32 s41, s41, 71303168
    s_lshl_b32 s42, s40, 17
    s_lshl_b32 s39, s3, 15
    s_add_u32 s42, s42, s39
    s_add_u32 s42, s42, 79691776
    s_cmp_lt_u32 s3, 2
    s_cselect_b32 s43, 53248, 0
    s_mov_b32 s44, 0
    s_mov_b32 s45, 0
    s_lshl_b32 s46, s3, 5
    s_add_u32 s46, s46, 97923072
    s_mov_b32 s38, 97918976
    s_mov_b32 s39, 64
spin_recurrent_scan__memory_aug_recurrent_mem_tr__dense_activation_mish__prompt_kernel_112:
    buffer_load_dword v9, v7, s[8:11], s38 offen offset:0 sc1
    s_waitcnt vmcnt(0)
    v_cmp_gt_u32 vcc, s39, v9
    s_cbranch_vccz spok_recurrent_scan__memory_aug_recurrent_mem_tr__dense_activation_mish__prompt_kernel_113
    s_add_u32 s44, s44, 1
    s_cmp_gt_u32 s44, 100000
    s_cbranch_scc1 recurrent_scan__memory_aug_recurrent_mem_tr__dense_activation_mish__prompt_kernel_exit
    s_sleep 2
    s_branch spin_recurrent_scan__memory_aug_recurrent_mem_tr__dense_activation_mish__prompt_kernel_112
spok_recurrent_scan__memory_aug_recurrent_mem_tr__dense_activation_mish__prompt_kernel_113:
spin_recurrent_scan__memory_aug_recurrent_mem_tr__dense_activation_mish__prompt_kernel_114:
    buffer_load_dword v9, v7, s[8:11], s38 offen offset:256 sc1
    s_waitcnt vmcnt(0)
    v_cmp_gt_u32 vcc, s39, v9
    s_cbranch_vccz spok_recurrent_scan__memory_aug_recurrent_mem_tr__dense_activation_mish__prompt_kernel_115
    s_add_u32 s44, s44, 1
    s_cmp_gt_u32 s44, 100000
    s_cbranch_scc1 recurrent_scan__memory_aug_recurrent_mem_tr__dense_activation_mish__prompt_kernel_exit
    s_sleep 2
    s_branch spin_recurrent_scan__memory_aug_recurrent_mem_tr__dense_activation_mish__prompt_kernel_114
spok_recurrent_scan__memory_aug_recurrent_mem_tr__dense_activation_mish__prompt_kernel_115:
spin_recurrent_scan__memory_aug_recurrent_mem_tr__dense_activation_mish__prompt_kernel_116:
    buffer_load_dword v9, v7, s[8:11], s38 offen offset:512 sc1
    s_waitcnt vmcnt(0)
    v_cmp_gt_u32 vcc, s39, v9
    s_cbranch_vccz spok_recurrent_scan__memory_aug_recurrent_mem_tr__dense_activation_mish__prompt_kernel_117
    s_add_u32 s44, s44, 1
    s_cmp_gt_u32 s44, 100000
    s_cbranch_scc1 recurrent_scan__memory_aug_recurrent_mem_tr__dense_activation_mish__prompt_kernel_exit
    s_sleep 2
    s_branch spin_recurrent_scan__memory_aug_recurrent_mem_tr__dense_activation_mish__prompt_kernel_116
spok_recurrent_scan__memory_aug_recurrent_mem_tr__dense_activation_mish__prompt_kernel_117:
    s_add_u32 s39, s41, 0
    buffer_load_dwordx4 v[32:35], v0, s[8:11], s39 offen sc1
    s_add_u32 s39, s41, 4096
    buffer_load_dwordx4 v[36:39], v0, s[8:11], s39 offen sc1
    s_add_u32 s39, s41, 8192
    buffer_load_dwordx4 v[40:43], v0, s[8:11], s39 offen sc1
    s_add_u32 s39, s41, 12288
    buffer_load_dwordx4 v[44:47], v0, s[8:11], s39 offen sc1
    s_add_u32 s39, s41, 16384
    buffer_load_dwordx4 v[48:51], v0, s[8:11], s39 offen sc1
    s_add_u32 s39, s41, 20480
    buffer_load_dwordx4 v[52:55], v0, s[8:11], s39 offen sc1
    s_add_u32 s39, s41, 24576
    buffer_load_dwordx4 v[56:59], v0, s[8:11], s39 offen sc1
    s_add_u32 s39, s41, 28672
    buffer_load_dwordx4 v[60:63], v0, s[8:11], s39 offen sc1
    s_add_u32 s39, s41, 32768
    buffer_load_dwordx4 v[64:67], v0, s[8:11], s39 offen sc1
    s_add_u32 s39, s41, 36864
    buffer_load_dwordx4 v[68:71], v0, s[8:11], s39 offen sc1
    s_add_u32 s39, s41, 40960
    buffer_load_dwordx4 v[72:75], v0, s[8:11], s39 offen sc1
    s_add_u32 s39, s41, 45056
    buffer_load_dwordx4 v[76:79], v0, s[8:11], s39 offen sc1
    s_add_u32 s39, s41, 49152
    buffer_load_dwordx4 v[80:83], v0, s[8:11], s39 offen sc1
    s_add_u32 s39, s41, s43
    buffer_load_dwordx4 v[84:87], v0, s[8:11], s39 offen sc1
    buffer_load_dword v9, v3, s[20:23], 0 offen
outloop_recurrent_scan__memory_aug_recurrent_mem_tr__dense_activation_mish__prompt_kernel_118:
    s_mul_i32 s47, s40, 20480
    s_waitcnt vmcnt(14)
    v_mfma_f32_16x16x32_bf16 v[24:27], v[144:147], v[32:35], 0
    v_mfma_f32_16x16x32_bf16 v[28:31], v[148:151], v[32:35], 0
    s_waitcnt vmcnt(13)
    v_mfma_f32_16x16x32_bf16 v[24:27], v[152:155], v[36:39], v[24:27]
    v_mfma_f32_16x16x32_bf16 v[28:31], v[156:159], v[36:39], v[28:31]
    s_waitcnt vmcnt(12)
    v_mfma_f32_16x16x32_bf16 v[24:27], v[160:163], v[40:43], v[24:27]
    v_mfma_f32_16x16x32_bf16 v[28:31], v[164:167], v[40:43], v[28:31]
    s_waitcnt vmcnt(11)
    v_mfma_f32_16x16x32_bf16 v[24:27], v[168:171], v[44:47], v[24:27]
    v_mfma_f32_16x16x32_bf16 v[28:31], v[172:175], v[44:47], v[28:31]
    s_waitcnt vmcnt(10)
    v_mfma_f32_16x16x32_bf16 v[24:27], v[176:179], v[48:51], v[24:27]
    v_mfma_f32_16x16x32_bf16 v[28:31], v[180:183], v[48:51], v[28:31]
    s_waitcnt vmcnt(9)
    v_mfma_f32_16x16x32_bf16 v[24:27], v[184:187], v[52:55], v[24:27]
    v_mfma_f32_16x16x32_bf16 v[28:31], v[188:191], v[52:55], v[28:31]
    s_waitcnt vmcnt(8)
    v_mfma_f32_16x16x32_bf16 v[24:27], v[192:195], v[56:59], v[24:27]
    v_mfma_f32_16x16x32_bf16 v[28:31], v[196:199], v[56:59], v[28:31]
    s_waitcnt vmcnt(7)
    v_mfma_f32_16x16x32_bf16 v[24:27], v[200:203], v[60:63], v[24:27]
    v_mfma_f32_16x16x32_bf16 v[28:31], v[204:207], v[60:63], v[28:31]
    s_waitcnt vmcnt(6)
    v_mfma_f32_16x16x32_bf16 v[24:27], v[208:211], v[64:67], v[24:27]
    v_mfma_f32_16x16x32_bf16 v[28:31], v[212:215], v[64:67], v[28:31]
    s_waitcnt vmcnt(5)
    v_mfma_f32_16x16x32_bf16 v[24:27], v[216:219], v[68:71], v[24:27]
    v_mfma_f32_16x16x32_bf16 v[28:31], v[220:223], v[68:71], v[28:31]
    s_waitcnt vmcnt(4)
    v_mfma_f32_16x16x32_bf16 v[24:27], v[224:227], v[72:75], v[24:27]
    v_mfma_f32_16x16x32_bf16 v[28:31], v[228:231], v[72:75], v[28:31]
    s_waitcnt vmcnt(3)
    v_mfma_f32_16x16x32_bf16 v[24:27], v[232:235], v[76:79], v[24:27]
    v_mfma_f32_16x16x32_bf16 v[28:31], v[236:239], v[76:79], v[28:31]
    s_waitcnt vmcnt(2)
    v_mfma_f32_16x16x32_bf16 v[24:27], v[240:243], v[80:83], v[24:27]
    v_mfma_f32_16x16x32_bf16 v[28:31], v[244:247], v[80:83], v[28:31]
    s_waitcnt vmcnt(1)
    v_mfma_f32_16x16x32_bf16 v[24:27], v[248:251], v[84:87], v[24:27]
    v_mfma_f32_16x16x32_bf16 v[28:31], v[252:255], v[84:87], v[28:31]
    s_lshr_b32 s38, s40, 1
    s_add_u32 s39, s38, 1
    s_and_b32 s38, s40, 7
    s_lshl_b32 s38, s38, 7
    s_add_u32 s38, s38, s46
spin_recurrent_scan__memory_aug_recurrent_mem_tr__dense_activation_mish__prompt_kernel_119:
    buffer_load_dword v9, v5, s[8:11], s38 offen offset:0 sc1
    s_waitcnt vmcnt(0)
    v_cmp_gt_u32 vcc, s39, v9
    s_cbranch_vccz spok_recurrent_scan__memory_aug_recurrent_mem_tr__dense_activation_mish__prompt_kernel_120
    s_add_u32 s44, s44, 1
    s_cmp_gt_u32 s44, 100000
    s_cbranch_scc1 recurrent_scan__memory_aug_recurrent_mem_tr__dense_activation_mish__prompt_kernel_exit
    s_sleep 2
    s_branch spin_recurrent_scan__memory_aug_recurrent_mem_tr__dense_activation_mish__prompt_kernel_119
spok_recurrent_scan__memory_aug_recurrent_mem_tr__dense_activation_mish__prompt_kernel_120:
    s_add_u32 s38, s42, 0
    buffer_load_dwordx4 v[88:91], v0, s[8:11], s38 offen offset:0 sc1
    buffer_load_dwordx4 v[92:95], v0, s[8:11], s38 offen offset:1024 sc1
    buffer_load_dwordx4 v[96:99], v0, s[8:11], s38 offen offset:2048 sc1
    buffer_load_dwordx4 v[100:103], v0, s[8:11], s38 offen offset:3072 sc1
    s_add_u32 s38, s42, 4096
    buffer_load_dwordx4 v[104:107], v0, s[8:11], s38 offen offset:0 sc1
    buffer_load_dwordx4 v[108:111], v0, s[8:11], s38 offen offset:1024 sc1
    buffer_load_dwordx4 v[112:115], v0, s[8:11], s38 offen offset:2048 sc1
    buffer_load_dwordx4 v[116:119], v0, s[8:11], s38 offen offset:3072 sc1
    s_add_u32 s38, s42, 8192
    buffer_load_dwordx4 v[120:123], v0, s[8:11], s38 offen offset:0 sc1
    buffer_load_dwordx4 v[124:127], v0, s[8:11], s38 offen offset:1024 sc1
    buffer_load_dwordx4 v[128:131], v0, s[8:11], s38 offen offset:2048 sc1
    buffer_load_dwordx4 v[132:135], v0, s[8:11], s38 offen offset:3072 sc1
    s_add_u32 s38, s42, 12288
    buffer_load_dwordx4 v[136:139], v0, s[8:11], s38 offen offset:0 sc1
    buffer_load_dwordx4 v[140:143], v0, s[8:11], s38 offen offset:1024 sc1
    buffer_load_dwordx4 v[32:35], v0, s[8:11], s38 offen offset:2048 sc1
    buffer_load_dwordx4 v[36:39], v0, s[8:11], s38 offen offset:3072 sc1
    s_add_u32 s38, s42, 16384
    buffer_load_dwordx4 v[40:43], v0, s[8:11], s38 offen offset:0 sc1
    buffer_load_dwordx4 v[44:47], v0, s[8:11], s38 offen offset:1024 sc1
    buffer_load_dwordx4 v[48:51], v0, s[8:11], s38 offen offset:2048 sc1
    buffer_load_dwordx4 v[52:55], v0, s[8:11], s38 offen offset:3072 sc1
    s_add_u32 s38, s42, 20480
    buffer_load_dwordx4 v[56:59], v0, s[8:11], s38 offen offset:0 sc1
    buffer_load_dwordx4 v[60:63], v0, s[8:11], s38 offen offset:1024 sc1
    buffer_load_dwordx4 v[64:67], v0, s[8:11], s38 offen offset:2048 sc1
    buffer_load_dwordx4 v[68:71], v0, s[8:11], s38 offen offset:3072 sc1
    s_add_u32 s38, s42, 24576
    buffer_load_dwordx4 v[72:75], v0, s[8:11], s38 offen offset:0 sc1
    buffer_load_dwordx4 v[76:79], v0, s[8:11], s38 offen offset:1024 sc1
    buffer_load_dwordx4 v[80:83], v0, s[8:11], s38 offen offset:2048 sc1
    buffer_load_dwordx4 v[84:87], v0, s[8:11], s38 offen offset:3072 sc1
    buffer_load_dword v9, v3, s[20:23], s47 offen
    v_add_u32 v10, s45, v6
    v_add_u32 v11, s45, v8
    ds_write_b128 v10, v[24:27] offset:2048
    ds_write_b128 v10, v[28:31] offset:3072
    s_add_u32 s41, s41, 331776
    s_add_u32 s48, s40, 6
    s_cmp_lt_u32 s48, 128
    s_cselect_b32 s41, s41, 71303168
    s_waitcnt vmcnt(28)
    v_mfma_f32_16x16x32_bf16 v[16:19], a[0:3], v[88:91], 0
    v_mfma_f32_16x16x32_bf16 v[20:23], a[4:7], v[88:91], 0
    s_add_u32 s38, s42, 28672
    buffer_load_dwordx4 v[88:91], v0, s[8:11], s38 offen offset:0 sc1
    s_waitcnt vmcnt(28)
    v_mfma_f32_16x16x32_bf16 v[16:19], a[8:11], v[92:95], v[16:19]
    v_mfma_f32_16x16x32_bf16 v[20:23], a[12:15], v[92:95], v[20:23]
    buffer_load_dwordx4 v[92:95], v0, s[8:11], s38 offen offset:1024 sc1
    s_waitcnt vmcnt(28)
    v_mfma_f32_16x16x32_bf16 v[16:19], a[16:19], v[96:99], v[16:19]
    v_mfma_f32_16x16x32_bf16 v[20:23], a[20:23], v[96:99], v[20:23]
    buffer_load_dwordx4 v[96:99], v0, s[8:11], s38 offen offset:2048 sc1
    s_waitcnt vmcnt(28)
    v_mfma_f32_16x16x32_bf16 v[16:19], a[24:27], v[100:103], v[16:19]
    v_mfma_f32_16x16x32_bf16 v[20:23], a[28:31], v[100:103], v[20:23]
    buffer_load_dwordx4 v[100:103], v0, s[8:11], s38 offen offset:3072 sc1
    s_waitcnt vmcnt(28)
    v_mfma_f32_16x16x32_bf16 v[16:19], a[32:35], v[104:107], v[16:19]
    v_mfma_f32_16x16x32_bf16 v[20:23], a[36:39], v[104:107], v[20:23]
    s_waitcnt vmcnt(27)
    v_mfma_f32_16x16x32_bf16 v[16:19], a[40:43], v[108:111], v[16:19]
    v_mfma_f32_16x16x32_bf16 v[20:23], a[44:47], v[108:111], v[20:23]
    s_waitcnt vmcnt(26)
    v_mfma_f32_16x16x32_bf16 v[16:19], a[48:51], v[112:115], v[16:19]
    v_mfma_f32_16x16x32_bf16 v[20:23], a[52:55], v[112:115], v[20:23]
    s_waitcnt vmcnt(25)
    v_mfma_f32_16x16x32_bf16 v[16:19], a[56:59], v[116:119], v[16:19]
    v_mfma_f32_16x16x32_bf16 v[20:23], a[60:63], v[116:119], v[20:23]
    s_waitcnt vmcnt(24)
    v_mfma_f32_16x16x32_bf16 v[16:19], a[64:67], v[120:123], v[16:19]
    v_mfma_f32_16x16x32_bf16 v[20:23], a[68:71], v[120:123], v[20:23]
    s_waitcnt vmcnt(23)
    v_mfma_f32_16x16x32_bf16 v[16:19], a[72:75], v[124:127], v[16:19]
    v_mfma_f32_16x16x32_bf16 v[20:23], a[76:79], v[124:127], v[20:23]
    s_waitcnt vmcnt(22)
    v_mfma_f32_16x16x32_bf16 v[16:19], a[80:83], v[128:131], v[16:19]
    v_mfma_f32_16x16x32_bf16 v[20:23], a[84:87], v[128:131], v[20:23]
    s_waitcnt vmcnt(21)
    v_mfma_f32_16x16x32_bf16 v[16:19], a[88:91], v[132:135], v[16:19]
    v_mfma_f32_16x16x32_bf16 v[20:23], a[92:95], v[132:135], v[20:23]
    s_waitcnt vmcnt(20)
    v_mfma_f32_16x16x32_bf16 v[16:19], a[96:99], v[136:139], v[16:19]
    v_mfma_f32_16x16x32_bf16 v[20:23], a[100:103], v[136:139], v[20:23]
    s_waitcnt vmcnt(19)
    v_mfma_f32_16x16x32_bf16 v[16:19], a[104:107], v[140:143], v[16:19]
    v_mfma_f32_16x16x32_bf16 v[20:23], a[108:111], v[140:143], v[20:23]
    s_waitcnt vmcnt(18)
    v_mfma_f32_16x16x32_bf16 v[16:19], a[112:115], v[32:35], v[16:19]
    v_mfma_f32_16x16x32_bf16 v[20:23], a[116:119], v[32:35], v[20:23]
    s_add_u32 s39, s41, 0
    buffer_load_dwordx4 v[32:35], v0, s[8:11], s39 offen sc1
    s_waitcnt vmcnt(18)
    v_mfma_f32_16x16x32_bf16 v[16:19], a[120:123], v[36:39], v[16:19]
    v_mfma_f32_16x16x32_bf16 v[20:23], a[124:127], v[36:39], v[20:23]
    s_add_u32 s39, s41, 4096
    buffer_load_dwordx4 v[36:39], v0, s[8:11], s39 offen sc1
    s_waitcnt vmcnt(18)
    v_mfma_f32_16x16x32_bf16 v[16:19], a[128:131], v[40:43], v[16:19]
    v_mfma_f32_16x16x32_bf16 v[20:23], a[132:135], v[40:43], v[20:23]
    s_add_u32 s39, s41, 8192
    buffer_load_dwordx4 v[40:43], v0, s[8:11], s39 offen sc1
    s_waitcnt vmcnt(18)
    v_mfma_f32_16x16x32_bf16 v[16:19], a[136:139], v[44:47], v[16:19]
    v_mfma_f32_16x16x32_bf16 v[20:23], a[140:143], v[44:47], v[20:23]
    s_add_u32 s39, s41, 12288
    buffer_load_dwordx4 v[44:47], v0, s[8:11], s39 offen sc1
    s_waitcnt vmcnt(18)
    v_mfma_f32_16x16x32_bf16 v[16:19], a[144:147], v[48:51], v[16:19]
    v_mfma_f32_16x16x32_bf16 v[20:23], a[148:151], v[48:51], v[20:23]
    s_add_u32 s39, s41, 16384
    buffer_load_dwordx4 v[48:51], v0, s[8:11], s39 offen sc1
    s_waitcnt vmcnt(18)
    v_mfma_f32_16x16x32_bf16 v[16:19], a[152:155], v[52:55], v[16:19]
    v_mfma_f32_16x16x32_bf16 v[20:23], a[156:159], v[52:55], v[20:23]
    s_add_u32 s39, s41, 20480
    buffer_load_dwordx4 v[52:55], v0, s[8:11], s39 offen sc1
    s_waitcnt vmcnt(18)
    v_mfma_f32_16x16x32_bf16 v[16:19], a[160:163], v[56:59], v[16:19]
    v_mfma_f32_16x16x32_bf16 v[20:23], a[164:167], v[56:59], v[20:23]
    s_add_u32 s39, s41, 24576
    buffer_load_dwordx4 v[56:59], v0, s[8:11], s39 offen sc1
    s_waitcnt vmcnt(18)
    v_mfma_f32_16x16x32_bf16 v[16:19], a[168:171], v[60:63], v[16:19]
    v_mfma_f32_16x16x32_bf16 v[20:23], a[172:175], v[60:63], v[20:23]
    s_add_u32 s39, s41, 28672
    buffer_load_dwordx4 v[60:63], v0, s[8:11], s39 offen sc1
    s_waitcnt vmcnt(18)
    v_mfma_f32_16x16x32_bf16 v[16:19], a[176:179], v[64:67], v[16:19]
    v_mfma_f32_16x16x32_bf16 v[20:23], a[180:183], v[64:67], v[20:23]
    s_add_u32 s39, s41, 32768
    buffer_load_dwordx4 v[64:67], v0, s[8:11], s39 offen sc1
    s_waitcnt vmcnt(18)
    v_mfma_f32_16x16x32_bf16 v[16:19], a[184:187], v[68:71], v[16:19]
    v_mfma_f32_16x16x32_bf16 v[20:23], a[188:191], v[68:71], v[20:23]
    s_add_u32 s39, s41, 36864
    buffer_load_dwordx4 v[68:71], v0, s[8:11], s39 offen sc1
    s_waitcnt vmcnt(18)
    v_mfma_f32_16x16x32_bf16 v[16:19], a[192:195], v[72:75], v[16:19]
    v_mfma_f32_16x16x32_bf16 v[20:23], a[196:199], v[72:75], v[20:23]
    s_add_u32 s39, s41, 40960
    buffer_load_dwordx4 v[72:75], v0, s[8:11], s39 offen sc1
    s_waitcnt vmcnt(18)
    v_mfma_f32_16x16x32_bf16 v[16:19], a[200:203], v[76:79], v[16:19]
    v_mfma_f32_16x16x32_bf16 v[20:23], a[204:207], v[76:79], v[20:23]
    s_add_u32 s39, s41, 45056
    buffer_load_dwordx4 v[76:79], v0, s[8:11], s39 offen sc1
    s_waitcnt vmcnt(18)
    v_mfma_f32_16x16x32_bf16 v[16:19], a[208:211], v[80:83], v[16:19]
    v_mfma_f32_16x16x32_bf16 v[20:23], a[212:215], v[80:83], v[20:23]
    s_add_u32 s39, s41, 49152
    buffer_load_dwordx4 v[80:83], v0, s[8:11], s39 offen sc1
    s_waitcnt vmcnt(18)
    v_mfma_f32_16x16x32_bf16 v[16:19], a[216:219], v[84:87], v[16:19]
    v_mfma_f32_16x16x32_bf16 v[20:23], a[220:223], v[84:87], v[20:23]
    s_add_u32 s39, s41, s43
    buffer_load_dwordx4 v[84:87], v0, s[8:11], s39 offen sc1
    s_waitcnt vmcnt(17)
    v_mfma_f32_16x16x32_bf16 v[16:19], a[224:227], v[88:91], v[16:19]
    v_mfma_f32_16x16x32_bf16 v[20:23], a[228:231], v[88:91], v[20:23]
    s_waitcnt vmcnt(16)
    v_mfma_f32_16x16x32_bf16 v[16:19], a[232:235], v[92:95], v[16:19]
    v_mfma_f32_16x16x32_bf16 v[20:23], a[236:239], v[92:95], v[20:23]
    s_waitcnt vmcnt(15)
    v_mfma_f32_16x16x32_bf16 v[16:19], a[240:243], v[96:99], v[16:19]
    v_mfma_f32_16x16x32_bf16 v[20:23], a[244:247], v[96:99], v[20:23]
    s_waitcnt vmcnt(14)
    v_mfma_f32_16x16x32_bf16 v[16:19], a[248:251], v[100:103], v[16:19]
    v_mfma_f32_16x16x32_bf16 v[20:23], a[252:255], v[100:103], v[20:23]
    s_nop 3
    ds_write_b128 v10, v[16:19] offset:0
    s_nop 2
    ds_write_b128 v10, v[20:23] offset:1024
    s_waitcnt lgkmcnt(0)
    s_barrier
    ds_read_b64 v[88:89], v11 offset:2048
    ds_read_b64 v[90:91], v11 offset:6144
    ds_read_b64 v[92:93], v11 offset:10240
    ds_read_b64 v[94:95], v11 offset:14336
    ds_read_b64 v[96:97], v11 offset:0
    ds_read_b64 v[98:99], v11 offset:4096
    ds_read_b64 v[100:101], v11 offset:8192
    ds_read_b64 v[102:103], v11 offset:12288
    s_waitcnt lgkmcnt(4)
    v_pk_add_f32 v[88:89], v[88:89], v[90:91]
    v_pk_add_f32 v[92:93], v[92:93], v[94:95]
    v_pk_add_f32 v[88:89], v[88:89], v[92:93]
    v_cvt_pk_bf16_f32 v90, v88, v89
    v_lshlrev_b32 v88, 16, v90
    v_and_b32 v89, 0xffff0000, v90
    v_mul_f32 v90, 0xbfb8aa3b, v88
    v_exp_f32 v90, v90
    v_mul_f32 v91, 0xbfb8aa3b, v89
    v_exp_f32 v91, v91
    v_add_f32 v90, 1.0, v90
    v_rcp_f32 v90, v90
    v_add_f32 v91, 1.0, v91
    v_rcp_f32 v91, v91
    s_waitcnt lgkmcnt(0)
    v_pk_add_f32 v[96:97], v[96:97], v[98:99]
    v_pk_add_f32 v[100:101], v[100:101], v[102:103]
    v_pk_add_f32 v[96:97], v[96:97], v[100:101]
    v_pk_mul_f32 v[88:89], v[88:89], v[90:91]
    v_cvt_pk_bf16_f32 v98, v96, v97
    v_lshlrev_b32 v96, 16, v98
    v_and_b32 v97, 0xffff0000, v98
    v_cvt_pk_bf16_f32 v90, v88, v89
    v_lshlrev_b32 v88, 16, v90
    v_and_b32 v89, 0xffff0000, v90
    v_pk_mul_f32 v[96:97], v[96:97], v[88:89]
    v_lshlrev_b32 v88, 16, v9
    v_and_b32 v89, 0xffff0000, v9
    v_cvt_pk_bf16_f32 v98, v96, v97
    v_lshlrev_b32 v96, 16, v98
    v_and_b32 v97, 0xffff0000, v98
    v_pk_add_f32 v[96:97], v[96:97], v[88:89]
    v_cvt_pk_bf16_f32 v12, v96, v97
    buffer_store_dword v12, v3, s[28:31], s47 offen
    s_mov_b32 s40, s48
    s_add_u32 s42, s42, 786432
    s_xor_b32 s45, s45, 16384
    s_cmp_lt_u32 s40, 128
    s_cbranch_scc1 outloop_recurrent_scan__memory_aug_recurrent_mem_tr__dense_activation_mish__prompt_kernel_118
outdone_recurrent_scan__memory_aug_recurrent_mem_tr__dense_activation_mish__prompt_kernel_110:
    s_endpgm
att_recurrent_scan__memory_aug_recurrent_mem_tr__dense_activation_mish__prompt_kernel_109:
    s_sub_u32 s7, 31, s5
    s_mul_i32 s7, s7, 6
    s_add_u32 s6, s6, s7
    s_cmp_ge_u32 s6, 64
    s_cbranch_scc1 recurrent_scan__memory_aug_recurrent_mem_tr__dense_activation_mish__prompt_kernel_exit
    v_mbcnt_lo_u32_b32 v0, -1, 0
    v_mbcnt_hi_u32_b32 v0, -1, v0
    s_lshr_b32 s26, s6, 4
    s_and_b32 s27, s6, 15
    s_lshl_b32 s27, s27, 1
    s_lshr_b32 s28, s3, 1
    s_add_u32 s27, s27, s28
    s_and_b32 s28, s3, 1
    v_lshrrev_b32 v2, 4, v0
    v_and_b32 v3, 15, v0
    s_lshl_b32 s29, s28, 4
    v_add_u32 v3, s29, v3
    v_lshlrev_b32 v2, 2, v2
    v_sub_u32 v3, v3, v2
    v_mov_b32 v4, 0xf149f2ca
    v_cmp_gt_i32 vcc, 0, v3
    s_nop 1
    v_cndmask_b32 v132, 0, v4, vcc
    v_cmp_gt_i32 vcc, 16, v3
    s_nop 1
    v_cndmask_b32 v136, 0, v4, vcc
    v_cmp_gt_i32 vcc, 1, v3
    s_nop 1
    v_cndmask_b32 v133, 0, v4, vcc
    v_cmp_gt_i32 vcc, 17, v3
    s_nop 1
    v_cndmask_b32 v137, 0, v4, vcc
    v_cmp_gt_i32 vcc, 2, v3
    s_nop 1
    v_cndmask_b32 v134, 0, v4, vcc
    v_cmp_gt_i32 vcc, 18, v3
    s_nop 1
    v_cndmask_b32 v138, 0, v4, vcc
    v_cmp_gt_i32 vcc, 3, v3
    s_nop 1
    v_cndmask_b32 v135, 0, v4, vcc
    v_cmp_gt_i32 vcc, 19, v3
    s_nop 1
    v_cndmask_b32 v139, 0, v4, vcc
    v_min_u32 v5, 1, v0
    v_lshlrev_b32 v5, 2, v5
    v_lshrrev_b32 v7, 2, v0
    v_lshlrev_b32 v7, 5, v7
    v_and_b32 v8, 1, v0
    v_lshl_add_u32 v7, v8, 4, v7
    v_min_u32 v6, 17, v0
    v_lshlrev_b32 v6, 2, v6
    v_lshlrev_b32 v1, 3, v0
    v_lshlrev_b32 v0, 4, v0
    v_mov_b32 v145, 0
    v_mov_b32 v146, 0
    s_mul_i32 s30, s27, 2097152
    s_lshl_b32 s31, s26, 15
    s_add_u32 s30, s30, s31
    s_lshl_b32 s31, s28, 10
    s_lshl_b32 s32, s27, 12
    s_lshl_b32 s33, s28, 17
    s_add_u32 s32, s32, s33
    s_lshl_b32 s33, s26, 18
    s_add_u32 s32, s32, s33
    s_add_u32 s32, s32, 79691776
    s_lshl_b32 s34, s27, 6
    s_add_u32 s34, s34, 97920000
    s_lshl_b32 s35, s27, 8
    s_add_u32 s35, s35, 97910784
    s_lshl_b32 s36, s26, 8
    s_lshl_b32 s37, s28, 7
    s_add_u32 s36, s36, s37
    s_lshl_b32 s37, s27, 2
    s_add_u32 s36, s36, s37
    s_add_u32 s36, s36, 97923072
    s_mov_b32 s40, 0
    s_mov_b32 s41, 0x3e0293ee
    s_add_u32 s37, s26, 1
spin_recurrent_scan__memory_aug_recurrent_mem_tr__dense_activation_mish__prompt_kernel_122:
    buffer_load_dword v148, v6, s[8:11], s35 offen offset:0 sc1
    s_waitcnt vmcnt(0)
    v_cmp_gt_u32 vcc, s37, v148
    s_cbranch_vccz spok_recurrent_scan__memory_aug_recurrent_mem_tr__dense_activation_mish__prompt_kernel_123
    s_add_u32 s40, s40, 1
    s_cmp_gt_u32 s40, 100000
    s_cbranch_scc1 recurrent_scan__memory_aug_recurrent_mem_tr__dense_activation_mish__prompt_kernel_exit
    s_sleep 2
    s_branch spin_recurrent_scan__memory_aug_recurrent_mem_tr__dense_activation_mish__prompt_kernel_122
spok_recurrent_scan__memory_aug_recurrent_mem_tr__dense_activation_mish__prompt_kernel_123:
    s_add_u32 s37, s30, 4194304
    s_add_u32 s37, s37, s31
    s_add_u32 s38, s37, 4096
    buffer_load_dwordx4 v[16:19], v0, s[8:11], s37 offen offset:0 sc1
    buffer_load_dwordx4 v[20:23], v0, s[8:11], s37 offen offset:2048 sc1
    buffer_load_dwordx4 v[24:27], v0, s[8:11], s38 offen offset:0 sc1
    buffer_load_dwordx4 v[28:31], v0, s[8:11], s38 offen offset:2048 sc1
    s_add_u32 s37, s30, 4202496
    s_add_u32 s38, s37, 4096
    buffer_load_dwordx4 v[32:35], v0, s[8:11], s37 offen offset:0 sc1
    buffer_load_dwordx4 v[36:39], v0, s[8:11], s37 offen offset:1024 sc1
    buffer_load_dwordx4 v[40:43], v0, s[8:11], s37 offen offset:2048 sc1
    buffer_load_dwordx4 v[44:47], v0, s[8:11], s37 offen offset:3072 sc1
    buffer_load_dwordx4 v[48:51], v0, s[8:11], s38 offen offset:0 sc1
    buffer_load_dwordx4 v[52:55], v0, s[8:11], s38 offen offset:1024 sc1
    buffer_load_dwordx4 v[56:59], v0, s[8:11], s38 offen offset:2048 sc1
    buffer_load_dwordx4 v[60:63], v0, s[8:11], s38 offen offset:3072 sc1
    s_add_u32 s37, s30, 4210688
    s_add_u32 s38, s37, 4096
    buffer_load_dwordx4 v[64:67], v0, s[8:11], s37 offen offset:0 sc1
    buffer_load_dwordx4 v[68:71], v0, s[8:11], s37 offen offset:1024 sc1
    buffer_load_dwordx4 v[72:75], v0, s[8:11], s37 offen offset:2048 sc1
    buffer_load_dwordx4 v[76:79], v0, s[8:11], s37 offen offset:3072 sc1
    buffer_load_dwordx4 v[80:83], v0, s[8:11], s38 offen offset:0 sc1
    buffer_load_dwordx4 v[84:87], v0, s[8:11], s38 offen offset:1024 sc1
    buffer_load_dwordx4 v[88:91], v0, s[8:11], s38 offen offset:2048 sc1
    buffer_load_dwordx4 v[92:95], v0, s[8:11], s38 offen offset:3072 sc1
attloop_recurrent_scan__memory_aug_recurrent_mem_tr__dense_activation_mish__prompt_kernel_124:
    s_waitcnt vmcnt(8)
    v_mfma_f32_16x16x32_bf16 v[120:123], v[32:35], v[16:19], v[132:135]
    v_mfma_f32_16x16x32_bf16 v[124:127], v[36:39], v[16:19], v[136:139]
    v_mfma_f32_16x16x32_bf16 v[120:123], v[40:43], v[20:23], v[120:123]
    v_mfma_f32_16x16x32_bf16 v[124:127], v[44:47], v[20:23], v[124:127]
    v_mfma_f32_16x16x32_bf16 v[120:123], v[48:51], v[24:27], v[120:123]
    v_mfma_f32_16x16x32_bf16 v[124:127], v[52:55], v[24:27], v[124:127]
    v_mfma_f32_16x16x32_bf16 v[120:123], v[56:59], v[28:31], v[120:123]
    v_mfma_f32_16x16x32_bf16 v[124:127], v[60:63], v[28:31], v[124:127]
    s_add_u32 s37, s26, 1
    s_add_u32 s39, s30, 4218880
    s_add_u32 s38, s39, 4096
    s_cmp_lt_u32 s26, 62
    s_cbranch_scc1 norm_recurrent_scan__memory_aug_recurrent_mem_tr__dense_activation_mish__prompt_kernel_126
fmp_recurrent_scan__memory_aug_recurrent_mem_tr__dense_activation_mish__prompt_kernel_127:
    buffer_load_dword v148, v5, s[8:11], s34 offen sc1
    buffer_load_dwordx4 v[96:99], v7, s[8:11], s39 offen offset:0 sc1
    buffer_load_dwordx4 v[100:103], v7, s[8:11], s39 offen offset:512 sc1
    buffer_load_dwordx4 v[104:107], v7, s[8:11], s39 offen offset:1024 sc1
    buffer_load_dwordx4 v[108:111], v7, s[8:11], s39 offen offset:1536 sc1
    buffer_load_dwordx2 v[112:113], v1, s[8:11], s38 offen offset:0 sc1
    buffer_load_dwordx2 v[114:115], v1, s[8:11], s38 offen offset:512 sc1
    buffer_load_dwordx2 v[116:117], v1, s[8:11], s38 offen offset:1024 sc1
    buffer_load_dwordx2 v[118:119], v1, s[8:11], s38 offen offset:1536 sc1
    s_waitcnt vmcnt(0)
    v_max_u32 v149, v96, v97
    v_max3_u32 v149, v149, v98, v99
    v_max3_u32 v149, v149, v100, v101
    v_max3_u32 v149, v149, v102, v103
    v_max3_u32 v149, v149, v104, v105
    v_max3_u32 v149, v149, v106, v107
    v_max3_u32 v149, v149, v108, v109
    v_max3_u32 v149, v149, v110, v111
    v_max3_u32 v149, v149, v112, v113
    v_max3_u32 v149, v149, v114, v115
    v_max3_u32 v149, v149, v116, v117
    v_max3_u32 v149, v149, v118, v119
    v_cmp_eq_u32 vcc, -1, v149
    s_cbranch_vccz have_recurrent_scan__memory_aug_recurrent_mem_tr__dense_activation_mish__prompt_kernel_125
    v_cmp_gt_u32 vcc, s37, v148
    s_cbranch_vccz norm_recurrent_scan__memory_aug_recurrent_mem_tr__dense_activation_mish__prompt_kernel_126
    s_add_u32 s40, s40, 1
    s_cmp_gt_u32 s40, 100000
    s_cbranch_scc1 recurrent_scan__memory_aug_recurrent_mem_tr__dense_activation_mish__prompt_kernel_exit
    s_sleep 1
    s_branch fmp_recurrent_scan__memory_aug_recurrent_mem_tr__dense_activation_mish__prompt_kernel_127
norm_recurrent_scan__memory_aug_recurrent_mem_tr__dense_activation_mish__prompt_kernel_126:
spin_recurrent_scan__memory_aug_recurrent_mem_tr__dense_activation_mish__prompt_kernel_128:
    buffer_load_dword v148, v5, s[8:11], s34 offen offset:0 sc1
    s_waitcnt vmcnt(0)
    v_cmp_gt_u32 vcc, s37, v148
    s_cbranch_vccz spok_recurrent_scan__memory_aug_recurrent_mem_tr__dense_activation_mish__prompt_kernel_129
    s_add_u32 s40, s40, 1
    s_cmp_gt_u32 s40, 100000
    s_cbranch_scc1 recurrent_scan__memory_aug_recurrent_mem_tr__dense_activation_mish__prompt_kernel_exit
    s_sleep 2
    s_branch spin_recurrent_scan__memory_aug_recurrent_mem_tr__dense_activation_mish__prompt_kernel_128
spok_recurrent_scan__memory_aug_recurrent_mem_tr__dense_activation_mish__prompt_kernel_129:
    buffer_load_dwordx4 v[96:99], v7, s[8:11], s39 offen offset:0 sc1
    buffer_load_dwordx4 v[100:103], v7, s[8:11], s39 offen offset:512 sc1
    buffer_load_dwordx4 v[104:107], v7, s[8:11], s39 offen offset:1024 sc1
    buffer_load_dwordx4 v[108:111], v7, s[8:11], s39 offen offset:1536 sc1
    buffer_load_dwordx2 v[112:113], v1, s[8:11], s38 offen offset:0 sc1
    buffer_load_dwordx2 v[114:115], v1, s[8:11], s38 offen offset:512 sc1
    buffer_load_dwordx2 v[116:117], v1, s[8:11], s38 offen offset:1024 sc1
    buffer_load_dwordx2 v[118:119], v1, s[8:11], s38 offen offset:1536 sc1
have_recurrent_scan__memory_aug_recurrent_mem_tr__dense_activation_mish__prompt_kernel_125:
    v_max3_f32 v148, v120, v121, v122
    v_max3_f32 v149, v123, v124, v125
    v_max3_f32 v149, v149, v126, v127
    v_max_f32 v148, v148, v149
    s_waitcnt vmcnt(7)
    v_mfma_f32_16x16x32_bf16 v[128:131], v[96:99], v[16:19], 0
    s_waitcnt vmcnt(6)
    v_mfma_f32_16x16x32_bf16 v[128:131], v[100:103], v[20:23], v[128:131]
    s_waitcnt vmcnt(5)
    v_mfma_f32_16x16x32_bf16 v[128:131], v[104:107], v[24:27], v[128:131]
    s_waitcnt vmcnt(4)
    v_mfma_f32_16x16x32_bf16 v[128:131], v[108:111], v[28:31], v[128:131]
    s_nop 7
    v_max3_f32 v148, v148, v128, v129
    v_mov_b32 v149, v148
    s_nop 1
    v_permlane32_swap_b32 v148, v149
    v_max_f32 v148, v148, v149
    v_mov_b32 v149, v148
    s_nop 1
    v_permlane16_swap_b32 v148, v149
    v_max_f32 v148, v148, v149
    v_mul_f32 v148, s41, v148
    v_fma_f32 v120, v120, s41, -v148
    v_fma_f32 v121, v121, s41, -v148
    v_fma_f32 v122, v122, s41, -v148
    v_fma_f32 v123, v123, s41, -v148
    v_fma_f32 v124, v124, s41, -v148
    v_fma_f32 v125, v125, s41, -v148
    v_fma_f32 v126, v126, s41, -v148
    v_fma_f32 v127, v127, s41, -v148
    v_fma_f32 v128, v128, s41, -v148
    v_fma_f32 v129, v129, s41, -v148
    v_exp_f32 v120, v120
    v_exp_f32 v121, v121
    v_exp_f32 v122, v122
    v_exp_f32 v123, v123
    v_exp_f32 v124, v124
    v_exp_f32 v125, v125
    v_exp_f32 v126, v126
    v_exp_f32 v127, v127
    v_exp_f32 v128, v128
    v_exp_f32 v129, v129
    v_cvt_pk_bf16_f32 v140, v120, v121
    v_cvt_pk_bf16_f32 v141, v122, v123
    v_cvt_pk_bf16_f32 v142, v124, v125
    v_cvt_pk_bf16_f32 v143, v126, v127
    v_cvt_pk_bf16_f32 v144, v128, v129
    v_mov_b32 v147, v144
    s_waitcnt vmcnt(0)
    v_mfma_f32_16x16x32_bf16 v[160:163], v[64:67], v[140:143], 0
    v_pk_add_f32 v[120:121], v[120:121], v[122:123]
    v_pk_add_f32 v[124:125], v[124:125], v[126:127]
    v_mfma_f32_16x16x32_bf16 v[164:167], v[68:71], v[140:143], 0
    v_pk_add_f32 v[120:121], v[120:121], v[128:129]
    v_mfma_f32_16x16x32_bf16 v[168:171], v[72:75], v[140:143], 0
    v_pk_add_f32 v[120:121], v[120:121], v[124:125]
    v_mfma_f32_16x16x32_bf16 v[172:175], v[76:79], v[140:143], 0
    v_add_f32 v150, v120, v121
    v_mfma_f32_16x16x32_bf16 v[176:179], v[80:83], v[140:143], 0
    v_mov_b32 v149, v150
    s_nop 1
    v_permlane32_swap_b32 v150, v149
    v_add_f32 v150, v150, v149
    v_mov_b32 v149, v150
    s_nop 1
    v_permlane16_swap_b32 v150, v149
    v_add_f32 v150, v150, v149
    v_mfma_f32_16x16x32_bf16 v[180:183], v[84:87], v[140:143], 0
    v_mfma_f32_16x16x32_bf16 v[184:187], v[88:91], v[140:143], 0
    v_mfma_f32_16x16x32_bf16 v[188:191], v[92:95], v[140:143], 0
    v_rcp_f32 v150, v150
    v_mfma_f32_16x16x16_bf16 v[160:163], v[112:113], v[144:145], v[160:163]
    v_mfma_f32_16x16x16_bf16 v[164:167], v[112:113], v[146:147], v[164:167]
    v_mfma_f32_16x16x16_bf16 v[168:171], v[114:115], v[144:145], v[168:171]
    v_mfma_f32_16x16x16_bf16 v[172:175], v[114:115], v[146:147], v[172:175]
    v_mfma_f32_16x16x16_bf16 v[176:179], v[116:117], v[144:145], v[176:179]
    v_mfma_f32_16x16x16_bf16 v[180:183], v[116:117], v[146:147], v[180:183]
    v_mfma_f32_16x16x16_bf16 v[184:187], v[118:119], v[144:145], v[184:187]
    v_mfma_f32_16x16x16_bf16 v[188:191], v[118:119], v[146:147], v[188:191]
    v_mov_b32 v151, v150
    v_pk_mul_f32 v[160:161], v[160:161], v[150:151]
    v_cvt_pk_bf16_f32 v192, v160, v161
    v_pk_mul_f32 v[162:163], v[162:163], v[150:151]
    v_cvt_pk_bf16_f32 v193, v162, v163
    v_pk_mul_f32 v[164:165], v[164:165], v[150:151]
    v_cvt_pk_bf16_f32 v194, v164, v165
    v_pk_mul_f32 v[166:167], v[166:167], v[150:151]
    v_cvt_pk_bf16_f32 v195, v166, v167
    buffer_store_dwordx4 v[192:195], v0, s[8:11], s32 offen offset:0 sc1
    v_pk_mul_f32 v[168:169], v[168:169], v[150:151]
    v_cvt_pk_bf16_f32 v196, v168, v169
    v_pk_mul_f32 v[170:171], v[170:171], v[150:151]
    v_cvt_pk_bf16_f32 v197, v170, v171
    v_pk_mul_f32 v[172:173], v[172:173], v[150:151]
    v_cvt_pk_bf16_f32 v198, v172, v173
    v_pk_mul_f32 v[174:175], v[174:175], v[150:151]
    v_cvt_pk_bf16_f32 v199, v174, v175
    buffer_store_dwordx4 v[196:199], v0, s[8:11], s32 offen offset:1024 sc1
    v_pk_mul_f32 v[176:177], v[176:177], v[150:151]
    v_cvt_pk_bf16_f32 v200, v176, v177
    v_pk_mul_f32 v[178:179], v[178:179], v[150:151]
    v_cvt_pk_bf16_f32 v201, v178, v179
    v_pk_mul_f32 v[180:181], v[180:181], v[150:151]
    v_cvt_pk_bf16_f32 v202, v180, v181
    v_pk_mul_f32 v[182:183], v[182:183], v[150:151]
    v_cvt_pk_bf16_f32 v203, v182, v183
    buffer_store_dwordx4 v[200:203], v0, s[8:11], s32 offen offset:2048 sc1
    v_pk_mul_f32 v[184:185], v[184:185], v[150:151]
    v_cvt_pk_bf16_f32 v204, v184, v185
    v_pk_mul_f32 v[186:187], v[186:187], v[150:151]
    v_cvt_pk_bf16_f32 v205, v186, v187
    v_pk_mul_f32 v[188:189], v[188:189], v[150:151]
    v_cvt_pk_bf16_f32 v206, v188, v189
    v_pk_mul_f32 v[190:191], v[190:191], v[150:151]
    v_cvt_pk_bf16_f32 v207, v190, v191
    buffer_store_dwordx4 v[204:207], v0, s[8:11], s32 offen offset:3072 sc1
    s_add_u32 s26, s26, 4
    s_add_u32 s30, s30, 131072
    s_add_u32 s32, s32, 1048576
    v_mov_b32 v149, s26
    s_waitcnt vmcnt(0)
    buffer_store_dword v149, off, s[8:11], s36 sc1
    s_cmp_ge_u32 s26, 64
    s_cbranch_scc1 attdone_recurrent_scan__memory_aug_recurrent_mem_tr__dense_activation_mish__prompt_kernel_121
    s_add_u32 s37, s26, 1
spin_recurrent_scan__memory_aug_recurrent_mem_tr__dense_activation_mish__prompt_kernel_130:
    buffer_load_dword v148, v6, s[8:11], s35 offen offset:0 sc1
    s_waitcnt vmcnt(0)
    v_cmp_gt_u32 vcc, s37, v148
    s_cbranch_vccz spok_recurrent_scan__memory_aug_recurrent_mem_tr__dense_activation_mish__prompt_kernel_131
    s_add_u32 s40, s40, 1
    s_cmp_gt_u32 s40, 100000
    s_cbranch_scc1 recurrent_scan__memory_aug_recurrent_mem_tr__dense_activation_mish__prompt_kernel_exit
    s_sleep 2
    s_branch spin_recurrent_scan__memory_aug_recurrent_mem_tr__dense_activation_mish__prompt_kernel_130
spok_recurrent_scan__memory_aug_recurrent_mem_tr__dense_activation_mish__prompt_kernel_131:
    s_add_u32 s37, s30, 4194304
    s_add_u32 s37, s37, s31
    s_add_u32 s38, s37, 4096
    buffer_load_dwordx4 v[16:19], v0, s[8:11], s37 offen offset:0 sc1
    buffer_load_dwordx4 v[20:23], v0, s[8:11], s37 offen offset:2048 sc1
    buffer_load_dwordx4 v[24:27], v0, s[8:11], s38 offen offset:0 sc1
    buffer_load_dwordx4 v[28:31], v0, s[8:11], s38 offen offset:2048 sc1
    s_add_u32 s37, s30, 4202496
    s_add_u32 s38, s37, 4096
    buffer_load_dwordx4 v[32:35], v0, s[8:11], s37 offen offset:0 sc1
    buffer_load_dwordx4 v[36:39], v0, s[8:11], s37 offen offset:1024 sc1
    buffer_load_dwordx4 v[40:43], v0, s[8:11], s37 offen offset:2048 sc1
    buffer_load_dwordx4 v[44:47], v0, s[8:11], s37 offen offset:3072 sc1
    buffer_load_dwordx4 v[48:51], v0, s[8:11], s38 offen offset:0 sc1
    buffer_load_dwordx4 v[52:55], v0, s[8:11], s38 offen offset:1024 sc1
    buffer_load_dwordx4 v[56:59], v0, s[8:11], s38 offen offset:2048 sc1
    buffer_load_dwordx4 v[60:63], v0, s[8:11], s38 offen offset:3072 sc1
    s_add_u32 s37, s30, 4210688
    s_add_u32 s38, s37, 4096
    buffer_load_dwordx4 v[64:67], v0, s[8:11], s37 offen offset:0 sc1
    buffer_load_dwordx4 v[68:71], v0, s[8:11], s37 offen offset:1024 sc1
    buffer_load_dwordx4 v[72:75], v0, s[8:11], s37 offen offset:2048 sc1
    buffer_load_dwordx4 v[76:79], v0, s[8:11], s37 offen offset:3072 sc1
    buffer_load_dwordx4 v[80:83], v0, s[8:11], s38 offen offset:0 sc1
    buffer_load_dwordx4 v[84:87], v0, s[8:11], s38 offen offset:1024 sc1
    buffer_load_dwordx4 v[88:91], v0, s[8:11], s38 offen offset:2048 sc1
    buffer_load_dwordx4 v[92:95], v0, s[8:11], s38 offen offset:3072 sc1
    s_branch attloop_recurrent_scan__memory_aug_recurrent_mem_tr__dense_activation_mish__prompt_kernel_124
attdone_recurrent_scan__memory_aug_recurrent_mem_tr__dense_activation_mish__prompt_kernel_121:
recurrent_scan__memory_aug_recurrent_mem_tr__dense_activation_mish__prompt_kernel_exit:
    s_endpgm
.section .rodata,"a"
.p2align 6
.amdhsa_kernel recurrent_scan__memory_aug_recurrent_mem_tr__dense_activation_mish__prompt_kernel
  .amdhsa_next_free_vgpr 512
  .amdhsa_next_free_sgpr 102
  .amdhsa_accum_offset 256
  .amdhsa_group_segment_fixed_size 0
  .amdhsa_kernarg_size 112
  .amdhsa_user_sgpr_count 2
  .amdhsa_user_sgpr_kernarg_segment_ptr 1
  .amdhsa_system_sgpr_workgroup_id_x 1
.end_amdhsa_kernel
```
